```python
import torch

def _softmax(x, axis=-1):
    return torch.softmax(x, dim=axis)
def _gelu(x):
    return torch.nn.functional.gelu(x, approximate="tanh")
def _silu(x):
    return torch.nn.functional.silu(x)
def _sigmoid(x):
    return torch.sigmoid(x)
def _layernorm(x, axis=-1, eps=1e-5):
    m = x.mean(dim=axis, keepdim=True)
    v = x.var(dim=axis, keepdim=True, unbiased=False)
    return (x - m) / torch.sqrt(v + eps)
def _scatter_add(tgt, idx, src, axis=0):
    return tgt.clone().index_add_(axis, idx, src)
def _segment_sum(src, seg, n):
    out = torch.zeros((n,) + src.shape[1:], dtype=src.dtype)
    return out.index_add_(0, seg, src)
def _pad(x, pw):
    flat = tuple(v for pair in reversed(pw) for v in pair)
    return torch.nn.functional.pad(x, flat)

kernel_name = 'recurrent_scan__sliding_block__geglu_ffn__prompt'

def setup_inputs():

    _w = (lambda a: (lambda t: t.to(torch.bfloat16) if t.is_floating_point() else t)(torch.as_tensor(a)))
    def _A_setup():
        B, S, D = 1, 2048, 640
        return {
            "x": _w((lambda *s: torch.randn(*s, dtype=torch.bfloat16) * 0.05)(B, S, D)),
            "wqkv": _w((lambda *s: torch.randn(*s, dtype=torch.bfloat16) * 0.05)(D, 3 * D)),
            "wo": _w((lambda *s: torch.randn(*s, dtype=torch.bfloat16) * 0.05)(D, D)),
        }
    _A_in = _A_setup()

    def _B_setup():
        B, S, D, F = 1, 2048, 640, 1728
        return {
            "x": _w((lambda *s: torch.randn(*s, dtype=torch.bfloat16) * 0.05)(B, S, D)),
            "w_gate": _w((lambda *s: torch.randn(*s, dtype=torch.bfloat16) * 0.05)(D, F)),
            "w_up": _w((lambda *s: torch.randn(*s, dtype=torch.bfloat16) * 0.05)(D, F)),
            "w_down": _w((lambda *s: torch.randn(*s, dtype=torch.bfloat16) * 0.05)(F, D)),
        }
    _B_in = _B_setup()

    return {
        "A_x": _A_in["x"],
        "A_wqkv": _A_in["wqkv"],
        "A_wo": _A_in["wo"],
        "B_x": _B_in["x"],
        "B_w_gate": _B_in["w_gate"],
        "B_w_up": _B_in["w_up"],
        "B_w_down": _B_in["w_down"],
    }

def reference(A_x, A_wqkv, A_wo, B_x, B_w_gate, B_w_up, B_w_down):
    def _A_ref(x, wqkv, wo):
        B, S, D = x.shape
        H = 32; Dh = D // H; W = 256
        qkv = (lambda x, *d: x.permute(*d))((x @ wqkv).reshape(B, S, 3, H, Dh), 2, 0, 3, 1, 4)
        q, k, v = qkv[0], qkv[1], qkv[2]
        scores = torch.einsum("bhqd,bhkd->bhqk", q, k) * (Dh ** -0.5)
        idx = torch.arange(S)
        mask = (idx[:, None] - idx[None, :] >= 0) & (idx[:, None] - idx[None, :] < W)
        scores = torch.where(mask[None, None], scores, -1e9)
        p = _softmax(scores, axis=-1)
        o = torch.einsum("bhqk,bhkd->bhqd", p, v)
        return (lambda x, *d: x.permute(*d))(o, 0, 2, 1, 3).reshape(B, S, D) @ wo

    def _B_ref(x, w_gate, w_up, w_down):
        return (_gelu(x @ w_gate) * (x @ w_up)) @ w_down

    x = A_x
    xn = _layernorm(x, axis=-1)
    s = _A_ref(xn, A_wqkv, A_wo)
    g = _silu(_B_ref(xn, B_w_gate, B_w_up, B_w_down))
    return x + s * g
```

```asm
; @launch grid=(256,1,1) block=(256,1,1) lds=163840
.amdgcn_target "amdgcn-amd-amdhsa--gfx950"
.text
.globl recurrent_scan__sliding_block__geglu_ffn__prompt_kernel
.p2align 8
.type recurrent_scan__sliding_block__geglu_ffn__prompt_kernel,@function
recurrent_scan__sliding_block__geglu_ffn__prompt_kernel:
s_cmp_ge_u32 s2, 256
s_cbranch_scc0 L_go
s_endpgm
L_go:
s_load_dwordx4 s[4:7], s[0:1], 0
s_load_dwordx4 s[20:23], s[0:1], 64
s_load_dwordx2 s[8:9], s[0:1], 16
s_load_dwordx4 s[12:15], s[0:1], 32
s_load_dwordx4 s[16:19], s[0:1], 48
v_and_b32 v224, 63, v0
v_lshrrev_b32 v240, 6, v0
s_nop 0
v_readfirstlane_b32 s3, v240
s_getpc_b64 s[70:71]
L_pc:
s_lshr_b32 s72, s2, 3
s_lshl_b32 s72, s72, 2
s_nop 0
s_add_u32 s72, s72, s3
s_lshl_b32 s72, s72, 9
v_and_b32 v241, 3, v224
v_lshlrev_b32 v241, 7, v241
v_add_u32 v241, s72, v241
v_min_u32 v241, L_end_of_code-L_pc-4, v241
global_load_dword a255, v241, s[70:71]
s_and_b32 s70, s2, 7
s_lshr_b32 s71, s2, 3
s_lshr_b32 s72, s70, 2
s_lshl_b32 s72, s72, 3
s_and_b32 s74, s71, 7
s_add_u32 s52, s72, s74
s_and_b32 s72, s70, 3
s_lshl_b32 s72, s72, 2
s_lshr_b32 s73, s71, 3
s_add_u32 s53, s72, s73
s_lshl_b32 s72, s52, 7
s_lshl_b32 s75, s3, 5
s_add_u32 s54, s72, s75
s_lshl_b32 s60, s3, 12
s_lshr_b32 s75, s70, 2
s_lshl_b32 s75, s75, 1
s_add_u32 s74, s74, s75
s_mul_i32 s73, s73, 3
s_and_b32 s74, s74, 15
s_mul_i32 s74, s74, 1
s_add_u32 s73, s73, s74
s_cmp_ge_u32 s73, 10
s_cselect_b32 s74, 10, 0
s_sub_u32 s76, s73, s74
v_lshrrev_b32 v240, 3, v224
v_mul_u32_u24 v240, 1280, v240
v_lshrrev_b32 v241, 4, v224
v_and_b32 v176, 7, v224
v_xor_b32 v176, v176, v241
v_lshl_add_u32 v176, v176, 4, v240
v_xor_b32 v177, 64, v176
v_add_u32 v177, 9216, v177
v_add_u32 v178, 18432, v176
v_add_u32 v179, 18432, v177
s_mul_i32 s10, s54, 1280
s_mul_i32 s11, s3, 28672
s_add_u32 s11, s11, 49152
s_waitcnt lgkmcnt(0)
s_mov_b32 s24, s4
s_and_b32 s25, s5, 0xffff
s_mov_b32 s26, 2621440
s_mov_b32 s27, 0x20000
s_mov_b32 s36, s22
s_and_b32 s37, s23, 0xffff
s_mov_b32 s38, 20607104
s_mov_b32 s39, 0x20000
s_mov_b32 s22, s76
s_sub_u32 s23, 10, s76
s_add_u32 s0, s22, 0
s_cmp_ge_u32 s0, 10
s_cselect_b32 s1, 10, 0
s_sub_u32 s0, s0, s1
s_lshl_b32 s0, s0, 7
s_add_u32 m0, s11, 0
s_add_u32 s0, s0, s10
buffer_load_dwordx4 v176, s[24:27], s0 offen lds
s_sub_u32 s32, s6, 4096
s_subb_u32 s33, s7, 0
s_and_b32 s33, s33, 0xffff
s_mov_b32 s34, 2461696
s_mov_b32 s35, 0x20000
s_mov_b32 s40, s18
s_and_b32 s41, s19, 0xffff
s_mov_b32 s42, 2621440
s_mov_b32 s43, 0x20000
s_cmp_lt_u32 s3, 2
s_cselect_b32 s70, s12, s14
s_cselect_b32 s71, s13, s15
s_sub_u32 s96, s70, 4096
s_subb_u32 s97, s71, 0
buffer_load_dwordx4 v177, s[24:27], s0 offen offset:1024 lds
s_and_b32 s97, s97, 0xffff
s_mov_b32 s98, 2215936
s_mov_b32 s99, 0x20000
s_mov_b32 s72, 2215936
s_cmp_ge_u32 s53, 13
s_cselect_b32 s70, s6, s70
s_cselect_b32 s71, s7, s71
s_cselect_b32 s72, 2461696, s72
s_sub_u32 s28, s70, 4096
s_subb_u32 s29, s71, 0
s_and_b32 s29, s29, 0xffff
s_mov_b32 s30, s72
s_mov_b32 s31, 0x20000
s_mul_i32 s62, s53, 3
buffer_load_dwordx4 v178, s[24:27], s0 offen offset:2048 lds
s_mov_b32 s61, 42
s_cmp_eq_u32 s53, 14
s_cselect_b32 s62, 50, s62
s_cselect_b32 s61, 46, s61
s_cmp_eq_u32 s53, 15
s_cselect_b32 s62, 53, s62
s_cselect_b32 s61, 56, s61
s_lshl_b32 s64, s53, 1
s_add_u32 s65, s64, 1
s_cmp_ge_u32 s53, 13
s_cselect_b32 s65, 26, s65
s_lshr_b32 s70, s3, 1
s_lshl_b32 s70, s70, 7
s_and_b32 s71, s62, 0xfe
buffer_load_dwordx4 v179, s[24:27], s0 offen offset:3072 lds
s_lshl_b32 s71, s71, 6
s_add_u32 s71, s71, s70
s_add_u32 s56, s71, 3072
s_lshl_b32 s72, s64, 7
s_lshl_b32 s73, s65, 7
s_lshl_b32 s74, s61, 6
s_add_u32 s74, s74, s70
s_cmp_ge_u32 s53, 13
s_cselect_b32 s72, s74, s72
s_mov_b32 s76, 55296
s_cselect_b32 s76, 61440, s76
s_add_u32 s55, s72, 4096
s_add_u32 s57, s73, 4096
s_sub_u32 s58, s76, 2048
s_add_u32 s0, s22, 1
s_cmp_ge_u32 s0, 10
s_cselect_b32 s1, 10, 0
s_sub_u32 s0, s0, s1
s_lshl_b32 s0, s0, 7
s_add_u32 m0, s11, 4096
s_add_u32 s0, s0, s10
buffer_load_dwordx4 v176, s[24:27], s0 offen lds
s_add_u32 s59, s76, 2048
s_lshl_b32 s70, s22, 2
s_mul_i32 s71, s70, s76
s_add_u32 s55, s55, s71
s_mul_i32 s71, s70, 55296
s_add_u32 s57, s57, s71
s_mul_i32 s71, s70, 61440
s_add_u32 s56, s56, s71
s_mul_i32 s20, s76, 40
s_mov_b32 s66, 2211840
s_mov_b32 s18, 54272
s_mov_b32 s19, 58368
s_cmp_ge_u32 s53, 15
s_cselect_b32 s57, 2146435072, s57
buffer_load_dwordx4 v177, s[24:27], s0 offen offset:1024 lds
v_lshrrev_b32 v240, 3, v224
v_lshrrev_b32 v241, 4, v224
v_and_b32 v241, 1, v241
v_lshlrev_b32 v241, 1, v241
s_lshr_b32 s70, s3, 1
v_add_u32 v241, s70, v241
v_bfe_u32 v242, v224, 1, 2
v_xor_b32 v242, v242, v241
v_lshlrev_b32 v242, 5, v242
v_and_b32 v243, 1, v224
v_lshl_add_u32 v242, v243, 4, v242
s_and_b32 s71, s3, 1
s_lshl_b32 s71, s71, 3
v_add_u32 v240, s71, v240
buffer_load_dwordx4 v178, s[24:27], s0 offen offset:2048 lds
s_mov_b32 s72, 3840
v_mul_lo_u32 v243, v240, s72
v_add_u32 v226, v243, v242
v_mul_u32_u24 v243, 3456, v240
v_add_u32 v250, v243, v242
s_cmp_ge_u32 s53, 13
s_mov_b32 s72, 3456
s_cselect_b32 s72, 3840, s72
v_mul_lo_u32 v243, v240, s72
v_add_u32 v225, v243, v242
v_and_b32 v240, 31, v224
v_lshlrev_b32 v240, 7, v240
v_add_u32 v240, s11, v240
v_bfe_u32 v241, v224, 1, 3
buffer_load_dwordx4 v179, s[24:27], s0 offen offset:3072 lds
v_lshrrev_b32 v242, 5, v224
v_add_u32 v243, 0, v242
v_xor_b32 v243, v243, v241
v_lshl_add_u32 v180, v243, 4, v240
v_add_u32 v243, 2, v242
v_xor_b32 v243, v243, v241
v_lshl_add_u32 v181, v243, 4, v240
v_add_u32 v243, 4, v242
v_xor_b32 v243, v243, v241
v_lshl_add_u32 v182, v243, 4, v240
v_add_u32 v243, 6, v242
v_xor_b32 v243, v243, v241
v_lshl_add_u32 v183, v243, 4, v240
v_mov_b32 v184, 0
s_add_u32 s0, s22, 2
s_cmp_ge_u32 s0, 10
s_cselect_b32 s1, 10, 0
s_sub_u32 s0, s0, s1
s_lshl_b32 s0, s0, 7
s_add_u32 m0, s11, 8192
s_add_u32 s0, s0, s10
buffer_load_dwordx4 v176, s[24:27], s0 offen lds
v_mov_b32 v185, 0
v_mov_b32 v186, 0
v_mov_b32 v187, 0
v_mov_b32 v188, 0
v_mov_b32 v189, 0
v_mov_b32 v190, 0
v_mov_b32 v191, 0
s_mov_b32 s4, 0x3f803f80
buffer_load_dwordx4 v177, s[24:27], s0 offen offset:1024 lds
buffer_load_dwordx4 v178, s[24:27], s0 offen offset:2048 lds
buffer_load_dwordx4 v179, s[24:27], s0 offen offset:3072 lds
s_add_u32 m0, s60, 0
s_nop 0
buffer_load_dwordx4 v225, s[28:31], s55 offen lds
s_add_u32 s55, s55, s58
buffer_load_dwordx4 v226, s[32:35], s56 offen offset:1024 lds
s_add_u32 s56, s56, 59392
buffer_load_dwordx4 v225, s[28:31], s55 offen offset:2048 lds
s_add_u32 s55, s55, s59
buffer_load_dwordx4 v226, s[32:35], s56 offen offset:3072 lds
s_add_u32 s56, s56, 63488
v_cmp_eq_u32 vcc, 0, v224
v_mov_b32 v252, 2146435072
v_mov_b32 v253, 20594688
v_cndmask_b32 v252, v252, v253, vcc
buffer_load_dword v253, v252, s[36:39], 0 offen sc1
s_lshl_b32 s70, s3, 8
s_add_u32 s70, s70, s2
s_cmp_ge_u32 s70, 540
s_cselect_b32 s71, 1, 0
s_cselect_b32 s72, 540, 0
s_cselect_b32 s74, s8, s16
s_cselect_b32 s75, s9, s17
s_mov_b32 s76, 2211840
s_cselect_b32 s76, 819200, s76
s_sub_u32 s72, s70, s72
s_cmp_ge_u32 s70, 740
s_cselect_b32 s76, 0, s76
s_cselect_b32 s77, 1, 0
s_mov_b32 s44, s74
s_and_b32 s45, s75, 0xffff
s_mov_b32 s46, s76
s_mov_b32 s47, 0x20000
s_mul_i32 s73, s72, 6554
s_lshr_b32 s73, s73, 16
s_mul_i32 s74, s73, 10
s_sub_u32 s74, s72, s74
v_bfe_u32 v244, v224, 3, 2
v_mul_u32_u24 v244, 1280, v244
v_and_b32 v245, 7, v224
v_lshl_add_u32 v244, v245, 4, v244
s_lshl_b32 s79, s74, 7
v_add_u32 v244, s79, v244
v_lshrrev_b32 v245, 5, v224
s_lshl_b32 s75, s73, 2
s_mul_i32 s76, s75, 13108
s_lshr_b32 s76, s76, 16
s_mul_i32 s78, s76, 5
s_sub_u32 s78, s75, s78
s_mul_i32 s76, s76, 40
s_lshl_b32 s67, s78, 2
s_add_u32 s67, s67, s76
s_cmp_ge_u32 s78, 2
s_cselect_b32 s68, 8, 0
s_add_u32 s67, s67, s68
s_cmp_eq_u32 s78, 2
s_cselect_b32 s69, 20, 8
s_lshl_b32 s68, s73, 5
s_add_u32 s68, s68, 0
s_cmp_eq_u32 s71, 1
s_cselect_b32 s67, s67, s68
s_cselect_b32 s69, s69, 8
s_mul_i32 s67, s67, 1280
s_sub_u32 s67, s67, 0
s_mul_i32 s69, s69, 1280
v_mul_lo_u32 v192, v245, s69
v_add_u32 v192, v192, v244
v_add_u32 v192, s67, v192
s_add_u32 s78, s78, 1
s_cmp_eq_u32 s78, 5
s_cselect_b32 s78, 0, s78
s_cselect_b32 s67, 40, 0
s_add_u32 s76, s76, s67
s_lshl_b32 s67, s78, 2
s_add_u32 s67, s67, s76
s_cmp_ge_u32 s78, 2
s_cselect_b32 s68, 8, 0
s_add_u32 s67, s67, s68
s_cmp_eq_u32 s78, 2
s_cselect_b32 s69, 20, 8
s_lshl_b32 s68, s73, 5
s_add_u32 s68, s68, 4
s_cmp_eq_u32 s71, 1
s_cselect_b32 s67, s67, s68
s_cselect_b32 s69, s69, 8
s_mul_i32 s67, s67, 1280
s_sub_u32 s67, s67, 1024
s_mul_i32 s69, s69, 1280
v_mul_lo_u32 v193, v245, s69
v_add_u32 v193, v193, v244
v_add_u32 v193, s67, v193
s_add_u32 s78, s78, 1
s_cmp_eq_u32 s78, 5
s_cselect_b32 s78, 0, s78
s_cselect_b32 s67, 40, 0
s_add_u32 s76, s76, s67
s_lshl_b32 s67, s78, 2
s_add_u32 s67, s67, s76
s_cmp_ge_u32 s78, 2
s_cselect_b32 s68, 8, 0
s_add_u32 s67, s67, s68
s_cmp_eq_u32 s78, 2
s_cselect_b32 s69, 20, 8
s_lshl_b32 s68, s73, 5
s_add_u32 s68, s68, 16
s_cmp_eq_u32 s71, 1
s_cselect_b32 s67, s67, s68
s_cselect_b32 s69, s69, 8
s_mul_i32 s67, s67, 1280
s_sub_u32 s67, s67, 2048
s_mul_i32 s69, s69, 1280
v_mul_lo_u32 v194, v245, s69
v_add_u32 v194, v194, v244
v_add_u32 v194, s67, v194
s_add_u32 s78, s78, 1
s_cmp_eq_u32 s78, 5
s_cselect_b32 s78, 0, s78
s_cselect_b32 s67, 40, 0
s_add_u32 s76, s76, s67
s_lshl_b32 s67, s78, 2
s_add_u32 s67, s67, s76
s_cmp_ge_u32 s78, 2
s_cselect_b32 s68, 8, 0
s_add_u32 s67, s67, s68
s_cmp_eq_u32 s78, 2
s_cselect_b32 s69, 20, 8
s_lshl_b32 s68, s73, 5
s_add_u32 s68, s68, 20
s_cmp_eq_u32 s71, 1
s_cselect_b32 s67, s67, s68
s_cselect_b32 s69, s69, 8
s_mul_i32 s67, s67, 1280
s_sub_u32 s67, s67, 3072
s_mul_i32 s69, s69, 1280
v_mul_lo_u32 v195, v245, s69
v_add_u32 v195, v195, v244
v_add_u32 v195, s67, v195
s_lshl_b32 s75, s74, 2
s_mul_i32 s76, s75, 13108
s_lshr_b32 s76, s76, 16
s_mul_i32 s78, s76, 5
s_sub_u32 s78, s75, s78
s_cmp_eq_u32 s71, 1
s_cselect_b32 s79, 20, 54
s_mov_b32 s75, 17563648
s_cselect_b32 s75, 19775488, s75
s_mul_i32 s67, s73, 5120
s_add_u32 s75, s75, s67
s_mul_i32 s79, s79, 5120
s_mul_i32 s67, s76, s79
s_add_u32 s67, s67, s75
s_lshl_b32 s68, s78, 10
s_add_u32 s67, s67, s68
s_cmp_eq_u32 s77, 1
s_cselect_b32 s12, 2146435072, s67
s_add_u32 s78, s78, 1
s_cmp_eq_u32 s78, 5
s_cselect_b32 s78, 0, s78
s_cselect_b32 s67, 1, 0
s_add_u32 s76, s76, s67
s_mul_i32 s67, s76, s79
s_add_u32 s67, s67, s75
s_lshl_b32 s68, s78, 10
s_add_u32 s67, s67, s68
s_cmp_eq_u32 s77, 1
s_cselect_b32 s13, 2146435072, s67
s_add_u32 s78, s78, 1
s_cmp_eq_u32 s78, 5
s_cselect_b32 s78, 0, s78
s_cselect_b32 s67, 1, 0
s_add_u32 s76, s76, s67
s_mul_i32 s67, s76, s79
s_add_u32 s67, s67, s75
s_lshl_b32 s68, s78, 10
s_add_u32 s67, s67, s68
s_cmp_eq_u32 s77, 1
s_cselect_b32 s14, 2146435072, s67
s_add_u32 s78, s78, 1
s_cmp_eq_u32 s78, 5
s_cselect_b32 s78, 0, s78
s_cselect_b32 s67, 1, 0
s_add_u32 s76, s76, s67
s_mul_i32 s67, s76, s79
s_add_u32 s67, s67, s75
s_lshl_b32 s68, s78, 10
s_add_u32 s67, s67, s68
s_cmp_eq_u32 s77, 1
s_cselect_b32 s15, 2146435072, s67
s_and_b32 s70, s2, 7
s_lshr_b32 s71, s2, 3
s_lshl_b32 s72, s70, 1
s_and_b32 s73, s71, 1
s_add_u32 s6, s72, s73
s_lshr_b32 s5, s71, 1
s_lshr_b32 s72, s70, 1
s_lshl_b32 s72, s72, 3
s_and_b32 s73, s71, 7
s_add_u32 s7, s72, s73
s_and_b32 s72, s70, 1
s_lshl_b32 s72, s72, 2
s_lshr_b32 s73, s71, 3
s_add_u32 s8, s72, s73
v_lshrrev_b32 v244, 5, v224
v_lshlrev_b32 v244, 12, v244
v_bfe_u32 v245, v224, 2, 2
v_lshl_add_u32 v244, v245, 7, v244
v_and_b32 v245, 3, v224
v_lshl_add_u32 v244, v245, 3, v244
v_bfe_u32 v245, v224, 4, 1
v_bfe_u32 v246, v224, 3, 1
v_lshlrev_b32 v246, 1, v246
s_and_b32 s73, s62, 1
s_add_u32 s73, s73, 0
s_lshr_b32 s74, s73, 1
s_and_b32 s75, s73, 1
s_lshl_b32 s75, s75, 1
v_add_u32 v247, s75, v245
v_add_u32 v248, s74, v246
v_xor_b32 v247, v247, v248
s_lshl_b32 s74, s74, 13
v_lshl_add_u32 v247, v247, 5, v244
v_add_u32 v231, s74, v247
s_and_b32 s73, s62, 1
s_add_u32 s73, s73, 1
s_lshr_b32 s74, s73, 1
s_and_b32 s75, s73, 1
s_lshl_b32 s75, s75, 1
v_add_u32 v247, s75, v245
v_add_u32 v248, s74, v246
v_xor_b32 v247, v247, v248
s_lshl_b32 s74, s74, 13
v_lshl_add_u32 v247, v247, 5, v244
v_add_u32 v232, s74, v247
s_and_b32 s73, s62, 1
s_add_u32 s73, s73, 2
s_lshr_b32 s74, s73, 1
s_and_b32 s75, s73, 1
s_lshl_b32 s75, s75, 1
v_add_u32 v247, s75, v245
v_add_u32 v248, s74, v246
v_xor_b32 v247, v247, v248
s_lshl_b32 s74, s74, 13
v_lshl_add_u32 v247, v247, 5, v244
v_add_u32 v233, s74, v247
s_cmp_ge_u32 s53, 13
s_cbranch_scc1 L_ta_1
v_add_u32 v248, v245, v246
v_xor_b32 v247, 0, v248
v_lshl_add_u32 v247, v247, 5, v244
v_lshl_add_u32 v227, v245, 13, v247
v_add_u32 v248, v245, v246
v_xor_b32 v247, 1, v248
v_lshl_add_u32 v247, v247, 5, v244
v_lshl_add_u32 v228, v245, 13, v247
v_add_u32 v248, v245, v246
v_xor_b32 v247, 2, v248
v_lshl_add_u32 v247, v247, 5, v244
v_lshl_add_u32 v229, v245, 13, v247
v_add_u32 v248, v245, v246
v_xor_b32 v247, 3, v248
v_lshl_add_u32 v247, v247, 5, v244
v_lshl_add_u32 v230, v245, 13, v247
s_branch L_tb_2
L_ta_1:
s_mov_b32 s73, 0
s_lshr_b32 s74, s73, 1
s_and_b32 s75, s73, 1
s_lshl_b32 s75, s75, 1
v_add_u32 v247, s75, v245
v_add_u32 v248, s74, v246
v_xor_b32 v247, v247, v248
s_lshl_b32 s74, s74, 13
v_lshl_add_u32 v247, v247, 5, v244
v_add_u32 v227, s74, v247
s_mov_b32 s73, 1
s_lshr_b32 s74, s73, 1
s_and_b32 s75, s73, 1
s_lshl_b32 s75, s75, 1
v_add_u32 v247, s75, v245
v_add_u32 v248, s74, v246
v_xor_b32 v247, v247, v248
s_lshl_b32 s74, s74, 13
v_lshl_add_u32 v247, v247, 5, v244
v_add_u32 v228, s74, v247
s_mov_b32 s73, 2
s_lshr_b32 s74, s73, 1
s_and_b32 s75, s73, 1
s_lshl_b32 s75, s75, 1
v_add_u32 v247, s75, v245
v_add_u32 v248, s74, v246
v_xor_b32 v247, v247, v248
s_lshl_b32 s74, s74, 13
v_lshl_add_u32 v247, v247, 5, v244
v_add_u32 v229, s74, v247
s_mov_b32 s73, 3
s_lshr_b32 s74, s73, 1
s_and_b32 s75, s73, 1
s_lshl_b32 s75, s75, 1
v_add_u32 v247, s75, v245
v_add_u32 v248, s74, v246
v_xor_b32 v247, v247, v248
s_lshl_b32 s74, s74, 13
v_lshl_add_u32 v247, v247, 5, v244
v_add_u32 v230, s74, v247
L_tb_2:
v_lshrrev_b32 v247, 5, v224
v_lshlrev_b32 v247, 15, v247
v_and_b32 v248, 31, v224
v_lshl_add_u32 v239, v248, 4, v247
s_waitcnt vmcnt(13)
ds_read_b128 v[0:3], v180 offset:0
ds_read_b128 v[4:7], v181 offset:0
ds_read_b128 v[8:11], v182 offset:0
ds_read_b128 v[12:15], v183 offset:0
s_add_u32 s0, s22, 3
s_cmp_ge_u32 s0, 10
s_cselect_b32 s1, 10, 0
s_sub_u32 s0, s0, s1
s_lshl_b32 s0, s0, 7
s_add_u32 m0, s11, 12288
s_add_u32 s0, s0, s10
buffer_load_dwordx4 v176, s[24:27], s0 offen lds
buffer_load_dwordx4 v177, s[24:27], s0 offen offset:1024 lds
buffer_load_dwordx4 v178, s[24:27], s0 offen offset:2048 lds
buffer_load_dwordx4 v179, s[24:27], s0 offen offset:3072 lds
s_waitcnt vmcnt(13) lgkmcnt(0)
ds_read_b128 v[16:19], v180 offset:4096
ds_read_b128 v[20:23], v181 offset:4096
ds_read_b128 v[24:27], v182 offset:4096
ds_read_b128 v[28:31], v183 offset:4096
s_add_u32 s0, s22, 4
s_cmp_ge_u32 s0, 10
s_cselect_b32 s1, 10, 0
s_sub_u32 s0, s0, s1
s_lshl_b32 s0, s0, 7
s_add_u32 m0, s11, 16384
s_add_u32 s0, s0, s10
buffer_load_dwordx4 v176, s[24:27], s0 offen lds
v_dot2_f32_bf16 v184, v0, s4, v184
v_dot2_f32_bf16 v188, v0, v0, v188
v_dot2_f32_bf16 v185, v1, s4, v185
v_dot2_f32_bf16 v189, v1, v1, v189
v_dot2_f32_bf16 v186, v2, s4, v186
v_dot2_f32_bf16 v190, v2, v2, v190
v_dot2_f32_bf16 v187, v3, s4, v187
v_dot2_f32_bf16 v191, v3, v3, v191
v_dot2_f32_bf16 v184, v4, s4, v184
v_dot2_f32_bf16 v188, v4, v4, v188
v_dot2_f32_bf16 v185, v5, s4, v185
v_dot2_f32_bf16 v189, v5, v5, v189
buffer_load_dwordx4 v177, s[24:27], s0 offen offset:1024 lds
v_dot2_f32_bf16 v186, v6, s4, v186
v_dot2_f32_bf16 v190, v6, v6, v190
v_dot2_f32_bf16 v187, v7, s4, v187
v_dot2_f32_bf16 v191, v7, v7, v191
v_dot2_f32_bf16 v184, v8, s4, v184
v_dot2_f32_bf16 v188, v8, v8, v188
v_dot2_f32_bf16 v185, v9, s4, v185
v_dot2_f32_bf16 v189, v9, v9, v189
v_dot2_f32_bf16 v186, v10, s4, v186
v_dot2_f32_bf16 v190, v10, v10, v190
v_dot2_f32_bf16 v187, v11, s4, v187
v_dot2_f32_bf16 v191, v11, v11, v191
buffer_load_dwordx4 v178, s[24:27], s0 offen offset:2048 lds
v_dot2_f32_bf16 v184, v12, s4, v184
v_dot2_f32_bf16 v188, v12, v12, v188
v_dot2_f32_bf16 v185, v13, s4, v185
v_dot2_f32_bf16 v189, v13, v13, v189
v_dot2_f32_bf16 v186, v14, s4, v186
v_dot2_f32_bf16 v190, v14, v14, v190
v_dot2_f32_bf16 v187, v15, s4, v187
v_dot2_f32_bf16 v191, v15, v15, v191
buffer_load_dwordx4 v179, s[24:27], s0 offen offset:3072 lds
s_waitcnt vmcnt(13) lgkmcnt(0)
ds_read_b128 v[32:35], v180 offset:8192
ds_read_b128 v[36:39], v181 offset:8192
ds_read_b128 v[40:43], v182 offset:8192
ds_read_b128 v[44:47], v183 offset:8192
s_add_u32 s0, s22, 5
s_cmp_ge_u32 s0, 10
s_cselect_b32 s1, 10, 0
s_sub_u32 s0, s0, s1
s_lshl_b32 s0, s0, 7
s_add_u32 m0, s11, 20480
s_add_u32 s0, s0, s10
buffer_load_dwordx4 v176, s[24:27], s0 offen lds
v_dot2_f32_bf16 v184, v16, s4, v184
v_dot2_f32_bf16 v188, v16, v16, v188
v_dot2_f32_bf16 v185, v17, s4, v185
v_dot2_f32_bf16 v189, v17, v17, v189
v_dot2_f32_bf16 v186, v18, s4, v186
v_dot2_f32_bf16 v190, v18, v18, v190
v_dot2_f32_bf16 v187, v19, s4, v187
v_dot2_f32_bf16 v191, v19, v19, v191
v_dot2_f32_bf16 v184, v20, s4, v184
v_dot2_f32_bf16 v188, v20, v20, v188
v_dot2_f32_bf16 v185, v21, s4, v185
v_dot2_f32_bf16 v189, v21, v21, v189
buffer_load_dwordx4 v177, s[24:27], s0 offen offset:1024 lds
v_dot2_f32_bf16 v186, v22, s4, v186
v_dot2_f32_bf16 v190, v22, v22, v190
v_dot2_f32_bf16 v187, v23, s4, v187
v_dot2_f32_bf16 v191, v23, v23, v191
v_dot2_f32_bf16 v184, v24, s4, v184
v_dot2_f32_bf16 v188, v24, v24, v188
v_dot2_f32_bf16 v185, v25, s4, v185
v_dot2_f32_bf16 v189, v25, v25, v189
v_dot2_f32_bf16 v186, v26, s4, v186
v_dot2_f32_bf16 v190, v26, v26, v190
v_dot2_f32_bf16 v187, v27, s4, v187
v_dot2_f32_bf16 v191, v27, v27, v191
buffer_load_dwordx4 v178, s[24:27], s0 offen offset:2048 lds
v_dot2_f32_bf16 v184, v28, s4, v184
v_dot2_f32_bf16 v188, v28, v28, v188
v_dot2_f32_bf16 v185, v29, s4, v185
v_dot2_f32_bf16 v189, v29, v29, v189
v_dot2_f32_bf16 v186, v30, s4, v186
v_dot2_f32_bf16 v190, v30, v30, v190
v_dot2_f32_bf16 v187, v31, s4, v187
v_dot2_f32_bf16 v191, v31, v31, v191
buffer_load_dwordx4 v179, s[24:27], s0 offen offset:3072 lds
s_waitcnt vmcnt(8) lgkmcnt(0)
ds_read_b128 v[48:51], v180 offset:12288
ds_read_b128 v[52:55], v181 offset:12288
ds_read_b128 v[56:59], v182 offset:12288
ds_read_b128 v[60:63], v183 offset:12288
s_add_u32 s0, s22, 6
s_cmp_ge_u32 s0, 10
s_cselect_b32 s1, 10, 0
s_sub_u32 s0, s0, s1
s_lshl_b32 s0, s0, 7
s_add_u32 m0, s11, 24576
s_add_u32 s0, s0, s10
buffer_load_dwordx4 v176, s[24:27], s0 offen lds
v_dot2_f32_bf16 v184, v32, s4, v184
v_dot2_f32_bf16 v188, v32, v32, v188
v_dot2_f32_bf16 v185, v33, s4, v185
v_dot2_f32_bf16 v189, v33, v33, v189
v_dot2_f32_bf16 v186, v34, s4, v186
v_dot2_f32_bf16 v190, v34, v34, v190
v_dot2_f32_bf16 v187, v35, s4, v187
v_dot2_f32_bf16 v191, v35, v35, v191
v_dot2_f32_bf16 v184, v36, s4, v184
v_dot2_f32_bf16 v188, v36, v36, v188
v_dot2_f32_bf16 v185, v37, s4, v185
v_dot2_f32_bf16 v189, v37, v37, v189
buffer_load_dwordx4 v177, s[24:27], s0 offen offset:1024 lds
v_dot2_f32_bf16 v186, v38, s4, v186
v_dot2_f32_bf16 v190, v38, v38, v190
v_dot2_f32_bf16 v187, v39, s4, v187
v_dot2_f32_bf16 v191, v39, v39, v191
v_dot2_f32_bf16 v184, v40, s4, v184
v_dot2_f32_bf16 v188, v40, v40, v188
v_dot2_f32_bf16 v185, v41, s4, v185
v_dot2_f32_bf16 v189, v41, v41, v189
v_dot2_f32_bf16 v186, v42, s4, v186
v_dot2_f32_bf16 v190, v42, v42, v190
v_dot2_f32_bf16 v187, v43, s4, v187
v_dot2_f32_bf16 v191, v43, v43, v191
buffer_load_dwordx4 v178, s[24:27], s0 offen offset:2048 lds
v_dot2_f32_bf16 v184, v44, s4, v184
v_dot2_f32_bf16 v188, v44, v44, v188
v_dot2_f32_bf16 v185, v45, s4, v185
v_dot2_f32_bf16 v189, v45, v45, v189
v_dot2_f32_bf16 v186, v46, s4, v186
v_dot2_f32_bf16 v190, v46, v46, v190
v_dot2_f32_bf16 v187, v47, s4, v187
v_dot2_f32_bf16 v191, v47, v47, v191
buffer_load_dwordx4 v179, s[24:27], s0 offen offset:3072 lds
s_waitcnt vmcnt(8) lgkmcnt(0)
ds_read_b128 v[64:67], v180 offset:16384
ds_read_b128 v[68:71], v181 offset:16384
ds_read_b128 v[72:75], v182 offset:16384
ds_read_b128 v[76:79], v183 offset:16384
s_add_u32 s0, s22, 7
s_cmp_ge_u32 s0, 10
s_cselect_b32 s1, 10, 0
s_sub_u32 s0, s0, s1
s_lshl_b32 s0, s0, 7
s_add_u32 m0, s11, 0
s_add_u32 s0, s0, s10
buffer_load_dwordx4 v176, s[24:27], s0 offen lds
v_dot2_f32_bf16 v184, v48, s4, v184
v_dot2_f32_bf16 v188, v48, v48, v188
v_dot2_f32_bf16 v185, v49, s4, v185
v_dot2_f32_bf16 v189, v49, v49, v189
v_dot2_f32_bf16 v186, v50, s4, v186
v_dot2_f32_bf16 v190, v50, v50, v190
v_dot2_f32_bf16 v187, v51, s4, v187
v_dot2_f32_bf16 v191, v51, v51, v191
v_dot2_f32_bf16 v184, v52, s4, v184
v_dot2_f32_bf16 v188, v52, v52, v188
v_dot2_f32_bf16 v185, v53, s4, v185
v_dot2_f32_bf16 v189, v53, v53, v189
buffer_load_dwordx4 v177, s[24:27], s0 offen offset:1024 lds
v_dot2_f32_bf16 v186, v54, s4, v186
v_dot2_f32_bf16 v190, v54, v54, v190
v_dot2_f32_bf16 v187, v55, s4, v187
v_dot2_f32_bf16 v191, v55, v55, v191
v_dot2_f32_bf16 v184, v56, s4, v184
v_dot2_f32_bf16 v188, v56, v56, v188
v_dot2_f32_bf16 v185, v57, s4, v185
v_dot2_f32_bf16 v189, v57, v57, v189
v_dot2_f32_bf16 v186, v58, s4, v186
v_dot2_f32_bf16 v190, v58, v58, v190
v_dot2_f32_bf16 v187, v59, s4, v187
v_dot2_f32_bf16 v191, v59, v59, v191
buffer_load_dwordx4 v178, s[24:27], s0 offen offset:2048 lds
v_dot2_f32_bf16 v184, v60, s4, v184
v_dot2_f32_bf16 v188, v60, v60, v188
v_dot2_f32_bf16 v185, v61, s4, v185
v_dot2_f32_bf16 v189, v61, v61, v189
v_dot2_f32_bf16 v186, v62, s4, v186
v_dot2_f32_bf16 v190, v62, v62, v190
v_dot2_f32_bf16 v187, v63, s4, v187
v_dot2_f32_bf16 v191, v63, v63, v191
buffer_load_dwordx4 v179, s[24:27], s0 offen offset:3072 lds
s_waitcnt vmcnt(8) lgkmcnt(0)
ds_read_b128 v[80:83], v180 offset:20480
ds_read_b128 v[84:87], v181 offset:20480
ds_read_b128 v[88:91], v182 offset:20480
ds_read_b128 v[92:95], v183 offset:20480
s_add_u32 s0, s22, 8
s_cmp_ge_u32 s0, 10
s_cselect_b32 s1, 10, 0
s_sub_u32 s0, s0, s1
s_lshl_b32 s0, s0, 7
s_add_u32 m0, s11, 4096
s_add_u32 s0, s0, s10
buffer_load_dwordx4 v176, s[24:27], s0 offen lds
v_dot2_f32_bf16 v184, v64, s4, v184
v_dot2_f32_bf16 v188, v64, v64, v188
v_dot2_f32_bf16 v185, v65, s4, v185
v_dot2_f32_bf16 v189, v65, v65, v189
v_dot2_f32_bf16 v186, v66, s4, v186
v_dot2_f32_bf16 v190, v66, v66, v190
v_dot2_f32_bf16 v187, v67, s4, v187
v_dot2_f32_bf16 v191, v67, v67, v191
v_dot2_f32_bf16 v184, v68, s4, v184
v_dot2_f32_bf16 v188, v68, v68, v188
v_dot2_f32_bf16 v185, v69, s4, v185
v_dot2_f32_bf16 v189, v69, v69, v189
buffer_load_dwordx4 v177, s[24:27], s0 offen offset:1024 lds
v_dot2_f32_bf16 v186, v70, s4, v186
v_dot2_f32_bf16 v190, v70, v70, v190
v_dot2_f32_bf16 v187, v71, s4, v187
v_dot2_f32_bf16 v191, v71, v71, v191
v_dot2_f32_bf16 v184, v72, s4, v184
v_dot2_f32_bf16 v188, v72, v72, v188
v_dot2_f32_bf16 v185, v73, s4, v185
v_dot2_f32_bf16 v189, v73, v73, v189
v_dot2_f32_bf16 v186, v74, s4, v186
v_dot2_f32_bf16 v190, v74, v74, v190
v_dot2_f32_bf16 v187, v75, s4, v187
v_dot2_f32_bf16 v191, v75, v75, v191
buffer_load_dwordx4 v178, s[24:27], s0 offen offset:2048 lds
v_dot2_f32_bf16 v184, v76, s4, v184
v_dot2_f32_bf16 v188, v76, v76, v188
v_dot2_f32_bf16 v185, v77, s4, v185
v_dot2_f32_bf16 v189, v77, v77, v189
v_dot2_f32_bf16 v186, v78, s4, v186
v_dot2_f32_bf16 v190, v78, v78, v190
v_dot2_f32_bf16 v187, v79, s4, v187
v_dot2_f32_bf16 v191, v79, v79, v191
buffer_load_dwordx4 v179, s[24:27], s0 offen offset:3072 lds
s_waitcnt vmcnt(8) lgkmcnt(0)
ds_read_b128 v[96:99], v180 offset:24576
ds_read_b128 v[100:103], v181 offset:24576
ds_read_b128 v[104:107], v182 offset:24576
ds_read_b128 v[108:111], v183 offset:24576
s_add_u32 s0, s22, 9
s_cmp_ge_u32 s0, 10
s_cselect_b32 s1, 10, 0
s_sub_u32 s0, s0, s1
s_lshl_b32 s0, s0, 7
s_add_u32 m0, s11, 8192
s_add_u32 s0, s0, s10
buffer_load_dwordx4 v176, s[24:27], s0 offen lds
v_dot2_f32_bf16 v184, v80, s4, v184
v_dot2_f32_bf16 v188, v80, v80, v188
v_dot2_f32_bf16 v185, v81, s4, v185
v_dot2_f32_bf16 v189, v81, v81, v189
v_dot2_f32_bf16 v186, v82, s4, v186
v_dot2_f32_bf16 v190, v82, v82, v190
v_dot2_f32_bf16 v187, v83, s4, v187
v_dot2_f32_bf16 v191, v83, v83, v191
v_dot2_f32_bf16 v184, v84, s4, v184
v_dot2_f32_bf16 v188, v84, v84, v188
v_dot2_f32_bf16 v185, v85, s4, v185
v_dot2_f32_bf16 v189, v85, v85, v189
buffer_load_dwordx4 v177, s[24:27], s0 offen offset:1024 lds
v_dot2_f32_bf16 v186, v86, s4, v186
v_dot2_f32_bf16 v190, v86, v86, v190
v_dot2_f32_bf16 v187, v87, s4, v187
v_dot2_f32_bf16 v191, v87, v87, v191
v_dot2_f32_bf16 v184, v88, s4, v184
v_dot2_f32_bf16 v188, v88, v88, v188
v_dot2_f32_bf16 v185, v89, s4, v185
v_dot2_f32_bf16 v189, v89, v89, v189
v_dot2_f32_bf16 v186, v90, s4, v186
v_dot2_f32_bf16 v190, v90, v90, v190
v_dot2_f32_bf16 v187, v91, s4, v187
v_dot2_f32_bf16 v191, v91, v91, v191
buffer_load_dwordx4 v178, s[24:27], s0 offen offset:2048 lds
v_dot2_f32_bf16 v184, v92, s4, v184
v_dot2_f32_bf16 v188, v92, v92, v188
v_dot2_f32_bf16 v185, v93, s4, v185
v_dot2_f32_bf16 v189, v93, v93, v189
v_dot2_f32_bf16 v186, v94, s4, v186
v_dot2_f32_bf16 v190, v94, v94, v190
v_dot2_f32_bf16 v187, v95, s4, v187
v_dot2_f32_bf16 v191, v95, v95, v191
buffer_load_dwordx4 v179, s[24:27], s0 offen offset:3072 lds
s_waitcnt vmcnt(8) lgkmcnt(0)
ds_read_b128 v[112:115], v180 offset:0
ds_read_b128 v[116:119], v181 offset:0
ds_read_b128 v[120:123], v182 offset:0
ds_read_b128 v[124:127], v183 offset:0
s_add_u32 m0, s60, 16384
s_nop 0
buffer_load_dwordx4 v225, s[28:31], s55 offen lds
v_dot2_f32_bf16 v184, v96, s4, v184
v_dot2_f32_bf16 v188, v96, v96, v188
v_dot2_f32_bf16 v185, v97, s4, v185
v_dot2_f32_bf16 v189, v97, v97, v189
v_dot2_f32_bf16 v186, v98, s4, v186
v_dot2_f32_bf16 v190, v98, v98, v190
v_dot2_f32_bf16 v187, v99, s4, v187
v_dot2_f32_bf16 v191, v99, v99, v191
v_dot2_f32_bf16 v184, v100, s4, v184
v_dot2_f32_bf16 v188, v100, v100, v188
v_dot2_f32_bf16 v185, v101, s4, v185
v_dot2_f32_bf16 v189, v101, v101, v189
s_add_u32 s55, s55, s58
buffer_load_dwordx4 v226, s[32:35], s56 offen offset:1024 lds
v_dot2_f32_bf16 v186, v102, s4, v186
v_dot2_f32_bf16 v190, v102, v102, v190
v_dot2_f32_bf16 v187, v103, s4, v187
v_dot2_f32_bf16 v191, v103, v103, v191
v_dot2_f32_bf16 v184, v104, s4, v184
v_dot2_f32_bf16 v188, v104, v104, v188
v_dot2_f32_bf16 v185, v105, s4, v185
v_dot2_f32_bf16 v189, v105, v105, v189
v_dot2_f32_bf16 v186, v106, s4, v186
v_dot2_f32_bf16 v190, v106, v106, v190
v_dot2_f32_bf16 v187, v107, s4, v187
v_dot2_f32_bf16 v191, v107, v107, v191
s_add_u32 s56, s56, 59392
buffer_load_dwordx4 v225, s[28:31], s55 offen offset:2048 lds
v_dot2_f32_bf16 v184, v108, s4, v184
v_dot2_f32_bf16 v188, v108, v108, v188
v_dot2_f32_bf16 v185, v109, s4, v185
v_dot2_f32_bf16 v189, v109, v109, v189
v_dot2_f32_bf16 v186, v110, s4, v186
v_dot2_f32_bf16 v190, v110, v110, v190
v_dot2_f32_bf16 v187, v111, s4, v187
v_dot2_f32_bf16 v191, v111, v111, v191
s_add_u32 s55, s55, s59
buffer_load_dwordx4 v226, s[32:35], s56 offen offset:3072 lds
s_add_u32 s56, s56, 63488
s_cmp_eq_u32 s23, 1
s_cselect_b32 s21, s20, 0
s_cselect_b32 s1, 2457600, 0
s_sub_u32 s55, s55, s21
s_sub_u32 s56, s56, s1
s_waitcnt vmcnt(8) lgkmcnt(0)
ds_read_b128 v[128:131], v180 offset:4096
ds_read_b128 v[132:135], v181 offset:4096
ds_read_b128 v[136:139], v182 offset:4096
ds_read_b128 v[140:143], v183 offset:4096
s_add_u32 m0, s60, 32768
s_nop 0
buffer_load_dwordx4 v225, s[28:31], s55 offen lds
v_dot2_f32_bf16 v184, v112, s4, v184
v_dot2_f32_bf16 v188, v112, v112, v188
v_dot2_f32_bf16 v185, v113, s4, v185
v_dot2_f32_bf16 v189, v113, v113, v189
v_dot2_f32_bf16 v186, v114, s4, v186
v_dot2_f32_bf16 v190, v114, v114, v190
v_dot2_f32_bf16 v187, v115, s4, v187
v_dot2_f32_bf16 v191, v115, v115, v191
v_dot2_f32_bf16 v184, v116, s4, v184
v_dot2_f32_bf16 v188, v116, v116, v188
v_dot2_f32_bf16 v185, v117, s4, v185
v_dot2_f32_bf16 v189, v117, v117, v189
s_add_u32 s55, s55, s58
buffer_load_dwordx4 v226, s[32:35], s56 offen offset:1024 lds
v_dot2_f32_bf16 v186, v118, s4, v186
v_dot2_f32_bf16 v190, v118, v118, v190
v_dot2_f32_bf16 v187, v119, s4, v187
v_dot2_f32_bf16 v191, v119, v119, v191
v_dot2_f32_bf16 v184, v120, s4, v184
v_dot2_f32_bf16 v188, v120, v120, v188
v_dot2_f32_bf16 v185, v121, s4, v185
v_dot2_f32_bf16 v189, v121, v121, v189
v_dot2_f32_bf16 v186, v122, s4, v186
v_dot2_f32_bf16 v190, v122, v122, v190
v_dot2_f32_bf16 v187, v123, s4, v187
v_dot2_f32_bf16 v191, v123, v123, v191
s_add_u32 s56, s56, 59392
buffer_load_dwordx4 v225, s[28:31], s55 offen offset:2048 lds
v_dot2_f32_bf16 v184, v124, s4, v184
v_dot2_f32_bf16 v188, v124, v124, v188
v_dot2_f32_bf16 v185, v125, s4, v185
v_dot2_f32_bf16 v189, v125, v125, v189
v_dot2_f32_bf16 v186, v126, s4, v186
v_dot2_f32_bf16 v190, v126, v126, v190
v_dot2_f32_bf16 v187, v127, s4, v187
v_dot2_f32_bf16 v191, v127, v127, v191
s_add_u32 s55, s55, s59
buffer_load_dwordx4 v226, s[32:35], s56 offen offset:3072 lds
s_add_u32 s56, s56, 63488
s_waitcnt vmcnt(8) lgkmcnt(0)
ds_read_b128 v[144:147], v180 offset:8192
ds_read_b128 v[148:151], v181 offset:8192
ds_read_b128 v[152:155], v182 offset:8192
ds_read_b128 v[156:159], v183 offset:8192
s_mul_i32 s0, s3, 28672
s_add_u32 m0, s0, 65536
s_nop 0
buffer_load_dwordx4 v192, s[44:47], 0 offen lds
v_dot2_f32_bf16 v184, v128, s4, v184
v_dot2_f32_bf16 v188, v128, v128, v188
v_dot2_f32_bf16 v185, v129, s4, v185
v_dot2_f32_bf16 v189, v129, v129, v189
v_dot2_f32_bf16 v186, v130, s4, v186
v_dot2_f32_bf16 v190, v130, v130, v190
v_dot2_f32_bf16 v187, v131, s4, v187
v_dot2_f32_bf16 v191, v131, v131, v191
v_dot2_f32_bf16 v184, v132, s4, v184
v_dot2_f32_bf16 v188, v132, v132, v188
v_dot2_f32_bf16 v185, v133, s4, v185
v_dot2_f32_bf16 v189, v133, v133, v189
buffer_load_dwordx4 v193, s[44:47], 0 offen offset:1024 lds
v_dot2_f32_bf16 v186, v134, s4, v186
v_dot2_f32_bf16 v190, v134, v134, v190
v_dot2_f32_bf16 v187, v135, s4, v187
v_dot2_f32_bf16 v191, v135, v135, v191
v_dot2_f32_bf16 v184, v136, s4, v184
v_dot2_f32_bf16 v188, v136, v136, v188
v_dot2_f32_bf16 v185, v137, s4, v185
v_dot2_f32_bf16 v189, v137, v137, v189
v_dot2_f32_bf16 v186, v138, s4, v186
v_dot2_f32_bf16 v190, v138, v138, v190
v_dot2_f32_bf16 v187, v139, s4, v187
v_dot2_f32_bf16 v191, v139, v139, v191
buffer_load_dwordx4 v194, s[44:47], 0 offen offset:2048 lds
v_dot2_f32_bf16 v184, v140, s4, v184
v_dot2_f32_bf16 v188, v140, v140, v188
v_dot2_f32_bf16 v185, v141, s4, v185
v_dot2_f32_bf16 v189, v141, v141, v189
v_dot2_f32_bf16 v186, v142, s4, v186
v_dot2_f32_bf16 v190, v142, v142, v190
v_dot2_f32_bf16 v187, v143, s4, v187
v_dot2_f32_bf16 v191, v143, v143, v191
buffer_load_dwordx4 v195, s[44:47], 0 offen offset:3072 lds
s_waitcnt lgkmcnt(0)
v_dot2_f32_bf16 v184, v144, s4, v184
v_dot2_f32_bf16 v188, v144, v144, v188
v_dot2_f32_bf16 v185, v145, s4, v185
v_dot2_f32_bf16 v189, v145, v145, v189
v_dot2_f32_bf16 v186, v146, s4, v186
v_dot2_f32_bf16 v190, v146, v146, v190
v_dot2_f32_bf16 v187, v147, s4, v187
v_dot2_f32_bf16 v191, v147, v147, v191
v_dot2_f32_bf16 v184, v148, s4, v184
v_dot2_f32_bf16 v188, v148, v148, v188
v_dot2_f32_bf16 v185, v149, s4, v185
v_dot2_f32_bf16 v189, v149, v149, v189
v_dot2_f32_bf16 v186, v150, s4, v186
v_dot2_f32_bf16 v190, v150, v150, v190
v_dot2_f32_bf16 v187, v151, s4, v187
v_dot2_f32_bf16 v191, v151, v151, v191
v_dot2_f32_bf16 v184, v152, s4, v184
v_dot2_f32_bf16 v188, v152, v152, v188
v_dot2_f32_bf16 v185, v153, s4, v185
v_dot2_f32_bf16 v189, v153, v153, v189
v_dot2_f32_bf16 v186, v154, s4, v186
v_dot2_f32_bf16 v190, v154, v154, v190
v_dot2_f32_bf16 v187, v155, s4, v187
v_dot2_f32_bf16 v191, v155, v155, v191
v_dot2_f32_bf16 v184, v156, s4, v184
v_dot2_f32_bf16 v188, v156, v156, v188
v_dot2_f32_bf16 v185, v157, s4, v185
v_dot2_f32_bf16 v189, v157, v157, v189
v_dot2_f32_bf16 v186, v158, s4, v186
v_dot2_f32_bf16 v190, v158, v158, v190
v_dot2_f32_bf16 v187, v159, s4, v187
v_dot2_f32_bf16 v191, v159, v159, v191
v_add_f32 v184, v184, v185
s_nop 0
v_add_f32 v186, v186, v187
v_add_f32 v188, v188, v189
v_add_f32 v190, v190, v191
v_add_f32 v184, v184, v186
v_add_f32 v188, v188, v190
v_mov_b32 v240, v184
v_mov_b32 v241, v188
s_nop 1
v_permlane32_swap_b32 v240, v184
v_permlane32_swap_b32 v241, v188
v_add_f32 v184, v184, v240
v_add_f32 v188, v188, v241
v_mul_f32 v240, 0x3acccccd, v184
v_mul_f32 v241, 0x3acccccd, v188
v_sub_f32 v234, 0, v240
v_fma_f32 v241, -v240, v240, v241
v_max_f32 v241, 0, v241
v_add_f32 v238, 0x3727c5ac, v241
v_rsq_f32 v235, v238
s_nop 0
v_mul_f32 v236, 0xc0135761, v235
v_mul_f32 v240, v235, v235
v_mul_f32 v240, 0x3d372713, v240
v_mul_f32 v237, v236, v240
s_mov_b32 s67, 0xffff0000
s_mov_b32 s0, 0x00003f80
s_mov_b32 s1, 0x3f800000
v_dot2_f32_bf16 v240, v0, s0, v234
v_dot2_f32_bf16 v241, v0, s1, v234
v_dot2_f32_bf16 v242, v1, s0, v234
v_dot2_f32_bf16 v243, v1, s1, v234
v_dot2_f32_bf16 v244, v2, s0, v234
v_dot2_f32_bf16 v245, v2, s1, v234
v_dot2_f32_bf16 v246, v3, s0, v234
v_dot2_f32_bf16 v247, v3, s1, v234
v_cvt_pk_bf16_f32 v0, v240, v241
v_cvt_pk_bf16_f32 v1, v242, v243
v_cvt_pk_bf16_f32 v2, v244, v245
v_cvt_pk_bf16_f32 v3, v246, v247
v_dot2_f32_bf16 v240, v4, s0, v234
v_dot2_f32_bf16 v241, v4, s1, v234
v_dot2_f32_bf16 v242, v5, s0, v234
v_dot2_f32_bf16 v243, v5, s1, v234
v_dot2_f32_bf16 v244, v6, s0, v234
v_dot2_f32_bf16 v245, v6, s1, v234
v_dot2_f32_bf16 v246, v7, s0, v234
v_dot2_f32_bf16 v247, v7, s1, v234
v_cvt_pk_bf16_f32 v4, v240, v241
v_cvt_pk_bf16_f32 v5, v242, v243
v_cvt_pk_bf16_f32 v6, v244, v245
v_cvt_pk_bf16_f32 v7, v246, v247
v_dot2_f32_bf16 v240, v8, s0, v234
v_dot2_f32_bf16 v241, v8, s1, v234
v_dot2_f32_bf16 v242, v9, s0, v234
v_dot2_f32_bf16 v243, v9, s1, v234
v_dot2_f32_bf16 v244, v10, s0, v234
v_dot2_f32_bf16 v245, v10, s1, v234
v_dot2_f32_bf16 v246, v11, s0, v234
v_dot2_f32_bf16 v247, v11, s1, v234
v_cvt_pk_bf16_f32 v8, v240, v241
v_cvt_pk_bf16_f32 v9, v242, v243
v_cvt_pk_bf16_f32 v10, v244, v245
v_cvt_pk_bf16_f32 v11, v246, v247
v_dot2_f32_bf16 v240, v12, s0, v234
v_dot2_f32_bf16 v241, v12, s1, v234
v_dot2_f32_bf16 v242, v13, s0, v234
v_dot2_f32_bf16 v243, v13, s1, v234
v_dot2_f32_bf16 v244, v14, s0, v234
v_dot2_f32_bf16 v245, v14, s1, v234
v_dot2_f32_bf16 v246, v15, s0, v234
v_dot2_f32_bf16 v247, v15, s1, v234
v_cvt_pk_bf16_f32 v12, v240, v241
v_cvt_pk_bf16_f32 v13, v242, v243
v_cvt_pk_bf16_f32 v14, v244, v245
v_cvt_pk_bf16_f32 v15, v246, v247
v_dot2_f32_bf16 v240, v16, s0, v234
v_dot2_f32_bf16 v241, v16, s1, v234
v_dot2_f32_bf16 v242, v17, s0, v234
v_dot2_f32_bf16 v243, v17, s1, v234
v_dot2_f32_bf16 v244, v18, s0, v234
v_dot2_f32_bf16 v245, v18, s1, v234
v_dot2_f32_bf16 v246, v19, s0, v234
v_dot2_f32_bf16 v247, v19, s1, v234
v_cvt_pk_bf16_f32 v16, v240, v241
v_cvt_pk_bf16_f32 v17, v242, v243
v_cvt_pk_bf16_f32 v18, v244, v245
v_cvt_pk_bf16_f32 v19, v246, v247
v_dot2_f32_bf16 v240, v20, s0, v234
v_dot2_f32_bf16 v241, v20, s1, v234
v_dot2_f32_bf16 v242, v21, s0, v234
v_dot2_f32_bf16 v243, v21, s1, v234
v_dot2_f32_bf16 v244, v22, s0, v234
v_dot2_f32_bf16 v245, v22, s1, v234
v_dot2_f32_bf16 v246, v23, s0, v234
v_dot2_f32_bf16 v247, v23, s1, v234
v_cvt_pk_bf16_f32 v20, v240, v241
v_cvt_pk_bf16_f32 v21, v242, v243
v_cvt_pk_bf16_f32 v22, v244, v245
v_cvt_pk_bf16_f32 v23, v246, v247
v_dot2_f32_bf16 v240, v24, s0, v234
v_dot2_f32_bf16 v241, v24, s1, v234
v_dot2_f32_bf16 v242, v25, s0, v234
v_dot2_f32_bf16 v243, v25, s1, v234
v_dot2_f32_bf16 v244, v26, s0, v234
v_dot2_f32_bf16 v245, v26, s1, v234
v_dot2_f32_bf16 v246, v27, s0, v234
v_dot2_f32_bf16 v247, v27, s1, v234
v_cvt_pk_bf16_f32 v24, v240, v241
v_cvt_pk_bf16_f32 v25, v242, v243
v_cvt_pk_bf16_f32 v26, v244, v245
v_cvt_pk_bf16_f32 v27, v246, v247
v_dot2_f32_bf16 v240, v28, s0, v234
v_dot2_f32_bf16 v241, v28, s1, v234
v_dot2_f32_bf16 v242, v29, s0, v234
v_dot2_f32_bf16 v243, v29, s1, v234
v_dot2_f32_bf16 v244, v30, s0, v234
v_dot2_f32_bf16 v245, v30, s1, v234
v_dot2_f32_bf16 v246, v31, s0, v234
v_dot2_f32_bf16 v247, v31, s1, v234
v_cvt_pk_bf16_f32 v28, v240, v241
v_cvt_pk_bf16_f32 v29, v242, v243
v_cvt_pk_bf16_f32 v30, v244, v245
v_cvt_pk_bf16_f32 v31, v246, v247
v_dot2_f32_bf16 v240, v32, s0, v234
v_dot2_f32_bf16 v241, v32, s1, v234
v_dot2_f32_bf16 v242, v33, s0, v234
v_dot2_f32_bf16 v243, v33, s1, v234
v_dot2_f32_bf16 v244, v34, s0, v234
v_dot2_f32_bf16 v245, v34, s1, v234
v_dot2_f32_bf16 v246, v35, s0, v234
v_dot2_f32_bf16 v247, v35, s1, v234
v_cvt_pk_bf16_f32 v32, v240, v241
v_cvt_pk_bf16_f32 v33, v242, v243
v_cvt_pk_bf16_f32 v34, v244, v245
v_cvt_pk_bf16_f32 v35, v246, v247
v_dot2_f32_bf16 v240, v36, s0, v234
v_dot2_f32_bf16 v241, v36, s1, v234
v_dot2_f32_bf16 v242, v37, s0, v234
v_dot2_f32_bf16 v243, v37, s1, v234
v_dot2_f32_bf16 v244, v38, s0, v234
v_dot2_f32_bf16 v245, v38, s1, v234
v_dot2_f32_bf16 v246, v39, s0, v234
v_dot2_f32_bf16 v247, v39, s1, v234
v_cvt_pk_bf16_f32 v36, v240, v241
v_cvt_pk_bf16_f32 v37, v242, v243
v_cvt_pk_bf16_f32 v38, v244, v245
v_cvt_pk_bf16_f32 v39, v246, v247
v_dot2_f32_bf16 v240, v40, s0, v234
v_dot2_f32_bf16 v241, v40, s1, v234
v_dot2_f32_bf16 v242, v41, s0, v234
v_dot2_f32_bf16 v243, v41, s1, v234
v_dot2_f32_bf16 v244, v42, s0, v234
v_dot2_f32_bf16 v245, v42, s1, v234
v_dot2_f32_bf16 v246, v43, s0, v234
v_dot2_f32_bf16 v247, v43, s1, v234
v_cvt_pk_bf16_f32 v40, v240, v241
v_cvt_pk_bf16_f32 v41, v242, v243
v_cvt_pk_bf16_f32 v42, v244, v245
v_cvt_pk_bf16_f32 v43, v246, v247
v_dot2_f32_bf16 v240, v44, s0, v234
v_dot2_f32_bf16 v241, v44, s1, v234
v_dot2_f32_bf16 v242, v45, s0, v234
v_dot2_f32_bf16 v243, v45, s1, v234
v_dot2_f32_bf16 v244, v46, s0, v234
v_dot2_f32_bf16 v245, v46, s1, v234
v_dot2_f32_bf16 v246, v47, s0, v234
v_dot2_f32_bf16 v247, v47, s1, v234
v_cvt_pk_bf16_f32 v44, v240, v241
v_cvt_pk_bf16_f32 v45, v242, v243
v_cvt_pk_bf16_f32 v46, v244, v245
v_cvt_pk_bf16_f32 v47, v246, v247
v_dot2_f32_bf16 v240, v48, s0, v234
v_dot2_f32_bf16 v241, v48, s1, v234
v_dot2_f32_bf16 v242, v49, s0, v234
v_dot2_f32_bf16 v243, v49, s1, v234
v_dot2_f32_bf16 v244, v50, s0, v234
v_dot2_f32_bf16 v245, v50, s1, v234
v_dot2_f32_bf16 v246, v51, s0, v234
v_dot2_f32_bf16 v247, v51, s1, v234
v_cvt_pk_bf16_f32 v48, v240, v241
v_cvt_pk_bf16_f32 v49, v242, v243
v_cvt_pk_bf16_f32 v50, v244, v245
v_cvt_pk_bf16_f32 v51, v246, v247
v_dot2_f32_bf16 v240, v52, s0, v234
v_dot2_f32_bf16 v241, v52, s1, v234
v_dot2_f32_bf16 v242, v53, s0, v234
v_dot2_f32_bf16 v243, v53, s1, v234
v_dot2_f32_bf16 v244, v54, s0, v234
v_dot2_f32_bf16 v245, v54, s1, v234
v_dot2_f32_bf16 v246, v55, s0, v234
v_dot2_f32_bf16 v247, v55, s1, v234
v_cvt_pk_bf16_f32 v52, v240, v241
v_cvt_pk_bf16_f32 v53, v242, v243
v_cvt_pk_bf16_f32 v54, v244, v245
v_cvt_pk_bf16_f32 v55, v246, v247
v_dot2_f32_bf16 v240, v56, s0, v234
v_dot2_f32_bf16 v241, v56, s1, v234
v_dot2_f32_bf16 v242, v57, s0, v234
v_dot2_f32_bf16 v243, v57, s1, v234
v_dot2_f32_bf16 v244, v58, s0, v234
v_dot2_f32_bf16 v245, v58, s1, v234
v_dot2_f32_bf16 v246, v59, s0, v234
v_dot2_f32_bf16 v247, v59, s1, v234
v_cvt_pk_bf16_f32 v56, v240, v241
v_cvt_pk_bf16_f32 v57, v242, v243
v_cvt_pk_bf16_f32 v58, v244, v245
v_cvt_pk_bf16_f32 v59, v246, v247
v_dot2_f32_bf16 v240, v60, s0, v234
v_dot2_f32_bf16 v241, v60, s1, v234
v_dot2_f32_bf16 v242, v61, s0, v234
v_dot2_f32_bf16 v243, v61, s1, v234
v_dot2_f32_bf16 v244, v62, s0, v234
v_dot2_f32_bf16 v245, v62, s1, v234
v_dot2_f32_bf16 v246, v63, s0, v234
v_dot2_f32_bf16 v247, v63, s1, v234
v_cvt_pk_bf16_f32 v60, v240, v241
v_cvt_pk_bf16_f32 v61, v242, v243
v_cvt_pk_bf16_f32 v62, v244, v245
v_cvt_pk_bf16_f32 v63, v246, v247
v_dot2_f32_bf16 v240, v64, s0, v234
v_dot2_f32_bf16 v241, v64, s1, v234
v_dot2_f32_bf16 v242, v65, s0, v234
v_dot2_f32_bf16 v243, v65, s1, v234
v_dot2_f32_bf16 v244, v66, s0, v234
v_dot2_f32_bf16 v245, v66, s1, v234
v_dot2_f32_bf16 v246, v67, s0, v234
v_dot2_f32_bf16 v247, v67, s1, v234
v_cvt_pk_bf16_f32 v64, v240, v241
v_cvt_pk_bf16_f32 v65, v242, v243
v_cvt_pk_bf16_f32 v66, v244, v245
v_cvt_pk_bf16_f32 v67, v246, v247
v_dot2_f32_bf16 v240, v68, s0, v234
v_dot2_f32_bf16 v241, v68, s1, v234
v_dot2_f32_bf16 v242, v69, s0, v234
v_dot2_f32_bf16 v243, v69, s1, v234
v_dot2_f32_bf16 v244, v70, s0, v234
v_dot2_f32_bf16 v245, v70, s1, v234
v_dot2_f32_bf16 v246, v71, s0, v234
v_dot2_f32_bf16 v247, v71, s1, v234
v_cvt_pk_bf16_f32 v68, v240, v241
v_cvt_pk_bf16_f32 v69, v242, v243
v_cvt_pk_bf16_f32 v70, v244, v245
v_cvt_pk_bf16_f32 v71, v246, v247
s_barrier
ds_read_b64_tr_b16 a[112:113], v227 offset:0
ds_read_b64_tr_b16 a[114:115], v227 offset:512
ds_read_b64_tr_b16 a[116:117], v228 offset:0
ds_read_b64_tr_b16 a[118:119], v228 offset:512
ds_read_b64_tr_b16 a[120:121], v229 offset:0
ds_read_b64_tr_b16 a[122:123], v229 offset:512
ds_read_b64_tr_b16 a[124:125], v230 offset:0
ds_read_b64_tr_b16 a[126:127], v230 offset:512
ds_read_b64_tr_b16 a[128:129], v231 offset:1024
ds_read_b64_tr_b16 a[130:131], v231 offset:1536
ds_read_b64_tr_b16 a[132:133], v232 offset:1024
ds_read_b64_tr_b16 a[134:135], v232 offset:1536
ds_read_b64_tr_b16 a[136:137], v233 offset:1024
ds_read_b64_tr_b16 a[138:139], v233 offset:1536
s_waitcnt lgkmcnt(6)
v_mfma_f32_32x32x16_bf16 v[160:175], a[112:115], v[0:3], 0
ds_read_b64_tr_b16 a[140:141], v227 offset:2048
ds_read_b64_tr_b16 a[142:143], v227 offset:2560
v_lshlrev_b32 v240, 16, v72
v_and_b32 v241, s67, v72
v_lshlrev_b32 v242, 16, v73
v_mfma_f32_32x32x16_bf16 v[176:191], a[116:119], v[0:3], 0
ds_read_b64_tr_b16 a[144:145], v228 offset:2048
ds_read_b64_tr_b16 a[146:147], v228 offset:2560
v_and_b32 v243, s67, v73
v_add_f32 v240, v240, v234
v_add_f32 v241, v241, v234
v_mfma_f32_32x32x16_bf16 v[192:207], a[120:123], v[0:3], 0
ds_read_b64_tr_b16 a[148:149], v229 offset:2048
ds_read_b64_tr_b16 a[150:151], v229 offset:2560
v_add_f32 v242, v242, v234
v_add_f32 v243, v243, v234
v_cvt_pk_bf16_f32 v72, v240, v241
v_mfma_f32_32x32x16_bf16 v[208:223], a[124:127], v[0:3], 0
ds_read_b64_tr_b16 a[152:153], v230 offset:2048
ds_read_b64_tr_b16 a[154:155], v230 offset:2560
v_cvt_pk_bf16_f32 v73, v242, v243
v_lshlrev_b32 v240, 16, v74
s_waitcnt lgkmcnt(8)
v_mfma_f32_32x32x16_bf16 a[0:15], a[128:131], v[0:3], 0
ds_read_b64_tr_b16 a[156:157], v231 offset:3072
ds_read_b64_tr_b16 a[158:159], v231 offset:3584
v_and_b32 v241, s67, v74
v_lshlrev_b32 v242, 16, v75
v_and_b32 v243, s67, v75
v_mfma_f32_32x32x16_bf16 a[16:31], a[132:135], v[0:3], 0
ds_read_b64_tr_b16 a[160:161], v232 offset:3072
ds_read_b64_tr_b16 a[162:163], v232 offset:3584
v_add_f32 v240, v240, v234
v_add_f32 v241, v241, v234
v_add_f32 v242, v242, v234
v_mfma_f32_32x32x16_bf16 a[32:47], a[136:139], v[0:3], 0
ds_read_b64_tr_b16 a[164:165], v233 offset:3072
ds_read_b64_tr_b16 a[166:167], v233 offset:3584
v_add_f32 v243, v243, v234
v_cvt_pk_bf16_f32 v74, v240, v241
v_cvt_pk_bf16_f32 v75, v242, v243
s_waitcnt lgkmcnt(6)
v_mfma_f32_32x32x16_bf16 v[160:175], a[140:143], v[4:7], v[160:175]
v_lshlrev_b32 v240, 16, v76
v_and_b32 v241, s67, v76
v_lshlrev_b32 v242, 16, v77
v_and_b32 v243, s67, v77
v_add_f32 v240, v240, v234
v_mfma_f32_32x32x16_bf16 v[176:191], a[144:147], v[4:7], v[176:191]
s_waitcnt vmcnt(8)
s_barrier
ds_read_b64_tr_b16 a[112:113], v227 offset:16384
ds_read_b64_tr_b16 a[114:115], v227 offset:16896
ds_read_b64_tr_b16 a[116:117], v228 offset:16384
ds_read_b64_tr_b16 a[118:119], v228 offset:16896
v_mfma_f32_32x32x16_bf16 v[192:207], a[148:151], v[4:7], v[192:207]
ds_read_b64_tr_b16 a[120:121], v229 offset:16384
ds_read_b64_tr_b16 a[122:123], v229 offset:16896
s_add_u32 m0, s60, 49152
s_nop 0
buffer_load_dwordx4 v225, s[28:31], s55 offen lds
s_add_u32 s55, s55, s58
v_mfma_f32_32x32x16_bf16 v[208:223], a[152:155], v[4:7], v[208:223]
ds_read_b64_tr_b16 a[124:125], v230 offset:16384
ds_read_b64_tr_b16 a[126:127], v230 offset:16896
buffer_load_dwordx4 v226, s[32:35], s56 offen offset:1024 lds
s_add_u32 s56, s56, 59392
s_waitcnt lgkmcnt(8)
v_mfma_f32_32x32x16_bf16 a[0:15], a[156:159], v[4:7], a[0:15]
ds_read_b64_tr_b16 a[128:129], v231 offset:17408
ds_read_b64_tr_b16 a[130:131], v231 offset:17920
v_add_f32 v241, v241, v234
v_add_f32 v242, v242, v234
v_add_f32 v243, v243, v234
v_mfma_f32_32x32x16_bf16 a[16:31], a[160:163], v[4:7], a[16:31]
ds_read_b64_tr_b16 a[132:133], v232 offset:17408
ds_read_b64_tr_b16 a[134:135], v232 offset:17920
v_cvt_pk_bf16_f32 v76, v240, v241
v_cvt_pk_bf16_f32 v77, v242, v243
v_lshlrev_b32 v240, 16, v78
v_mfma_f32_32x32x16_bf16 a[32:47], a[164:167], v[4:7], a[32:47]
ds_read_b64_tr_b16 a[136:137], v233 offset:17408
ds_read_b64_tr_b16 a[138:139], v233 offset:17920
v_and_b32 v241, s67, v78
v_lshlrev_b32 v242, 16, v79
v_and_b32 v243, s67, v79
s_waitcnt lgkmcnt(6)
v_mfma_f32_32x32x16_bf16 v[160:175], a[112:115], v[8:11], v[160:175]
ds_read_b64_tr_b16 a[140:141], v227 offset:18432
ds_read_b64_tr_b16 a[142:143], v227 offset:18944
buffer_load_dwordx4 v225, s[28:31], s55 offen offset:2048 lds
s_add_u32 s55, s55, s59
buffer_load_dwordx4 v226, s[32:35], s56 offen offset:3072 lds
v_mfma_f32_32x32x16_bf16 v[176:191], a[116:119], v[8:11], v[176:191]
ds_read_b64_tr_b16 a[144:145], v228 offset:18432
ds_read_b64_tr_b16 a[146:147], v228 offset:18944
s_add_u32 s56, s56, 63488
v_mfma_f32_32x32x16_bf16 v[192:207], a[120:123], v[8:11], v[192:207]
ds_read_b64_tr_b16 a[148:149], v229 offset:18432
ds_read_b64_tr_b16 a[150:151], v229 offset:18944
s_cmp_eq_u32 s23, 2
s_cselect_b32 s21, s20, 0
s_cselect_b32 s1, 2457600, 0
v_mfma_f32_32x32x16_bf16 v[208:223], a[124:127], v[8:11], v[208:223]
ds_read_b64_tr_b16 a[152:153], v230 offset:18432
ds_read_b64_tr_b16 a[154:155], v230 offset:18944
s_sub_u32 s55, s55, s21
s_sub_u32 s56, s56, s1
s_waitcnt lgkmcnt(8)
v_mfma_f32_32x32x16_bf16 a[0:15], a[128:131], v[8:11], a[0:15]
ds_read_b64_tr_b16 a[156:157], v231 offset:19456
ds_read_b64_tr_b16 a[158:159], v231 offset:19968
v_add_f32 v240, v240, v234
v_add_f32 v241, v241, v234
v_add_f32 v242, v242, v234
v_mfma_f32_32x32x16_bf16 a[16:31], a[132:135], v[8:11], a[16:31]
ds_read_b64_tr_b16 a[160:161], v232 offset:19456
ds_read_b64_tr_b16 a[162:163], v232 offset:19968
v_add_f32 v243, v243, v234
v_cvt_pk_bf16_f32 v78, v240, v241
v_cvt_pk_bf16_f32 v79, v242, v243
v_mfma_f32_32x32x16_bf16 a[32:47], a[136:139], v[8:11], a[32:47]
ds_read_b64_tr_b16 a[164:165], v233 offset:19456
ds_read_b64_tr_b16 a[166:167], v233 offset:19968
s_waitcnt lgkmcnt(6)
v_mfma_f32_32x32x16_bf16 v[160:175], a[140:143], v[12:15], v[160:175]
v_lshlrev_b32 v240, 16, v80
v_and_b32 v241, s67, v80
v_lshlrev_b32 v242, 16, v81
v_and_b32 v243, s67, v81
v_add_f32 v240, v240, v234
v_mfma_f32_32x32x16_bf16 v[176:191], a[144:147], v[12:15], v[176:191]
s_waitcnt vmcnt(8)
s_barrier
ds_read_b64_tr_b16 a[112:113], v227 offset:32768
ds_read_b64_tr_b16 a[114:115], v227 offset:33280
ds_read_b64_tr_b16 a[116:117], v228 offset:32768
ds_read_b64_tr_b16 a[118:119], v228 offset:33280
v_mfma_f32_32x32x16_bf16 v[192:207], a[148:151], v[12:15], v[192:207]
ds_read_b64_tr_b16 a[120:121], v229 offset:32768
ds_read_b64_tr_b16 a[122:123], v229 offset:33280
s_add_u32 m0, s60, 0
s_nop 0
buffer_load_dwordx4 v225, s[28:31], s55 offen lds
s_add_u32 s55, s55, s58
v_mfma_f32_32x32x16_bf16 v[208:223], a[152:155], v[12:15], v[208:223]
ds_read_b64_tr_b16 a[124:125], v230 offset:32768
ds_read_b64_tr_b16 a[126:127], v230 offset:33280
buffer_load_dwordx4 v226, s[32:35], s56 offen offset:1024 lds
s_add_u32 s56, s56, 59392
s_waitcnt lgkmcnt(8)
v_mfma_f32_32x32x16_bf16 a[0:15], a[156:159], v[12:15], a[0:15]
ds_read_b64_tr_b16 a[128:129], v231 offset:33792
ds_read_b64_tr_b16 a[130:131], v231 offset:34304
v_add_f32 v241, v241, v234
v_add_f32 v242, v242, v234
v_add_f32 v243, v243, v234
v_mfma_f32_32x32x16_bf16 a[16:31], a[160:163], v[12:15], a[16:31]
ds_read_b64_tr_b16 a[132:133], v232 offset:33792
ds_read_b64_tr_b16 a[134:135], v232 offset:34304
v_cvt_pk_bf16_f32 v80, v240, v241
v_cvt_pk_bf16_f32 v81, v242, v243
v_lshlrev_b32 v240, 16, v82
v_mfma_f32_32x32x16_bf16 a[32:47], a[164:167], v[12:15], a[32:47]
ds_read_b64_tr_b16 a[136:137], v233 offset:33792
ds_read_b64_tr_b16 a[138:139], v233 offset:34304
v_and_b32 v241, s67, v82
v_lshlrev_b32 v242, 16, v83
v_and_b32 v243, s67, v83
s_waitcnt lgkmcnt(6)
v_mfma_f32_32x32x16_bf16 v[160:175], a[112:115], v[16:19], v[160:175]
ds_read_b64_tr_b16 a[140:141], v227 offset:34816
ds_read_b64_tr_b16 a[142:143], v227 offset:35328
buffer_load_dwordx4 v225, s[28:31], s55 offen offset:2048 lds
s_add_u32 s55, s55, s59
buffer_load_dwordx4 v226, s[32:35], s56 offen offset:3072 lds
v_mfma_f32_32x32x16_bf16 v[176:191], a[116:119], v[16:19], v[176:191]
ds_read_b64_tr_b16 a[144:145], v228 offset:34816
ds_read_b64_tr_b16 a[146:147], v228 offset:35328
s_add_u32 s56, s56, 63488
v_lshrrev_b32 v244, 4, v224
v_lshlrev_b32 v244, 10, v244
v_mfma_f32_32x32x16_bf16 v[192:207], a[120:123], v[16:19], v[192:207]
ds_read_b64_tr_b16 a[148:149], v229 offset:34816
ds_read_b64_tr_b16 a[150:151], v229 offset:35328
v_bfe_u32 v245, v224, 2, 2
v_lshl_add_u32 v244, v245, 7, v244
v_and_b32 v245, 3, v224
v_mfma_f32_32x32x16_bf16 v[208:223], a[124:127], v[16:19], v[208:223]
ds_read_b64_tr_b16 a[152:153], v230 offset:34816
ds_read_b64_tr_b16 a[154:155], v230 offset:35328
v_lshl_add_u32 v244, v245, 3, v244
s_mul_i32 s72, s3, 28672
s_waitcnt lgkmcnt(8)
v_mfma_f32_32x32x16_bf16 a[0:15], a[128:131], v[16:19], a[0:15]
ds_read_b64_tr_b16 a[156:157], v231 offset:35840
ds_read_b64_tr_b16 a[158:159], v231 offset:36352
s_add_u32 s72, s72, 65536
v_add_u32 v244, s72, v244
v_lshlrev_b32 v245, 4, v224
v_mfma_f32_32x32x16_bf16 a[16:31], a[132:135], v[16:19], a[16:31]
ds_read_b64_tr_b16 a[160:161], v232 offset:35840
ds_read_b64_tr_b16 a[162:163], v232 offset:36352
s_waitcnt vmcnt(8)
ds_read_b64_tr_b16 a[168:169], v244 offset:0
ds_read_b64_tr_b16 a[170:171], v244 offset:512
v_mfma_f32_32x32x16_bf16 a[32:47], a[136:139], v[16:19], a[32:47]
ds_read_b64_tr_b16 a[164:165], v233 offset:35840
ds_read_b64_tr_b16 a[166:167], v233 offset:36352
ds_read_b64_tr_b16 a[172:173], v244 offset:32
ds_read_b64_tr_b16 a[174:175], v244 offset:544
ds_read_b64_tr_b16 a[176:177], v244 offset:64
ds_read_b64_tr_b16 a[178:179], v244 offset:576
ds_read_b64_tr_b16 a[180:181], v244 offset:96
ds_read_b64_tr_b16 a[182:183], v244 offset:608
s_waitcnt lgkmcnt(8)
buffer_store_dwordx4 a[168:171], v245, s[36:39], s12 offen sc1
s_waitcnt lgkmcnt(4)
buffer_store_dwordx4 a[172:175], v245, s[36:39], s13 offen sc1
s_waitcnt lgkmcnt(2)
buffer_store_dwordx4 a[176:179], v245, s[36:39], s14 offen sc1
s_waitcnt lgkmcnt(0)
buffer_store_dwordx4 a[180:183], v245, s[36:39], s15 offen sc1
s_mov_b32 s70, 0x9E3779B1
v_mul_lo_u32 v254, v253, s70
v_xor_b32 v254, 0x7F4A7C15, v254
v_or_b32 v254, 1, v254
v_cmp_eq_u32 vcc, v254, v253
v_xor_b32 v253, 2, v254
s_nop 0
v_cndmask_b32 v254, v254, v253, vcc
s_nop 0
v_readfirstlane_b32 s4, v254
v_mfma_f32_32x32x16_bf16 v[160:175], a[140:143], v[20:23], v[160:175]
v_add_f32 v240, v240, v234
v_add_f32 v241, v241, v234
v_add_f32 v242, v242, v234
v_add_f32 v243, v243, v234
v_cvt_pk_bf16_f32 v82, v240, v241
v_mfma_f32_32x32x16_bf16 v[176:191], a[144:147], v[20:23], v[176:191]
s_waitcnt vmcnt(8)
s_barrier
ds_read_b64_tr_b16 a[112:113], v227 offset:49152
ds_read_b64_tr_b16 a[114:115], v227 offset:49664
ds_read_b64_tr_b16 a[116:117], v228 offset:49152
ds_read_b64_tr_b16 a[118:119], v228 offset:49664
v_mfma_f32_32x32x16_bf16 v[192:207], a[148:151], v[20:23], v[192:207]
ds_read_b64_tr_b16 a[120:121], v229 offset:49152
ds_read_b64_tr_b16 a[122:123], v229 offset:49664
s_add_u32 m0, s60, 16384
s_nop 0
buffer_load_dwordx4 v225, s[28:31], s55 offen lds
s_add_u32 s55, s55, s58
v_mfma_f32_32x32x16_bf16 v[208:223], a[152:155], v[20:23], v[208:223]
ds_read_b64_tr_b16 a[124:125], v230 offset:49152
ds_read_b64_tr_b16 a[126:127], v230 offset:49664
buffer_load_dwordx4 v226, s[32:35], s56 offen offset:1024 lds
s_add_u32 s56, s56, 59392
v_mfma_f32_32x32x16_bf16 a[0:15], a[156:159], v[20:23], a[0:15]
ds_read_b64_tr_b16 a[128:129], v231 offset:50176
ds_read_b64_tr_b16 a[130:131], v231 offset:50688
v_cvt_pk_bf16_f32 v83, v242, v243
v_lshlrev_b32 v240, 16, v84
v_and_b32 v241, s67, v84
v_mfma_f32_32x32x16_bf16 a[16:31], a[160:163], v[20:23], a[16:31]
ds_read_b64_tr_b16 a[132:133], v232 offset:50176
ds_read_b64_tr_b16 a[134:135], v232 offset:50688
v_lshlrev_b32 v242, 16, v85
v_and_b32 v243, s67, v85
v_add_f32 v240, v240, v234
v_mfma_f32_32x32x16_bf16 a[32:47], a[164:167], v[20:23], a[32:47]
ds_read_b64_tr_b16 a[136:137], v233 offset:50176
ds_read_b64_tr_b16 a[138:139], v233 offset:50688
v_add_f32 v241, v241, v234
v_add_f32 v242, v242, v234
v_add_f32 v243, v243, v234
s_waitcnt lgkmcnt(6)
v_mfma_f32_32x32x16_bf16 v[160:175], a[112:115], v[24:27], v[160:175]
ds_read_b64_tr_b16 a[140:141], v227 offset:51200
ds_read_b64_tr_b16 a[142:143], v227 offset:51712
buffer_load_dwordx4 v225, s[28:31], s55 offen offset:2048 lds
s_add_u32 s55, s55, s59
buffer_load_dwordx4 v226, s[32:35], s56 offen offset:3072 lds
v_mfma_f32_32x32x16_bf16 v[176:191], a[116:119], v[24:27], v[176:191]
ds_read_b64_tr_b16 a[144:145], v228 offset:51200
ds_read_b64_tr_b16 a[146:147], v228 offset:51712
s_add_u32 s56, s56, 63488
v_mfma_f32_32x32x16_bf16 v[192:207], a[120:123], v[24:27], v[192:207]
ds_read_b64_tr_b16 a[148:149], v229 offset:51200
ds_read_b64_tr_b16 a[150:151], v229 offset:51712
s_cmp_eq_u32 s23, 3
s_cselect_b32 s21, s20, 0
s_cselect_b32 s1, 2457600, 0
v_mfma_f32_32x32x16_bf16 v[208:223], a[124:127], v[24:27], v[208:223]
ds_read_b64_tr_b16 a[152:153], v230 offset:51200
ds_read_b64_tr_b16 a[154:155], v230 offset:51712
s_sub_u32 s55, s55, s21
s_sub_u32 s56, s56, s1
s_waitcnt lgkmcnt(8)
v_mfma_f32_32x32x16_bf16 a[0:15], a[128:131], v[24:27], a[0:15]
ds_read_b64_tr_b16 a[156:157], v231 offset:52224
ds_read_b64_tr_b16 a[158:159], v231 offset:52736
v_cvt_pk_bf16_f32 v84, v240, v241
v_cvt_pk_bf16_f32 v85, v242, v243
v_lshlrev_b32 v240, 16, v86
v_mfma_f32_32x32x16_bf16 a[16:31], a[132:135], v[24:27], a[16:31]
ds_read_b64_tr_b16 a[160:161], v232 offset:52224
ds_read_b64_tr_b16 a[162:163], v232 offset:52736
v_and_b32 v241, s67, v86
v_lshlrev_b32 v242, 16, v87
v_and_b32 v243, s67, v87
v_mfma_f32_32x32x16_bf16 a[32:47], a[136:139], v[24:27], a[32:47]
ds_read_b64_tr_b16 a[164:165], v233 offset:52224
ds_read_b64_tr_b16 a[166:167], v233 offset:52736
v_add_f32 v240, v240, v234
v_add_f32 v241, v241, v234
v_add_f32 v242, v242, v234
s_waitcnt lgkmcnt(6)
v_mfma_f32_32x32x16_bf16 v[160:175], a[140:143], v[28:31], v[160:175]
v_add_f32 v243, v243, v234
v_cvt_pk_bf16_f32 v86, v240, v241
v_cvt_pk_bf16_f32 v87, v242, v243
v_lshlrev_b32 v240, 16, v88
v_and_b32 v241, s67, v88
v_mfma_f32_32x32x16_bf16 v[176:191], a[144:147], v[28:31], v[176:191]
s_waitcnt vmcnt(8)
s_barrier
ds_read_b64_tr_b16 a[112:113], v227 offset:0
ds_read_b64_tr_b16 a[114:115], v227 offset:512
ds_read_b64_tr_b16 a[116:117], v228 offset:0
ds_read_b64_tr_b16 a[118:119], v228 offset:512
v_mfma_f32_32x32x16_bf16 v[192:207], a[148:151], v[28:31], v[192:207]
ds_read_b64_tr_b16 a[120:121], v229 offset:0
ds_read_b64_tr_b16 a[122:123], v229 offset:512
s_add_u32 m0, s60, 32768
s_nop 0
buffer_load_dwordx4 v225, s[28:31], s55 offen lds
s_add_u32 s55, s55, s58
v_mfma_f32_32x32x16_bf16 v[208:223], a[152:155], v[28:31], v[208:223]
ds_read_b64_tr_b16 a[124:125], v230 offset:0
ds_read_b64_tr_b16 a[126:127], v230 offset:512
buffer_load_dwordx4 v226, s[32:35], s56 offen offset:1024 lds
s_add_u32 s56, s56, 59392
s_waitcnt lgkmcnt(8)
v_mfma_f32_32x32x16_bf16 a[0:15], a[156:159], v[28:31], a[0:15]
ds_read_b64_tr_b16 a[128:129], v231 offset:1024
ds_read_b64_tr_b16 a[130:131], v231 offset:1536
v_lshlrev_b32 v242, 16, v89
v_and_b32 v243, s67, v89
v_add_f32 v240, v240, v234
v_mfma_f32_32x32x16_bf16 a[16:31], a[160:163], v[28:31], a[16:31]
ds_read_b64_tr_b16 a[132:133], v232 offset:1024
ds_read_b64_tr_b16 a[134:135], v232 offset:1536
v_add_f32 v241, v241, v234
v_add_f32 v242, v242, v234
v_add_f32 v243, v243, v234
v_mfma_f32_32x32x16_bf16 a[32:47], a[164:167], v[28:31], a[32:47]
ds_read_b64_tr_b16 a[136:137], v233 offset:1024
ds_read_b64_tr_b16 a[138:139], v233 offset:1536
v_cvt_pk_bf16_f32 v88, v240, v241
v_cvt_pk_bf16_f32 v89, v242, v243
v_lshlrev_b32 v240, 16, v90
s_waitcnt lgkmcnt(6)
v_mfma_f32_32x32x16_bf16 v[160:175], a[112:115], v[32:35], v[160:175]
ds_read_b64_tr_b16 a[140:141], v227 offset:2048
ds_read_b64_tr_b16 a[142:143], v227 offset:2560
buffer_load_dwordx4 v225, s[28:31], s55 offen offset:2048 lds
s_add_u32 s55, s55, s59
buffer_load_dwordx4 v226, s[32:35], s56 offen offset:3072 lds
v_mfma_f32_32x32x16_bf16 v[176:191], a[116:119], v[32:35], v[176:191]
ds_read_b64_tr_b16 a[144:145], v228 offset:2048
ds_read_b64_tr_b16 a[146:147], v228 offset:2560
s_add_u32 s56, s56, 63488
v_and_b32 v241, s67, v90
v_lshlrev_b32 v242, 16, v91
v_mfma_f32_32x32x16_bf16 v[192:207], a[120:123], v[32:35], v[192:207]
ds_read_b64_tr_b16 a[148:149], v229 offset:2048
ds_read_b64_tr_b16 a[150:151], v229 offset:2560
v_and_b32 v243, s67, v91
v_add_f32 v240, v240, v234
v_add_f32 v241, v241, v234
v_mfma_f32_32x32x16_bf16 v[208:223], a[124:127], v[32:35], v[208:223]
ds_read_b64_tr_b16 a[152:153], v230 offset:2048
ds_read_b64_tr_b16 a[154:155], v230 offset:2560
v_add_f32 v242, v242, v234
v_add_f32 v243, v243, v234
s_waitcnt lgkmcnt(8)
v_mfma_f32_32x32x16_bf16 a[0:15], a[128:131], v[32:35], a[0:15]
ds_read_b64_tr_b16 a[156:157], v231 offset:3072
ds_read_b64_tr_b16 a[158:159], v231 offset:3584
v_cvt_pk_bf16_f32 v90, v240, v241
v_cvt_pk_bf16_f32 v91, v242, v243
v_mfma_f32_32x32x16_bf16 a[16:31], a[132:135], v[32:35], a[16:31]
ds_read_b64_tr_b16 a[160:161], v232 offset:3072
ds_read_b64_tr_b16 a[162:163], v232 offset:3584
v_mfma_f32_32x32x16_bf16 a[32:47], a[136:139], v[32:35], a[32:47]
ds_read_b64_tr_b16 a[164:165], v233 offset:3072
ds_read_b64_tr_b16 a[166:167], v233 offset:3584
s_waitcnt lgkmcnt(6)
v_mfma_f32_32x32x16_bf16 v[160:175], a[140:143], v[36:39], v[160:175]
v_lshlrev_b32 v240, 16, v92
v_and_b32 v241, s67, v92
v_lshlrev_b32 v242, 16, v93
v_and_b32 v243, s67, v93
v_add_f32 v240, v240, v234
v_mfma_f32_32x32x16_bf16 v[176:191], a[144:147], v[36:39], v[176:191]
s_waitcnt vmcnt(4)
s_barrier
ds_read_b64_tr_b16 a[112:113], v227 offset:16384
ds_read_b64_tr_b16 a[114:115], v227 offset:16896
ds_read_b64_tr_b16 a[116:117], v228 offset:16384
ds_read_b64_tr_b16 a[118:119], v228 offset:16896
v_mfma_f32_32x32x16_bf16 v[192:207], a[148:151], v[36:39], v[192:207]
ds_read_b64_tr_b16 a[120:121], v229 offset:16384
ds_read_b64_tr_b16 a[122:123], v229 offset:16896
s_add_u32 m0, s60, 49152
s_nop 0
buffer_load_dwordx4 v225, s[28:31], s55 offen lds
s_add_u32 s55, s55, s58
v_mfma_f32_32x32x16_bf16 v[208:223], a[152:155], v[36:39], v[208:223]
ds_read_b64_tr_b16 a[124:125], v230 offset:16384
ds_read_b64_tr_b16 a[126:127], v230 offset:16896
buffer_load_dwordx4 v226, s[32:35], s56 offen offset:1024 lds
s_add_u32 s56, s56, 59392
s_waitcnt lgkmcnt(8)
v_mfma_f32_32x32x16_bf16 a[0:15], a[156:159], v[36:39], a[0:15]
ds_read_b64_tr_b16 a[128:129], v231 offset:17408
ds_read_b64_tr_b16 a[130:131], v231 offset:17920
v_add_f32 v241, v241, v234
v_add_f32 v242, v242, v234
v_add_f32 v243, v243, v234
v_mfma_f32_32x32x16_bf16 a[16:31], a[160:163], v[36:39], a[16:31]
ds_read_b64_tr_b16 a[132:133], v232 offset:17408
ds_read_b64_tr_b16 a[134:135], v232 offset:17920
v_cvt_pk_bf16_f32 v92, v240, v241
v_cvt_pk_bf16_f32 v93, v242, v243
v_lshlrev_b32 v240, 16, v94
v_mfma_f32_32x32x16_bf16 a[32:47], a[164:167], v[36:39], a[32:47]
ds_read_b64_tr_b16 a[136:137], v233 offset:17408
ds_read_b64_tr_b16 a[138:139], v233 offset:17920
v_and_b32 v241, s67, v94
v_lshlrev_b32 v242, 16, v95
v_and_b32 v243, s67, v95
s_waitcnt lgkmcnt(6)
v_mfma_f32_32x32x16_bf16 v[160:175], a[112:115], v[40:43], v[160:175]
ds_read_b64_tr_b16 a[140:141], v227 offset:18432
ds_read_b64_tr_b16 a[142:143], v227 offset:18944
buffer_load_dwordx4 v225, s[28:31], s55 offen offset:2048 lds
s_add_u32 s55, s55, s59
buffer_load_dwordx4 v226, s[32:35], s56 offen offset:3072 lds
v_mfma_f32_32x32x16_bf16 v[176:191], a[116:119], v[40:43], v[176:191]
ds_read_b64_tr_b16 a[144:145], v228 offset:18432
ds_read_b64_tr_b16 a[146:147], v228 offset:18944
s_add_u32 s56, s56, 63488
v_mfma_f32_32x32x16_bf16 v[192:207], a[120:123], v[40:43], v[192:207]
ds_read_b64_tr_b16 a[148:149], v229 offset:18432
ds_read_b64_tr_b16 a[150:151], v229 offset:18944
s_cmp_eq_u32 s23, 4
s_cselect_b32 s21, s20, 0
s_cselect_b32 s1, 2457600, 0
v_mfma_f32_32x32x16_bf16 v[208:223], a[124:127], v[40:43], v[208:223]
ds_read_b64_tr_b16 a[152:153], v230 offset:18432
ds_read_b64_tr_b16 a[154:155], v230 offset:18944
s_sub_u32 s55, s55, s21
s_sub_u32 s56, s56, s1
s_waitcnt lgkmcnt(8)
v_mfma_f32_32x32x16_bf16 a[0:15], a[128:131], v[40:43], a[0:15]
ds_read_b64_tr_b16 a[156:157], v231 offset:19456
ds_read_b64_tr_b16 a[158:159], v231 offset:19968
v_add_f32 v240, v240, v234
v_add_f32 v241, v241, v234
v_add_f32 v242, v242, v234
v_mfma_f32_32x32x16_bf16 a[16:31], a[132:135], v[40:43], a[16:31]
ds_read_b64_tr_b16 a[160:161], v232 offset:19456
ds_read_b64_tr_b16 a[162:163], v232 offset:19968
v_add_f32 v243, v243, v234
v_cvt_pk_bf16_f32 v94, v240, v241
v_cvt_pk_bf16_f32 v95, v242, v243
v_mfma_f32_32x32x16_bf16 a[32:47], a[136:139], v[40:43], a[32:47]
ds_read_b64_tr_b16 a[164:165], v233 offset:19456
ds_read_b64_tr_b16 a[166:167], v233 offset:19968
v_lshlrev_b32 v240, 16, v96
v_and_b32 v241, s67, v96
v_lshlrev_b32 v242, 16, v97
s_waitcnt lgkmcnt(6)
v_mfma_f32_32x32x16_bf16 v[160:175], a[140:143], v[44:47], v[160:175]
v_and_b32 v243, s67, v97
v_add_f32 v240, v240, v234
v_add_f32 v241, v241, v234
v_add_f32 v242, v242, v234
v_add_f32 v243, v243, v234
v_mfma_f32_32x32x16_bf16 v[176:191], a[144:147], v[44:47], v[176:191]
s_waitcnt vmcnt(4)
s_barrier
s_lshl_b32 s72, s52, 7
s_lshl_b32 s73, s53, 2
s_add_u32 s72, s72, s73
s_add_u32 s72, s72, 20596864
s_cmp_eq_u32 s3, 0
s_cselect_b32 s72, s72, 2146435072
v_lshlrev_b32 v254, 25, v224
v_mov_b32 v255, s4
buffer_store_dword v255, v254, s[36:39], s72 offen sc1
ds_read_b64_tr_b16 a[112:113], v227 offset:32768
ds_read_b64_tr_b16 a[114:115], v227 offset:33280
ds_read_b64_tr_b16 a[116:117], v228 offset:32768
ds_read_b64_tr_b16 a[118:119], v228 offset:33280
v_mfma_f32_32x32x16_bf16 v[192:207], a[148:151], v[44:47], v[192:207]
ds_read_b64_tr_b16 a[120:121], v229 offset:32768
ds_read_b64_tr_b16 a[122:123], v229 offset:33280
s_add_u32 m0, s60, 0
s_nop 0
buffer_load_dwordx4 v225, s[28:31], s55 offen lds
s_add_u32 s55, s55, s58
v_mfma_f32_32x32x16_bf16 v[208:223], a[152:155], v[44:47], v[208:223]
ds_read_b64_tr_b16 a[124:125], v230 offset:32768
ds_read_b64_tr_b16 a[126:127], v230 offset:33280
buffer_load_dwordx4 v226, s[32:35], s56 offen offset:1024 lds
s_add_u32 s56, s56, 59392
s_waitcnt lgkmcnt(8)
v_mfma_f32_32x32x16_bf16 a[0:15], a[156:159], v[44:47], a[0:15]
ds_read_b64_tr_b16 a[128:129], v231 offset:33792
ds_read_b64_tr_b16 a[130:131], v231 offset:34304
v_cvt_pk_bf16_f32 v96, v240, v241
v_cvt_pk_bf16_f32 v97, v242, v243
v_lshlrev_b32 v240, 16, v98
v_mfma_f32_32x32x16_bf16 a[16:31], a[160:163], v[44:47], a[16:31]
ds_read_b64_tr_b16 a[132:133], v232 offset:33792
ds_read_b64_tr_b16 a[134:135], v232 offset:34304
v_and_b32 v241, s67, v98
v_lshlrev_b32 v242, 16, v99
v_and_b32 v243, s67, v99
v_mfma_f32_32x32x16_bf16 a[32:47], a[164:167], v[44:47], a[32:47]
ds_read_b64_tr_b16 a[136:137], v233 offset:33792
ds_read_b64_tr_b16 a[138:139], v233 offset:34304
v_add_f32 v240, v240, v234
v_add_f32 v241, v241, v234
v_add_f32 v242, v242, v234
s_waitcnt lgkmcnt(6)
v_mfma_f32_32x32x16_bf16 v[160:175], a[112:115], v[48:51], v[160:175]
ds_read_b64_tr_b16 a[140:141], v227 offset:34816
ds_read_b64_tr_b16 a[142:143], v227 offset:35328
buffer_load_dwordx4 v225, s[28:31], s55 offen offset:2048 lds
s_add_u32 s55, s55, s59
buffer_load_dwordx4 v226, s[32:35], s56 offen offset:3072 lds
v_mfma_f32_32x32x16_bf16 v[176:191], a[116:119], v[48:51], v[176:191]
ds_read_b64_tr_b16 a[144:145], v228 offset:34816
ds_read_b64_tr_b16 a[146:147], v228 offset:35328
s_add_u32 s56, s56, 63488
v_add_f32 v243, v243, v234
v_cvt_pk_bf16_f32 v98, v240, v241
v_mfma_f32_32x32x16_bf16 v[192:207], a[120:123], v[48:51], v[192:207]
ds_read_b64_tr_b16 a[148:149], v229 offset:34816
ds_read_b64_tr_b16 a[150:151], v229 offset:35328
v_cvt_pk_bf16_f32 v99, v242, v243
v_lshlrev_b32 v240, 16, v100
v_and_b32 v241, s67, v100
v_mfma_f32_32x32x16_bf16 v[208:223], a[124:127], v[48:51], v[208:223]
ds_read_b64_tr_b16 a[152:153], v230 offset:34816
ds_read_b64_tr_b16 a[154:155], v230 offset:35328
v_lshlrev_b32 v242, 16, v101
v_and_b32 v243, s67, v101
s_waitcnt lgkmcnt(8)
v_mfma_f32_32x32x16_bf16 a[0:15], a[128:131], v[48:51], a[0:15]
ds_read_b64_tr_b16 a[156:157], v231 offset:35840
ds_read_b64_tr_b16 a[158:159], v231 offset:36352
v_add_f32 v240, v240, v234
v_add_f32 v241, v241, v234
v_add_f32 v242, v242, v234
v_mfma_f32_32x32x16_bf16 a[16:31], a[132:135], v[48:51], a[16:31]
ds_read_b64_tr_b16 a[160:161], v232 offset:35840
ds_read_b64_tr_b16 a[162:163], v232 offset:36352
v_add_f32 v243, v243, v234
v_cvt_pk_bf16_f32 v100, v240, v241
v_cvt_pk_bf16_f32 v101, v242, v243
v_mfma_f32_32x32x16_bf16 a[32:47], a[136:139], v[48:51], a[32:47]
ds_read_b64_tr_b16 a[164:165], v233 offset:35840
ds_read_b64_tr_b16 a[166:167], v233 offset:36352
v_lshlrev_b32 v240, 16, v102
v_and_b32 v241, s67, v102
v_lshlrev_b32 v242, 16, v103
s_waitcnt lgkmcnt(6)
v_mfma_f32_32x32x16_bf16 v[160:175], a[140:143], v[52:55], v[160:175]
v_and_b32 v243, s67, v103
v_add_f32 v240, v240, v234
v_add_f32 v241, v241, v234
v_add_f32 v242, v242, v234
v_add_f32 v243, v243, v234
v_mfma_f32_32x32x16_bf16 v[176:191], a[144:147], v[52:55], v[176:191]
s_waitcnt vmcnt(5)
s_barrier
ds_read_b64_tr_b16 a[112:113], v227 offset:49152
ds_read_b64_tr_b16 a[114:115], v227 offset:49664
ds_read_b64_tr_b16 a[116:117], v228 offset:49152
ds_read_b64_tr_b16 a[118:119], v228 offset:49664
v_mfma_f32_32x32x16_bf16 v[192:207], a[148:151], v[52:55], v[192:207]
ds_read_b64_tr_b16 a[120:121], v229 offset:49152
ds_read_b64_tr_b16 a[122:123], v229 offset:49664
s_add_u32 m0, s60, 16384
s_nop 0
buffer_load_dwordx4 v225, s[28:31], s55 offen lds
s_add_u32 s55, s55, s58
v_mfma_f32_32x32x16_bf16 v[208:223], a[152:155], v[52:55], v[208:223]
ds_read_b64_tr_b16 a[124:125], v230 offset:49152
ds_read_b64_tr_b16 a[126:127], v230 offset:49664
buffer_load_dwordx4 v226, s[32:35], s56 offen offset:1024 lds
s_add_u32 s56, s56, 59392
s_waitcnt lgkmcnt(8)
v_mfma_f32_32x32x16_bf16 a[0:15], a[156:159], v[52:55], a[0:15]
ds_read_b64_tr_b16 a[128:129], v231 offset:50176
ds_read_b64_tr_b16 a[130:131], v231 offset:50688
v_cvt_pk_bf16_f32 v102, v240, v241
v_cvt_pk_bf16_f32 v103, v242, v243
v_mfma_f32_32x32x16_bf16 a[16:31], a[160:163], v[52:55], a[16:31]
ds_read_b64_tr_b16 a[132:133], v232 offset:50176
ds_read_b64_tr_b16 a[134:135], v232 offset:50688
v_mfma_f32_32x32x16_bf16 a[32:47], a[164:167], v[52:55], a[32:47]
ds_read_b64_tr_b16 a[136:137], v233 offset:50176
ds_read_b64_tr_b16 a[138:139], v233 offset:50688
s_waitcnt lgkmcnt(6)
v_mfma_f32_32x32x16_bf16 v[160:175], a[112:115], v[56:59], v[160:175]
ds_read_b64_tr_b16 a[140:141], v227 offset:51200
ds_read_b64_tr_b16 a[142:143], v227 offset:51712
buffer_load_dwordx4 v225, s[28:31], s55 offen offset:2048 lds
s_add_u32 s55, s55, s59
buffer_load_dwordx4 v226, s[32:35], s56 offen offset:3072 lds
v_mfma_f32_32x32x16_bf16 v[176:191], a[116:119], v[56:59], v[176:191]
ds_read_b64_tr_b16 a[144:145], v228 offset:51200
ds_read_b64_tr_b16 a[146:147], v228 offset:51712
s_add_u32 s56, s56, 63488
v_mfma_f32_32x32x16_bf16 v[192:207], a[120:123], v[56:59], v[192:207]
ds_read_b64_tr_b16 a[148:149], v229 offset:51200
ds_read_b64_tr_b16 a[150:151], v229 offset:51712
s_cmp_eq_u32 s23, 5
s_cselect_b32 s21, s20, 0
s_cselect_b32 s1, 2457600, 0
v_mfma_f32_32x32x16_bf16 v[208:223], a[124:127], v[56:59], v[208:223]
ds_read_b64_tr_b16 a[152:153], v230 offset:51200
ds_read_b64_tr_b16 a[154:155], v230 offset:51712
s_sub_u32 s55, s55, s21
s_sub_u32 s56, s56, s1
s_waitcnt lgkmcnt(8)
v_mfma_f32_32x32x16_bf16 a[0:15], a[128:131], v[56:59], a[0:15]
ds_read_b64_tr_b16 a[156:157], v231 offset:52224
ds_read_b64_tr_b16 a[158:159], v231 offset:52736
v_lshlrev_b32 v240, 16, v104
v_and_b32 v241, s67, v104
v_lshlrev_b32 v242, 16, v105
v_mfma_f32_32x32x16_bf16 a[16:31], a[132:135], v[56:59], a[16:31]
ds_read_b64_tr_b16 a[160:161], v232 offset:52224
ds_read_b64_tr_b16 a[162:163], v232 offset:52736
v_and_b32 v243, s67, v105
v_add_f32 v240, v240, v234
v_add_f32 v241, v241, v234
v_mfma_f32_32x32x16_bf16 a[32:47], a[136:139], v[56:59], a[32:47]
ds_read_b64_tr_b16 a[164:165], v233 offset:52224
ds_read_b64_tr_b16 a[166:167], v233 offset:52736
v_add_f32 v242, v242, v234
v_add_f32 v243, v243, v234
v_cvt_pk_bf16_f32 v104, v240, v241
s_waitcnt lgkmcnt(6)
v_mfma_f32_32x32x16_bf16 v[160:175], a[140:143], v[60:63], v[160:175]
v_cvt_pk_bf16_f32 v105, v242, v243
v_lshlrev_b32 v240, 16, v106
v_and_b32 v241, s67, v106
v_lshlrev_b32 v242, 16, v107
v_and_b32 v243, s67, v107
v_mfma_f32_32x32x16_bf16 v[176:191], a[144:147], v[60:63], v[176:191]
s_waitcnt vmcnt(4)
s_barrier
ds_read_b64_tr_b16 a[112:113], v227 offset:0
ds_read_b64_tr_b16 a[114:115], v227 offset:512
ds_read_b64_tr_b16 a[116:117], v228 offset:0
ds_read_b64_tr_b16 a[118:119], v228 offset:512
v_mfma_f32_32x32x16_bf16 v[192:207], a[148:151], v[60:63], v[192:207]
ds_read_b64_tr_b16 a[120:121], v229 offset:0
ds_read_b64_tr_b16 a[122:123], v229 offset:512
s_add_u32 m0, s60, 32768
s_nop 0
buffer_load_dwordx4 v225, s[28:31], s55 offen lds
s_add_u32 s55, s55, s58
v_mfma_f32_32x32x16_bf16 v[208:223], a[152:155], v[60:63], v[208:223]
ds_read_b64_tr_b16 a[124:125], v230 offset:0
ds_read_b64_tr_b16 a[126:127], v230 offset:512
buffer_load_dwordx4 v226, s[32:35], s56 offen offset:1024 lds
s_add_u32 s56, s56, 59392
s_waitcnt lgkmcnt(8)
v_mfma_f32_32x32x16_bf16 a[0:15], a[156:159], v[60:63], a[0:15]
ds_read_b64_tr_b16 a[128:129], v231 offset:1024
ds_read_b64_tr_b16 a[130:131], v231 offset:1536
v_add_f32 v240, v240, v234
v_add_f32 v241, v241, v234
v_add_f32 v242, v242, v234
v_mfma_f32_32x32x16_bf16 a[16:31], a[160:163], v[60:63], a[16:31]
ds_read_b64_tr_b16 a[132:133], v232 offset:1024
ds_read_b64_tr_b16 a[134:135], v232 offset:1536
v_add_f32 v243, v243, v234
v_cvt_pk_bf16_f32 v106, v240, v241
v_cvt_pk_bf16_f32 v107, v242, v243
v_mfma_f32_32x32x16_bf16 a[32:47], a[164:167], v[60:63], a[32:47]
ds_read_b64_tr_b16 a[136:137], v233 offset:1024
ds_read_b64_tr_b16 a[138:139], v233 offset:1536
s_waitcnt lgkmcnt(6)
v_mfma_f32_32x32x16_bf16 v[160:175], a[112:115], v[64:67], v[160:175]
ds_read_b64_tr_b16 a[140:141], v227 offset:2048
ds_read_b64_tr_b16 a[142:143], v227 offset:2560
buffer_load_dwordx4 v225, s[28:31], s55 offen offset:2048 lds
s_add_u32 s55, s55, s59
buffer_load_dwordx4 v226, s[32:35], s56 offen offset:3072 lds
v_mfma_f32_32x32x16_bf16 v[176:191], a[116:119], v[64:67], v[176:191]
ds_read_b64_tr_b16 a[144:145], v228 offset:2048
ds_read_b64_tr_b16 a[146:147], v228 offset:2560
s_add_u32 s56, s56, 63488
v_lshlrev_b32 v240, 16, v108
v_and_b32 v241, s67, v108
v_mfma_f32_32x32x16_bf16 v[192:207], a[120:123], v[64:67], v[192:207]
ds_read_b64_tr_b16 a[148:149], v229 offset:2048
ds_read_b64_tr_b16 a[150:151], v229 offset:2560
v_lshlrev_b32 v242, 16, v109
v_and_b32 v243, s67, v109
v_add_f32 v240, v240, v234
v_mfma_f32_32x32x16_bf16 v[208:223], a[124:127], v[64:67], v[208:223]
ds_read_b64_tr_b16 a[152:153], v230 offset:2048
ds_read_b64_tr_b16 a[154:155], v230 offset:2560
v_add_f32 v241, v241, v234
v_add_f32 v242, v242, v234
s_waitcnt lgkmcnt(8)
v_mfma_f32_32x32x16_bf16 a[0:15], a[128:131], v[64:67], a[0:15]
ds_read_b64_tr_b16 a[156:157], v231 offset:3072
ds_read_b64_tr_b16 a[158:159], v231 offset:3584
v_add_f32 v243, v243, v234
v_cvt_pk_bf16_f32 v108, v240, v241
v_cvt_pk_bf16_f32 v109, v242, v243
v_mfma_f32_32x32x16_bf16 a[16:31], a[132:135], v[64:67], a[16:31]
ds_read_b64_tr_b16 a[160:161], v232 offset:3072
ds_read_b64_tr_b16 a[162:163], v232 offset:3584
v_lshlrev_b32 v240, 16, v110
v_and_b32 v241, s67, v110
v_lshlrev_b32 v242, 16, v111
v_mfma_f32_32x32x16_bf16 a[32:47], a[136:139], v[64:67], a[32:47]
ds_read_b64_tr_b16 a[164:165], v233 offset:3072
ds_read_b64_tr_b16 a[166:167], v233 offset:3584
v_and_b32 v243, s67, v111
v_add_f32 v240, v240, v234
v_add_f32 v241, v241, v234
s_waitcnt lgkmcnt(6)
v_mfma_f32_32x32x16_bf16 v[160:175], a[140:143], v[68:71], v[160:175]
v_add_f32 v242, v242, v234
v_add_f32 v243, v243, v234
v_cvt_pk_bf16_f32 v110, v240, v241
v_cvt_pk_bf16_f32 v111, v242, v243
v_mfma_f32_32x32x16_bf16 v[176:191], a[144:147], v[68:71], v[176:191]
s_waitcnt vmcnt(4)
s_barrier
ds_read_b64_tr_b16 a[112:113], v227 offset:16384
ds_read_b64_tr_b16 a[114:115], v227 offset:16896
ds_read_b64_tr_b16 a[116:117], v228 offset:16384
ds_read_b64_tr_b16 a[118:119], v228 offset:16896
v_mfma_f32_32x32x16_bf16 v[192:207], a[148:151], v[68:71], v[192:207]
ds_read_b64_tr_b16 a[120:121], v229 offset:16384
ds_read_b64_tr_b16 a[122:123], v229 offset:16896
s_add_u32 m0, s60, 49152
s_nop 0
buffer_load_dwordx4 v225, s[28:31], s55 offen lds
s_add_u32 s55, s55, s58
v_mfma_f32_32x32x16_bf16 v[208:223], a[152:155], v[68:71], v[208:223]
ds_read_b64_tr_b16 a[124:125], v230 offset:16384
ds_read_b64_tr_b16 a[126:127], v230 offset:16896
buffer_load_dwordx4 v226, s[32:35], s56 offen offset:1024 lds
s_add_u32 s56, s56, 59392
s_waitcnt lgkmcnt(8)
v_mfma_f32_32x32x16_bf16 a[0:15], a[156:159], v[68:71], a[0:15]
ds_read_b64_tr_b16 a[128:129], v231 offset:17408
ds_read_b64_tr_b16 a[130:131], v231 offset:17920
v_mfma_f32_32x32x16_bf16 a[16:31], a[160:163], v[68:71], a[16:31]
ds_read_b64_tr_b16 a[132:133], v232 offset:17408
ds_read_b64_tr_b16 a[134:135], v232 offset:17920
v_mfma_f32_32x32x16_bf16 a[32:47], a[164:167], v[68:71], a[32:47]
ds_read_b64_tr_b16 a[136:137], v233 offset:17408
ds_read_b64_tr_b16 a[138:139], v233 offset:17920
s_waitcnt lgkmcnt(6)
v_mfma_f32_32x32x16_bf16 v[160:175], a[112:115], v[72:75], v[160:175]
ds_read_b64_tr_b16 a[140:141], v227 offset:18432
ds_read_b64_tr_b16 a[142:143], v227 offset:18944
buffer_load_dwordx4 v225, s[28:31], s55 offen offset:2048 lds
s_add_u32 s55, s55, s59
buffer_load_dwordx4 v226, s[32:35], s56 offen offset:3072 lds
v_mfma_f32_32x32x16_bf16 v[176:191], a[116:119], v[72:75], v[176:191]
ds_read_b64_tr_b16 a[144:145], v228 offset:18432
ds_read_b64_tr_b16 a[146:147], v228 offset:18944
s_add_u32 s56, s56, 63488
v_mfma_f32_32x32x16_bf16 v[192:207], a[120:123], v[72:75], v[192:207]
ds_read_b64_tr_b16 a[148:149], v229 offset:18432
ds_read_b64_tr_b16 a[150:151], v229 offset:18944
s_cmp_eq_u32 s23, 6
s_cselect_b32 s21, s20, 0
s_cselect_b32 s1, 2457600, 0
v_mfma_f32_32x32x16_bf16 v[208:223], a[124:127], v[72:75], v[208:223]
ds_read_b64_tr_b16 a[152:153], v230 offset:18432
ds_read_b64_tr_b16 a[154:155], v230 offset:18944
s_sub_u32 s55, s55, s21
s_sub_u32 s56, s56, s1
s_waitcnt lgkmcnt(8)
v_mfma_f32_32x32x16_bf16 a[0:15], a[128:131], v[72:75], a[0:15]
ds_read_b64_tr_b16 a[156:157], v231 offset:19456
ds_read_b64_tr_b16 a[158:159], v231 offset:19968
v_lshlrev_b32 v240, 16, v112
v_and_b32 v241, s67, v112
v_lshlrev_b32 v242, 16, v113
v_mfma_f32_32x32x16_bf16 a[16:31], a[132:135], v[72:75], a[16:31]
ds_read_b64_tr_b16 a[160:161], v232 offset:19456
ds_read_b64_tr_b16 a[162:163], v232 offset:19968
v_and_b32 v243, s67, v113
v_add_f32 v240, v240, v234
v_add_f32 v241, v241, v234
v_mfma_f32_32x32x16_bf16 a[32:47], a[136:139], v[72:75], a[32:47]
ds_read_b64_tr_b16 a[164:165], v233 offset:19456
ds_read_b64_tr_b16 a[166:167], v233 offset:19968
v_add_f32 v242, v242, v234
v_add_f32 v243, v243, v234
v_cvt_pk_bf16_f32 v112, v240, v241
s_waitcnt lgkmcnt(6)
v_mfma_f32_32x32x16_bf16 v[160:175], a[140:143], v[76:79], v[160:175]
v_cvt_pk_bf16_f32 v113, v242, v243
v_lshlrev_b32 v240, 16, v114
v_and_b32 v241, s67, v114
v_lshlrev_b32 v242, 16, v115
v_and_b32 v243, s67, v115
v_mfma_f32_32x32x16_bf16 v[176:191], a[144:147], v[76:79], v[176:191]
s_waitcnt vmcnt(4)
s_barrier
ds_read_b64_tr_b16 a[112:113], v227 offset:32768
ds_read_b64_tr_b16 a[114:115], v227 offset:33280
ds_read_b64_tr_b16 a[116:117], v228 offset:32768
ds_read_b64_tr_b16 a[118:119], v228 offset:33280
v_mfma_f32_32x32x16_bf16 v[192:207], a[148:151], v[76:79], v[192:207]
ds_read_b64_tr_b16 a[120:121], v229 offset:32768
ds_read_b64_tr_b16 a[122:123], v229 offset:33280
s_add_u32 m0, s60, 0
s_nop 0
buffer_load_dwordx4 v225, s[28:31], s55 offen lds
s_add_u32 s55, s55, s58
v_mfma_f32_32x32x16_bf16 v[208:223], a[152:155], v[76:79], v[208:223]
ds_read_b64_tr_b16 a[124:125], v230 offset:32768
ds_read_b64_tr_b16 a[126:127], v230 offset:33280
buffer_load_dwordx4 v226, s[32:35], s56 offen offset:1024 lds
s_add_u32 s56, s56, 59392
s_waitcnt lgkmcnt(8)
v_mfma_f32_32x32x16_bf16 a[0:15], a[156:159], v[76:79], a[0:15]
ds_read_b64_tr_b16 a[128:129], v231 offset:33792
ds_read_b64_tr_b16 a[130:131], v231 offset:34304
v_add_f32 v240, v240, v234
v_add_f32 v241, v241, v234
v_add_f32 v242, v242, v234
v_mfma_f32_32x32x16_bf16 a[16:31], a[160:163], v[76:79], a[16:31]
ds_read_b64_tr_b16 a[132:133], v232 offset:33792
ds_read_b64_tr_b16 a[134:135], v232 offset:34304
v_add_f32 v243, v243, v234
v_cvt_pk_bf16_f32 v114, v240, v241
v_cvt_pk_bf16_f32 v115, v242, v243
v_mfma_f32_32x32x16_bf16 a[32:47], a[164:167], v[76:79], a[32:47]
ds_read_b64_tr_b16 a[136:137], v233 offset:33792
ds_read_b64_tr_b16 a[138:139], v233 offset:34304
s_waitcnt lgkmcnt(6)
v_mfma_f32_32x32x16_bf16 v[160:175], a[112:115], v[80:83], v[160:175]
ds_read_b64_tr_b16 a[140:141], v227 offset:34816
ds_read_b64_tr_b16 a[142:143], v227 offset:35328
buffer_load_dwordx4 v225, s[28:31], s55 offen offset:2048 lds
s_add_u32 s55, s55, s59
buffer_load_dwordx4 v226, s[32:35], s56 offen offset:3072 lds
v_mfma_f32_32x32x16_bf16 v[176:191], a[116:119], v[80:83], v[176:191]
ds_read_b64_tr_b16 a[144:145], v228 offset:34816
ds_read_b64_tr_b16 a[146:147], v228 offset:35328
s_add_u32 s56, s56, 63488
v_lshlrev_b32 v240, 16, v116
v_and_b32 v241, s67, v116
v_mfma_f32_32x32x16_bf16 v[192:207], a[120:123], v[80:83], v[192:207]
ds_read_b64_tr_b16 a[148:149], v229 offset:34816
ds_read_b64_tr_b16 a[150:151], v229 offset:35328
v_lshlrev_b32 v242, 16, v117
v_and_b32 v243, s67, v117
v_add_f32 v240, v240, v234
v_mfma_f32_32x32x16_bf16 v[208:223], a[124:127], v[80:83], v[208:223]
ds_read_b64_tr_b16 a[152:153], v230 offset:34816
ds_read_b64_tr_b16 a[154:155], v230 offset:35328
v_add_f32 v241, v241, v234
v_add_f32 v242, v242, v234
s_waitcnt lgkmcnt(8)
v_mfma_f32_32x32x16_bf16 a[0:15], a[128:131], v[80:83], a[0:15]
ds_read_b64_tr_b16 a[156:157], v231 offset:35840
ds_read_b64_tr_b16 a[158:159], v231 offset:36352
v_add_f32 v243, v243, v234
v_cvt_pk_bf16_f32 v116, v240, v241
v_cvt_pk_bf16_f32 v117, v242, v243
v_mfma_f32_32x32x16_bf16 a[16:31], a[132:135], v[80:83], a[16:31]
ds_read_b64_tr_b16 a[160:161], v232 offset:35840
ds_read_b64_tr_b16 a[162:163], v232 offset:36352
v_lshlrev_b32 v240, 16, v118
v_and_b32 v241, s67, v118
v_lshlrev_b32 v242, 16, v119
v_mfma_f32_32x32x16_bf16 a[32:47], a[136:139], v[80:83], a[32:47]
ds_read_b64_tr_b16 a[164:165], v233 offset:35840
ds_read_b64_tr_b16 a[166:167], v233 offset:36352
v_and_b32 v243, s67, v119
v_add_f32 v240, v240, v234
v_add_f32 v241, v241, v234
s_waitcnt lgkmcnt(6)
v_mfma_f32_32x32x16_bf16 v[160:175], a[140:143], v[84:87], v[160:175]
v_add_f32 v242, v242, v234
v_add_f32 v243, v243, v234
v_cvt_pk_bf16_f32 v118, v240, v241
v_cvt_pk_bf16_f32 v119, v242, v243
v_lshlrev_b32 v240, 16, v120
v_mfma_f32_32x32x16_bf16 v[176:191], a[144:147], v[84:87], v[176:191]
s_waitcnt vmcnt(4)
s_barrier
ds_read_b64_tr_b16 a[112:113], v227 offset:49152
ds_read_b64_tr_b16 a[114:115], v227 offset:49664
ds_read_b64_tr_b16 a[116:117], v228 offset:49152
ds_read_b64_tr_b16 a[118:119], v228 offset:49664
v_mfma_f32_32x32x16_bf16 v[192:207], a[148:151], v[84:87], v[192:207]
ds_read_b64_tr_b16 a[120:121], v229 offset:49152
ds_read_b64_tr_b16 a[122:123], v229 offset:49664
s_add_u32 m0, s60, 16384
s_nop 0
buffer_load_dwordx4 v225, s[28:31], s55 offen lds
s_add_u32 s55, s55, s58
v_mfma_f32_32x32x16_bf16 v[208:223], a[152:155], v[84:87], v[208:223]
ds_read_b64_tr_b16 a[124:125], v230 offset:49152
ds_read_b64_tr_b16 a[126:127], v230 offset:49664
buffer_load_dwordx4 v226, s[32:35], s56 offen offset:1024 lds
s_add_u32 s56, s56, 59392
s_waitcnt lgkmcnt(8)
v_mfma_f32_32x32x16_bf16 a[0:15], a[156:159], v[84:87], a[0:15]
ds_read_b64_tr_b16 a[128:129], v231 offset:50176
ds_read_b64_tr_b16 a[130:131], v231 offset:50688
v_and_b32 v241, s67, v120
v_lshlrev_b32 v242, 16, v121
v_and_b32 v243, s67, v121
v_mfma_f32_32x32x16_bf16 a[16:31], a[160:163], v[84:87], a[16:31]
ds_read_b64_tr_b16 a[132:133], v232 offset:50176
ds_read_b64_tr_b16 a[134:135], v232 offset:50688
v_add_f32 v240, v240, v234
v_add_f32 v241, v241, v234
v_add_f32 v242, v242, v234
v_mfma_f32_32x32x16_bf16 a[32:47], a[164:167], v[84:87], a[32:47]
ds_read_b64_tr_b16 a[136:137], v233 offset:50176
ds_read_b64_tr_b16 a[138:139], v233 offset:50688
v_add_f32 v243, v243, v234
v_cvt_pk_bf16_f32 v120, v240, v241
v_cvt_pk_bf16_f32 v121, v242, v243
s_waitcnt lgkmcnt(6)
v_mfma_f32_32x32x16_bf16 v[160:175], a[112:115], v[88:91], v[160:175]
ds_read_b64_tr_b16 a[140:141], v227 offset:51200
ds_read_b64_tr_b16 a[142:143], v227 offset:51712
buffer_load_dwordx4 v225, s[28:31], s55 offen offset:2048 lds
s_add_u32 s55, s55, s59
buffer_load_dwordx4 v226, s[32:35], s56 offen offset:3072 lds
v_mfma_f32_32x32x16_bf16 v[176:191], a[116:119], v[88:91], v[176:191]
ds_read_b64_tr_b16 a[144:145], v228 offset:51200
ds_read_b64_tr_b16 a[146:147], v228 offset:51712
s_add_u32 s56, s56, 63488
v_mfma_f32_32x32x16_bf16 v[192:207], a[120:123], v[88:91], v[192:207]
ds_read_b64_tr_b16 a[148:149], v229 offset:51200
ds_read_b64_tr_b16 a[150:151], v229 offset:51712
s_cmp_eq_u32 s23, 7
s_cselect_b32 s21, s20, 0
s_cselect_b32 s1, 2457600, 0
v_mfma_f32_32x32x16_bf16 v[208:223], a[124:127], v[88:91], v[208:223]
ds_read_b64_tr_b16 a[152:153], v230 offset:51200
ds_read_b64_tr_b16 a[154:155], v230 offset:51712
s_sub_u32 s55, s55, s21
s_sub_u32 s56, s56, s1
s_waitcnt lgkmcnt(8)
v_mfma_f32_32x32x16_bf16 a[0:15], a[128:131], v[88:91], a[0:15]
ds_read_b64_tr_b16 a[156:157], v231 offset:52224
ds_read_b64_tr_b16 a[158:159], v231 offset:52736
v_lshlrev_b32 v240, 16, v122
v_and_b32 v241, s67, v122
v_lshlrev_b32 v242, 16, v123
v_mfma_f32_32x32x16_bf16 a[16:31], a[132:135], v[88:91], a[16:31]
ds_read_b64_tr_b16 a[160:161], v232 offset:52224
ds_read_b64_tr_b16 a[162:163], v232 offset:52736
v_and_b32 v243, s67, v123
v_add_f32 v240, v240, v234
v_add_f32 v241, v241, v234
v_mfma_f32_32x32x16_bf16 a[32:47], a[136:139], v[88:91], a[32:47]
ds_read_b64_tr_b16 a[164:165], v233 offset:52224
ds_read_b64_tr_b16 a[166:167], v233 offset:52736
v_add_f32 v242, v242, v234
v_add_f32 v243, v243, v234
v_cvt_pk_bf16_f32 v122, v240, v241
s_waitcnt lgkmcnt(6)
v_mfma_f32_32x32x16_bf16 v[160:175], a[140:143], v[92:95], v[160:175]
v_cvt_pk_bf16_f32 v123, v242, v243
v_lshlrev_b32 v240, 16, v124
v_and_b32 v241, s67, v124
v_lshlrev_b32 v242, 16, v125
v_and_b32 v243, s67, v125
v_mfma_f32_32x32x16_bf16 v[176:191], a[144:147], v[92:95], v[176:191]
s_waitcnt vmcnt(4)
s_barrier
v_lshrrev_b32 v248, 2, v224
v_lshlrev_b32 v248, 7, v248
v_and_b32 v244, 3, v224
v_lshl_add_u32 v248, v244, 4, v248
s_mov_b32 s72, 20596864
buffer_load_dwordx4 v[244:247], v248, s[36:39], s72 offen sc1
ds_read_b64_tr_b16 a[112:113], v227 offset:0
ds_read_b64_tr_b16 a[114:115], v227 offset:512
ds_read_b64_tr_b16 a[116:117], v228 offset:0
ds_read_b64_tr_b16 a[118:119], v228 offset:512
v_mfma_f32_32x32x16_bf16 v[192:207], a[148:151], v[92:95], v[192:207]
ds_read_b64_tr_b16 a[120:121], v229 offset:0
ds_read_b64_tr_b16 a[122:123], v229 offset:512
s_add_u32 m0, s60, 32768
s_nop 0
buffer_load_dwordx4 v225, s[28:31], s55 offen lds
s_add_u32 s55, s55, s58
v_mfma_f32_32x32x16_bf16 v[208:223], a[152:155], v[92:95], v[208:223]
ds_read_b64_tr_b16 a[124:125], v230 offset:0
ds_read_b64_tr_b16 a[126:127], v230 offset:512
buffer_load_dwordx4 v226, s[32:35], s56 offen offset:1024 lds
s_add_u32 s56, s56, 59392
s_waitcnt lgkmcnt(8)
v_mfma_f32_32x32x16_bf16 a[0:15], a[156:159], v[92:95], a[0:15]
ds_read_b64_tr_b16 a[128:129], v231 offset:1024
ds_read_b64_tr_b16 a[130:131], v231 offset:1536
v_add_f32 v240, v240, v234
v_add_f32 v241, v241, v234
v_add_f32 v242, v242, v234
v_mfma_f32_32x32x16_bf16 a[16:31], a[160:163], v[92:95], a[16:31]
ds_read_b64_tr_b16 a[132:133], v232 offset:1024
ds_read_b64_tr_b16 a[134:135], v232 offset:1536
v_add_f32 v243, v243, v234
v_cvt_pk_bf16_f32 v124, v240, v241
v_cvt_pk_bf16_f32 v125, v242, v243
v_mfma_f32_32x32x16_bf16 a[32:47], a[164:167], v[92:95], a[32:47]
ds_read_b64_tr_b16 a[136:137], v233 offset:1024
ds_read_b64_tr_b16 a[138:139], v233 offset:1536
v_lshlrev_b32 v240, 16, v126
v_and_b32 v241, s67, v126
v_lshlrev_b32 v242, 16, v127
s_waitcnt lgkmcnt(6)
v_mfma_f32_32x32x16_bf16 v[160:175], a[112:115], v[96:99], v[160:175]
ds_read_b64_tr_b16 a[140:141], v227 offset:2048
ds_read_b64_tr_b16 a[142:143], v227 offset:2560
buffer_load_dwordx4 v225, s[28:31], s55 offen offset:2048 lds
s_add_u32 s55, s55, s59
buffer_load_dwordx4 v226, s[32:35], s56 offen offset:3072 lds
v_mfma_f32_32x32x16_bf16 v[176:191], a[116:119], v[96:99], v[176:191]
ds_read_b64_tr_b16 a[144:145], v228 offset:2048
ds_read_b64_tr_b16 a[146:147], v228 offset:2560
s_add_u32 s56, s56, 63488
v_and_b32 v243, s67, v127
v_add_f32 v240, v240, v234
v_mfma_f32_32x32x16_bf16 v[192:207], a[120:123], v[96:99], v[192:207]
ds_read_b64_tr_b16 a[148:149], v229 offset:2048
ds_read_b64_tr_b16 a[150:151], v229 offset:2560
v_add_f32 v241, v241, v234
v_add_f32 v242, v242, v234
v_add_f32 v243, v243, v234
v_mfma_f32_32x32x16_bf16 v[208:223], a[124:127], v[96:99], v[208:223]
ds_read_b64_tr_b16 a[152:153], v230 offset:2048
ds_read_b64_tr_b16 a[154:155], v230 offset:2560
v_cvt_pk_bf16_f32 v126, v240, v241
v_cvt_pk_bf16_f32 v127, v242, v243
s_waitcnt lgkmcnt(8)
v_mfma_f32_32x32x16_bf16 a[0:15], a[128:131], v[96:99], a[0:15]
ds_read_b64_tr_b16 a[156:157], v231 offset:3072
ds_read_b64_tr_b16 a[158:159], v231 offset:3584
v_mfma_f32_32x32x16_bf16 a[16:31], a[132:135], v[96:99], a[16:31]
ds_read_b64_tr_b16 a[160:161], v232 offset:3072
ds_read_b64_tr_b16 a[162:163], v232 offset:3584
v_mfma_f32_32x32x16_bf16 a[32:47], a[136:139], v[96:99], a[32:47]
ds_read_b64_tr_b16 a[164:165], v233 offset:3072
ds_read_b64_tr_b16 a[166:167], v233 offset:3584
s_waitcnt lgkmcnt(6)
v_mfma_f32_32x32x16_bf16 v[160:175], a[140:143], v[100:103], v[160:175]
v_lshlrev_b32 v240, 16, v128
v_and_b32 v241, s67, v128
v_lshlrev_b32 v242, 16, v129
v_and_b32 v243, s67, v129
v_add_f32 v240, v240, v234
v_mfma_f32_32x32x16_bf16 v[176:191], a[144:147], v[100:103], v[176:191]
s_waitcnt vmcnt(5)
s_barrier
ds_read_b64_tr_b16 a[112:113], v227 offset:16384
ds_read_b64_tr_b16 a[114:115], v227 offset:16896
ds_read_b64_tr_b16 a[116:117], v228 offset:16384
ds_read_b64_tr_b16 a[118:119], v228 offset:16896
v_mfma_f32_32x32x16_bf16 v[192:207], a[148:151], v[100:103], v[192:207]
ds_read_b64_tr_b16 a[120:121], v229 offset:16384
ds_read_b64_tr_b16 a[122:123], v229 offset:16896
s_add_u32 m0, s60, 49152
s_nop 0
buffer_load_dwordx4 v225, s[28:31], s55 offen lds
s_add_u32 s55, s55, s58
v_mfma_f32_32x32x16_bf16 v[208:223], a[152:155], v[100:103], v[208:223]
ds_read_b64_tr_b16 a[124:125], v230 offset:16384
ds_read_b64_tr_b16 a[126:127], v230 offset:16896
buffer_load_dwordx4 v226, s[32:35], s56 offen offset:1024 lds
s_add_u32 s56, s56, 59392
s_waitcnt lgkmcnt(8)
v_mfma_f32_32x32x16_bf16 a[0:15], a[156:159], v[100:103], a[0:15]
ds_read_b64_tr_b16 a[128:129], v231 offset:17408
ds_read_b64_tr_b16 a[130:131], v231 offset:17920
v_add_f32 v241, v241, v234
v_add_f32 v242, v242, v234
v_add_f32 v243, v243, v234
v_mfma_f32_32x32x16_bf16 a[16:31], a[160:163], v[100:103], a[16:31]
ds_read_b64_tr_b16 a[132:133], v232 offset:17408
ds_read_b64_tr_b16 a[134:135], v232 offset:17920
v_cvt_pk_bf16_f32 v128, v240, v241
v_cvt_pk_bf16_f32 v129, v242, v243
v_lshlrev_b32 v240, 16, v130
v_mfma_f32_32x32x16_bf16 a[32:47], a[164:167], v[100:103], a[32:47]
ds_read_b64_tr_b16 a[136:137], v233 offset:17408
ds_read_b64_tr_b16 a[138:139], v233 offset:17920
v_and_b32 v241, s67, v130
v_lshlrev_b32 v242, 16, v131
v_and_b32 v243, s67, v131
s_waitcnt lgkmcnt(6)
v_mfma_f32_32x32x16_bf16 v[160:175], a[112:115], v[104:107], v[160:175]
ds_read_b64_tr_b16 a[140:141], v227 offset:18432
ds_read_b64_tr_b16 a[142:143], v227 offset:18944
buffer_load_dwordx4 v225, s[28:31], s55 offen offset:2048 lds
s_add_u32 s55, s55, s59
buffer_load_dwordx4 v226, s[32:35], s56 offen offset:3072 lds
v_mfma_f32_32x32x16_bf16 v[176:191], a[116:119], v[104:107], v[176:191]
ds_read_b64_tr_b16 a[144:145], v228 offset:18432
ds_read_b64_tr_b16 a[146:147], v228 offset:18944
s_add_u32 s56, s56, 63488
v_mfma_f32_32x32x16_bf16 v[192:207], a[120:123], v[104:107], v[192:207]
ds_read_b64_tr_b16 a[148:149], v229 offset:18432
ds_read_b64_tr_b16 a[150:151], v229 offset:18944
s_cmp_eq_u32 s23, 8
s_cselect_b32 s21, s20, 0
s_cselect_b32 s1, 2457600, 0
v_mfma_f32_32x32x16_bf16 v[208:223], a[124:127], v[104:107], v[208:223]
ds_read_b64_tr_b16 a[152:153], v230 offset:18432
ds_read_b64_tr_b16 a[154:155], v230 offset:18944
s_sub_u32 s55, s55, s21
s_sub_u32 s56, s56, s1
s_waitcnt lgkmcnt(8)
v_mfma_f32_32x32x16_bf16 a[0:15], a[128:131], v[104:107], a[0:15]
ds_read_b64_tr_b16 a[156:157], v231 offset:19456
ds_read_b64_tr_b16 a[158:159], v231 offset:19968
v_add_f32 v240, v240, v234
v_add_f32 v241, v241, v234
v_add_f32 v242, v242, v234
v_mfma_f32_32x32x16_bf16 a[16:31], a[132:135], v[104:107], a[16:31]
ds_read_b64_tr_b16 a[160:161], v232 offset:19456
ds_read_b64_tr_b16 a[162:163], v232 offset:19968
v_add_f32 v243, v243, v234
v_cvt_pk_bf16_f32 v130, v240, v241
v_cvt_pk_bf16_f32 v131, v242, v243
v_mfma_f32_32x32x16_bf16 a[32:47], a[136:139], v[104:107], a[32:47]
ds_read_b64_tr_b16 a[164:165], v233 offset:19456
ds_read_b64_tr_b16 a[166:167], v233 offset:19968
s_waitcnt lgkmcnt(6)
v_mfma_f32_32x32x16_bf16 v[160:175], a[140:143], v[108:111], v[160:175]
v_lshlrev_b32 v240, 16, v132
v_and_b32 v241, s67, v132
v_lshlrev_b32 v242, 16, v133
v_and_b32 v243, s67, v133
v_add_f32 v240, v240, v234
v_mfma_f32_32x32x16_bf16 v[176:191], a[144:147], v[108:111], v[176:191]
s_waitcnt vmcnt(4)
s_mov_b32 s70, 0
L_pq_3:
v_xor_b32 v244, s4, v244
v_xor_b32 v245, s4, v245
v_xor_b32 v246, s4, v246
v_xor_b32 v247, s4, v247
v_or3_b32 v244, v244, v245, v246
v_or_b32 v244, v244, v247
v_cmp_ne_u32 vcc, 0, v244
s_nop 3
s_and_b64 vcc, vcc, exec
s_cbranch_scc0 L_pd_4
s_add_u32 s70, s70, 1
s_cmp_ge_u32 s70, 200000
s_cbranch_scc1 L_pd_4
s_sleep 2
s_mov_b32 s72, 20596864
buffer_load_dwordx4 v[244:247], v248, s[36:39], s72 offen sc1
s_waitcnt vmcnt(0)
s_branch L_pq_3
L_pd_4:
s_barrier
s_lshl_b32 s72, s3, 8
s_add_u32 s72, s72, s2
s_cmp_eq_u32 s72, 0
s_mov_b32 s72, 2146435072
s_cselect_b32 s72, 20594688, s72
v_lshlrev_b32 v254, 25, v224
v_mov_b32 v255, s4
buffer_store_dword v255, v254, s[36:39], s72 offen sc1
v_lshlrev_b32 v249, 4, v224
s_mul_i32 s17, s3, 21504
s_mul_i32 s16, s8, 102400
s_add_u32 s16, s16, 19775488
s_add_u32 s16, s16, s17
s_add_u32 s17, s17, 77824
ds_read_b64_tr_b16 a[112:113], v227 offset:32768
ds_read_b64_tr_b16 a[114:115], v227 offset:33280
ds_read_b64_tr_b16 a[116:117], v228 offset:32768
ds_read_b64_tr_b16 a[118:119], v228 offset:33280
v_mfma_f32_32x32x16_bf16 v[192:207], a[148:151], v[108:111], v[192:207]
ds_read_b64_tr_b16 a[120:121], v229 offset:32768
ds_read_b64_tr_b16 a[122:123], v229 offset:33280
s_add_u32 s74, s16, 0
s_add_u32 m0, s17, 0
s_nop 0
buffer_load_dwordx4 v249, s[36:39], s74 offen sc1 lds
v_mfma_f32_32x32x16_bf16 v[208:223], a[152:155], v[108:111], v[208:223]
ds_read_b64_tr_b16 a[124:125], v230 offset:32768
ds_read_b64_tr_b16 a[126:127], v230 offset:33280
s_add_u32 m0, s60, 0
s_nop 0
buffer_load_dwordx4 v225, s[28:31], s55 offen lds
s_waitcnt lgkmcnt(8)
v_mfma_f32_32x32x16_bf16 a[0:15], a[156:159], v[108:111], a[0:15]
ds_read_b64_tr_b16 a[128:129], v231 offset:33792
ds_read_b64_tr_b16 a[130:131], v231 offset:34304
s_add_u32 s55, s55, s58
buffer_load_dwordx4 v226, s[32:35], s56 offen offset:1024 lds
s_add_u32 s56, s56, 59392
v_mfma_f32_32x32x16_bf16 a[16:31], a[160:163], v[108:111], a[16:31]
ds_read_b64_tr_b16 a[132:133], v232 offset:33792
ds_read_b64_tr_b16 a[134:135], v232 offset:34304
v_add_f32 v241, v241, v234
v_add_f32 v242, v242, v234
v_add_f32 v243, v243, v234
v_mfma_f32_32x32x16_bf16 a[32:47], a[164:167], v[108:111], a[32:47]
ds_read_b64_tr_b16 a[136:137], v233 offset:33792
ds_read_b64_tr_b16 a[138:139], v233 offset:34304
v_cvt_pk_bf16_f32 v132, v240, v241
v_cvt_pk_bf16_f32 v133, v242, v243
v_lshlrev_b32 v240, 16, v134
s_waitcnt lgkmcnt(6)
v_mfma_f32_32x32x16_bf16 v[160:175], a[112:115], v[112:115], v[160:175]
ds_read_b64_tr_b16 a[140:141], v227 offset:34816
ds_read_b64_tr_b16 a[142:143], v227 offset:35328
buffer_load_dwordx4 v225, s[28:31], s55 offen offset:2048 lds
s_add_u32 s55, s55, s59
buffer_load_dwordx4 v226, s[32:35], s56 offen offset:3072 lds
v_mfma_f32_32x32x16_bf16 v[176:191], a[116:119], v[112:115], v[176:191]
ds_read_b64_tr_b16 a[144:145], v228 offset:34816
ds_read_b64_tr_b16 a[146:147], v228 offset:35328
s_add_u32 s56, s56, 63488
s_add_u32 s74, s16, 1024
s_add_u32 m0, s17, 1024
v_mfma_f32_32x32x16_bf16 v[192:207], a[120:123], v[112:115], v[192:207]
ds_read_b64_tr_b16 a[148:149], v229 offset:34816
ds_read_b64_tr_b16 a[150:151], v229 offset:35328
buffer_load_dwordx4 v249, s[36:39], s74 offen sc1 lds
v_and_b32 v241, s67, v134
v_lshlrev_b32 v242, 16, v135
v_mfma_f32_32x32x16_bf16 v[208:223], a[124:127], v[112:115], v[208:223]
ds_read_b64_tr_b16 a[152:153], v230 offset:34816
ds_read_b64_tr_b16 a[154:155], v230 offset:35328
v_and_b32 v243, s67, v135
v_add_f32 v240, v240, v234
s_waitcnt lgkmcnt(8)
v_mfma_f32_32x32x16_bf16 a[0:15], a[128:131], v[112:115], a[0:15]
ds_read_b64_tr_b16 a[156:157], v231 offset:35840
ds_read_b64_tr_b16 a[158:159], v231 offset:36352
v_add_f32 v241, v241, v234
v_add_f32 v242, v242, v234
v_add_f32 v243, v243, v234
v_mfma_f32_32x32x16_bf16 a[16:31], a[132:135], v[112:115], a[16:31]
ds_read_b64_tr_b16 a[160:161], v232 offset:35840
ds_read_b64_tr_b16 a[162:163], v232 offset:36352
v_cvt_pk_bf16_f32 v134, v240, v241
v_cvt_pk_bf16_f32 v135, v242, v243
v_mfma_f32_32x32x16_bf16 a[32:47], a[136:139], v[112:115], a[32:47]
ds_read_b64_tr_b16 a[164:165], v233 offset:35840
ds_read_b64_tr_b16 a[166:167], v233 offset:36352
s_waitcnt lgkmcnt(6)
v_mfma_f32_32x32x16_bf16 v[160:175], a[140:143], v[116:119], v[160:175]
v_lshlrev_b32 v240, 16, v136
v_and_b32 v241, s67, v136
v_lshlrev_b32 v242, 16, v137
v_and_b32 v243, s67, v137
v_add_f32 v240, v240, v234
v_mfma_f32_32x32x16_bf16 v[176:191], a[144:147], v[116:119], v[176:191]
s_waitcnt vmcnt(7)
s_barrier
ds_read_b64_tr_b16 a[112:113], v227 offset:49152
ds_read_b64_tr_b16 a[114:115], v227 offset:49664
ds_read_b64_tr_b16 a[116:117], v228 offset:49152
ds_read_b64_tr_b16 a[118:119], v228 offset:49664
v_mfma_f32_32x32x16_bf16 v[192:207], a[148:151], v[116:119], v[192:207]
ds_read_b64_tr_b16 a[120:121], v229 offset:49152
ds_read_b64_tr_b16 a[122:123], v229 offset:49664
s_add_u32 s74, s16, 2048
s_add_u32 m0, s17, 2048
s_nop 0
buffer_load_dwordx4 v249, s[36:39], s74 offen sc1 lds
v_mfma_f32_32x32x16_bf16 v[208:223], a[152:155], v[116:119], v[208:223]
ds_read_b64_tr_b16 a[124:125], v230 offset:49152
ds_read_b64_tr_b16 a[126:127], v230 offset:49664
s_add_u32 m0, s60, 16384
s_nop 0
buffer_load_dwordx4 v225, s[28:31], s55 offen lds
s_waitcnt lgkmcnt(8)
v_mfma_f32_32x32x16_bf16 a[0:15], a[156:159], v[116:119], a[0:15]
ds_read_b64_tr_b16 a[128:129], v231 offset:50176
ds_read_b64_tr_b16 a[130:131], v231 offset:50688
s_add_u32 s55, s55, s58
buffer_load_dwordx4 v226, s[32:35], s56 offen offset:1024 lds
s_add_u32 s56, s56, 59392
v_mfma_f32_32x32x16_bf16 a[16:31], a[160:163], v[116:119], a[16:31]
ds_read_b64_tr_b16 a[132:133], v232 offset:50176
ds_read_b64_tr_b16 a[134:135], v232 offset:50688
v_add_f32 v241, v241, v234
v_add_f32 v242, v242, v234
v_add_f32 v243, v243, v234
v_mfma_f32_32x32x16_bf16 a[32:47], a[164:167], v[116:119], a[32:47]
ds_read_b64_tr_b16 a[136:137], v233 offset:50176
ds_read_b64_tr_b16 a[138:139], v233 offset:50688
v_cvt_pk_bf16_f32 v136, v240, v241
v_cvt_pk_bf16_f32 v137, v242, v243
v_lshlrev_b32 v240, 16, v138
s_waitcnt lgkmcnt(6)
v_mfma_f32_32x32x16_bf16 v[160:175], a[112:115], v[120:123], v[160:175]
ds_read_b64_tr_b16 a[140:141], v227 offset:51200
ds_read_b64_tr_b16 a[142:143], v227 offset:51712
buffer_load_dwordx4 v225, s[28:31], s55 offen offset:2048 lds
s_add_u32 s55, s55, s59
buffer_load_dwordx4 v226, s[32:35], s56 offen offset:3072 lds
v_mfma_f32_32x32x16_bf16 v[176:191], a[116:119], v[120:123], v[176:191]
ds_read_b64_tr_b16 a[144:145], v228 offset:51200
ds_read_b64_tr_b16 a[146:147], v228 offset:51712
s_add_u32 s56, s56, 63488
v_mfma_f32_32x32x16_bf16 v[192:207], a[120:123], v[120:123], v[192:207]
ds_read_b64_tr_b16 a[148:149], v229 offset:51200
ds_read_b64_tr_b16 a[150:151], v229 offset:51712
s_cmp_eq_u32 s23, 9
s_cselect_b32 s21, s20, 0
s_cselect_b32 s1, 2457600, 0
v_mfma_f32_32x32x16_bf16 v[208:223], a[124:127], v[120:123], v[208:223]
ds_read_b64_tr_b16 a[152:153], v230 offset:51200
ds_read_b64_tr_b16 a[154:155], v230 offset:51712
s_sub_u32 s55, s55, s21
s_sub_u32 s56, s56, s1
s_waitcnt lgkmcnt(8)
v_mfma_f32_32x32x16_bf16 a[0:15], a[128:131], v[120:123], a[0:15]
ds_read_b64_tr_b16 a[156:157], v231 offset:52224
ds_read_b64_tr_b16 a[158:159], v231 offset:52736
s_add_u32 s74, s16, 3072
s_add_u32 m0, s17, 3072
s_nop 0
buffer_load_dwordx4 v249, s[36:39], s74 offen sc1 lds
v_mfma_f32_32x32x16_bf16 a[16:31], a[132:135], v[120:123], a[16:31]
ds_read_b64_tr_b16 a[160:161], v232 offset:52224
ds_read_b64_tr_b16 a[162:163], v232 offset:52736
v_and_b32 v241, s67, v138
v_lshlrev_b32 v242, 16, v139
v_and_b32 v243, s67, v139
v_mfma_f32_32x32x16_bf16 a[32:47], a[136:139], v[120:123], a[32:47]
ds_read_b64_tr_b16 a[164:165], v233 offset:52224
ds_read_b64_tr_b16 a[166:167], v233 offset:52736
v_add_f32 v240, v240, v234
v_add_f32 v241, v241, v234
v_add_f32 v242, v242, v234
s_waitcnt lgkmcnt(6)
v_mfma_f32_32x32x16_bf16 v[160:175], a[140:143], v[124:127], v[160:175]
v_add_f32 v243, v243, v234
v_cvt_pk_bf16_f32 v138, v240, v241
v_cvt_pk_bf16_f32 v139, v242, v243
v_lshlrev_b32 v240, 16, v140
v_and_b32 v241, s67, v140
v_mfma_f32_32x32x16_bf16 v[176:191], a[144:147], v[124:127], v[176:191]
s_waitcnt vmcnt(7)
s_barrier
ds_read_b64_tr_b16 a[112:113], v227 offset:0
ds_read_b64_tr_b16 a[114:115], v227 offset:512
ds_read_b64_tr_b16 a[116:117], v228 offset:0
ds_read_b64_tr_b16 a[118:119], v228 offset:512
v_mfma_f32_32x32x16_bf16 v[192:207], a[148:151], v[124:127], v[192:207]
ds_read_b64_tr_b16 a[120:121], v229 offset:0
ds_read_b64_tr_b16 a[122:123], v229 offset:512
s_add_u32 s74, s16, 4096
s_add_u32 m0, s17, 4096
s_nop 0
buffer_load_dwordx4 v249, s[36:39], s74 offen sc1 lds
v_mfma_f32_32x32x16_bf16 v[208:223], a[152:155], v[124:127], v[208:223]
ds_read_b64_tr_b16 a[124:125], v230 offset:0
ds_read_b64_tr_b16 a[126:127], v230 offset:512
s_add_u32 m0, s60, 32768
s_nop 0
buffer_load_dwordx4 v225, s[28:31], s55 offen lds
s_waitcnt lgkmcnt(8)
v_mfma_f32_32x32x16_bf16 a[0:15], a[156:159], v[124:127], a[0:15]
ds_read_b64_tr_b16 a[128:129], v231 offset:1024
ds_read_b64_tr_b16 a[130:131], v231 offset:1536
s_add_u32 s55, s55, s58
buffer_load_dwordx4 v226, s[32:35], s56 offen offset:1024 lds
s_add_u32 s56, s56, 59392
v_mfma_f32_32x32x16_bf16 a[16:31], a[160:163], v[124:127], a[16:31]
ds_read_b64_tr_b16 a[132:133], v232 offset:1024
ds_read_b64_tr_b16 a[134:135], v232 offset:1536
v_lshlrev_b32 v242, 16, v141
v_and_b32 v243, s67, v141
v_add_f32 v240, v240, v234
v_mfma_f32_32x32x16_bf16 a[32:47], a[164:167], v[124:127], a[32:47]
ds_read_b64_tr_b16 a[136:137], v233 offset:1024
ds_read_b64_tr_b16 a[138:139], v233 offset:1536
v_add_f32 v241, v241, v234
v_add_f32 v242, v242, v234
v_add_f32 v243, v243, v234
s_waitcnt lgkmcnt(6)
v_mfma_f32_32x32x16_bf16 v[160:175], a[112:115], v[128:131], v[160:175]
ds_read_b64_tr_b16 a[140:141], v227 offset:2048
ds_read_b64_tr_b16 a[142:143], v227 offset:2560
buffer_load_dwordx4 v225, s[28:31], s55 offen offset:2048 lds
s_add_u32 s55, s55, s59
buffer_load_dwordx4 v226, s[32:35], s56 offen offset:3072 lds
v_mfma_f32_32x32x16_bf16 v[176:191], a[116:119], v[128:131], v[176:191]
ds_read_b64_tr_b16 a[144:145], v228 offset:2048
ds_read_b64_tr_b16 a[146:147], v228 offset:2560
s_add_u32 s56, s56, 63488
s_add_u32 s74, s16, 5120
s_add_u32 m0, s17, 5120
v_mfma_f32_32x32x16_bf16 v[192:207], a[120:123], v[128:131], v[192:207]
ds_read_b64_tr_b16 a[148:149], v229 offset:2048
ds_read_b64_tr_b16 a[150:151], v229 offset:2560
buffer_load_dwordx4 v249, s[36:39], s74 offen sc1 lds
v_cvt_pk_bf16_f32 v140, v240, v241
v_cvt_pk_bf16_f32 v141, v242, v243
v_mfma_f32_32x32x16_bf16 v[208:223], a[124:127], v[128:131], v[208:223]
ds_read_b64_tr_b16 a[152:153], v230 offset:2048
ds_read_b64_tr_b16 a[154:155], v230 offset:2560
v_lshlrev_b32 v240, 16, v142
v_and_b32 v241, s67, v142
s_waitcnt lgkmcnt(8)
v_mfma_f32_32x32x16_bf16 a[0:15], a[128:131], v[128:131], a[0:15]
ds_read_b64_tr_b16 a[156:157], v231 offset:3072
ds_read_b64_tr_b16 a[158:159], v231 offset:3584
v_lshlrev_b32 v242, 16, v143
v_and_b32 v243, s67, v143
v_add_f32 v240, v240, v234
v_mfma_f32_32x32x16_bf16 a[16:31], a[132:135], v[128:131], a[16:31]
ds_read_b64_tr_b16 a[160:161], v232 offset:3072
ds_read_b64_tr_b16 a[162:163], v232 offset:3584
v_add_f32 v241, v241, v234
v_add_f32 v242, v242, v234
v_add_f32 v243, v243, v234
v_mfma_f32_32x32x16_bf16 a[32:47], a[136:139], v[128:131], a[32:47]
ds_read_b64_tr_b16 a[164:165], v233 offset:3072
ds_read_b64_tr_b16 a[166:167], v233 offset:3584
v_cvt_pk_bf16_f32 v142, v240, v241
v_cvt_pk_bf16_f32 v143, v242, v243
v_lshlrev_b32 v240, 16, v144
s_waitcnt lgkmcnt(6)
v_mfma_f32_32x32x16_bf16 v[160:175], a[140:143], v[132:135], v[160:175]
v_and_b32 v241, s67, v144
v_lshlrev_b32 v242, 16, v145
v_and_b32 v243, s67, v145
v_add_f32 v240, v240, v234
v_add_f32 v241, v241, v234
v_mfma_f32_32x32x16_bf16 v[176:191], a[144:147], v[132:135], v[176:191]
s_waitcnt vmcnt(7)
s_barrier
s_getpc_b64 s[72:73]
L_pc_5:
s_lshr_b32 s70, s2, 3
s_lshl_b32 s70, s70, 2
s_add_u32 s70, s70, s3
s_lshl_b32 s70, s70, 7
s_add_u32 s70, s70, 2048
v_and_b32 v253, 3, v224
v_lshlrev_b32 v253, 14, v253
v_add_u32 v253, s70, v253
v_min_u32 v253, L_end_of_code-L_pc_5-4, v253
global_load_dword a255, v253, s[72:73]
ds_read_b64_tr_b16 a[112:113], v227 offset:16384
ds_read_b64_tr_b16 a[114:115], v227 offset:16896
ds_read_b64_tr_b16 a[116:117], v228 offset:16384
ds_read_b64_tr_b16 a[118:119], v228 offset:16896
v_mfma_f32_32x32x16_bf16 v[192:207], a[148:151], v[132:135], v[192:207]
ds_read_b64_tr_b16 a[120:121], v229 offset:16384
ds_read_b64_tr_b16 a[122:123], v229 offset:16896
s_add_u32 s74, s16, 6144
s_add_u32 m0, s17, 6144
s_nop 0
buffer_load_dwordx4 v249, s[36:39], s74 offen sc1 lds
v_mfma_f32_32x32x16_bf16 v[208:223], a[152:155], v[132:135], v[208:223]
ds_read_b64_tr_b16 a[124:125], v230 offset:16384
ds_read_b64_tr_b16 a[126:127], v230 offset:16896
s_add_u32 m0, s60, 49152
s_nop 0
buffer_load_dwordx4 v225, s[28:31], s55 offen lds
s_waitcnt lgkmcnt(8)
v_mfma_f32_32x32x16_bf16 a[0:15], a[156:159], v[132:135], a[0:15]
ds_read_b64_tr_b16 a[128:129], v231 offset:17408
ds_read_b64_tr_b16 a[130:131], v231 offset:17920
s_add_u32 s55, s55, s58
buffer_load_dwordx4 v226, s[32:35], s56 offen offset:1024 lds
s_add_u32 s56, s56, 59392
v_mfma_f32_32x32x16_bf16 a[16:31], a[160:163], v[132:135], a[16:31]
ds_read_b64_tr_b16 a[132:133], v232 offset:17408
ds_read_b64_tr_b16 a[134:135], v232 offset:17920
v_add_f32 v242, v242, v234
v_add_f32 v243, v243, v234
v_cvt_pk_bf16_f32 v144, v240, v241
v_mfma_f32_32x32x16_bf16 a[32:47], a[164:167], v[132:135], a[32:47]
ds_read_b64_tr_b16 a[136:137], v233 offset:17408
ds_read_b64_tr_b16 a[138:139], v233 offset:17920
v_cvt_pk_bf16_f32 v145, v242, v243
v_lshlrev_b32 v240, 16, v146
v_and_b32 v241, s67, v146
s_waitcnt lgkmcnt(6)
v_mfma_f32_32x32x16_bf16 v[160:175], a[112:115], v[136:139], v[160:175]
ds_read_b64_tr_b16 a[140:141], v227 offset:18432
ds_read_b64_tr_b16 a[142:143], v227 offset:18944
buffer_load_dwordx4 v225, s[28:31], s55 offen offset:2048 lds
s_add_u32 s55, s55, s59
buffer_load_dwordx4 v226, s[32:35], s56 offen offset:3072 lds
v_mfma_f32_32x32x16_bf16 v[176:191], a[116:119], v[136:139], v[176:191]
ds_read_b64_tr_b16 a[144:145], v228 offset:18432
ds_read_b64_tr_b16 a[146:147], v228 offset:18944
s_add_u32 s56, s56, 63488
s_add_u32 s74, s16, 7168
s_add_u32 m0, s17, 7168
v_mfma_f32_32x32x16_bf16 v[192:207], a[120:123], v[136:139], v[192:207]
ds_read_b64_tr_b16 a[148:149], v229 offset:18432
ds_read_b64_tr_b16 a[150:151], v229 offset:18944
buffer_load_dwordx4 v249, s[36:39], s74 offen sc1 lds
v_lshlrev_b32 v242, 16, v147
v_and_b32 v243, s67, v147
v_mfma_f32_32x32x16_bf16 v[208:223], a[124:127], v[136:139], v[208:223]
ds_read_b64_tr_b16 a[152:153], v230 offset:18432
ds_read_b64_tr_b16 a[154:155], v230 offset:18944
v_add_f32 v240, v240, v234
v_add_f32 v241, v241, v234
s_waitcnt lgkmcnt(8)
v_mfma_f32_32x32x16_bf16 a[0:15], a[128:131], v[136:139], a[0:15]
ds_read_b64_tr_b16 a[156:157], v231 offset:19456
ds_read_b64_tr_b16 a[158:159], v231 offset:19968
v_add_f32 v242, v242, v234
v_add_f32 v243, v243, v234
v_cvt_pk_bf16_f32 v146, v240, v241
v_mfma_f32_32x32x16_bf16 a[16:31], a[132:135], v[136:139], a[16:31]
ds_read_b64_tr_b16 a[160:161], v232 offset:19456
ds_read_b64_tr_b16 a[162:163], v232 offset:19968
v_cvt_pk_bf16_f32 v147, v242, v243
v_lshlrev_b32 v240, 16, v148
v_and_b32 v241, s67, v148
v_mfma_f32_32x32x16_bf16 a[32:47], a[136:139], v[136:139], a[32:47]
ds_read_b64_tr_b16 a[164:165], v233 offset:19456
ds_read_b64_tr_b16 a[166:167], v233 offset:19968
v_lshlrev_b32 v242, 16, v149
v_and_b32 v243, s67, v149
v_add_f32 v240, v240, v234
s_waitcnt lgkmcnt(6)
v_mfma_f32_32x32x16_bf16 v[160:175], a[140:143], v[140:143], v[160:175]
v_add_f32 v241, v241, v234
v_add_f32 v242, v242, v234
v_add_f32 v243, v243, v234
v_cvt_pk_bf16_f32 v148, v240, v241
v_cvt_pk_bf16_f32 v149, v242, v243
v_mfma_f32_32x32x16_bf16 v[176:191], a[144:147], v[140:143], v[176:191]
s_waitcnt vmcnt(8)
s_barrier
ds_read_b64_tr_b16 a[112:113], v227 offset:32768
ds_read_b64_tr_b16 a[114:115], v227 offset:33280
ds_read_b64_tr_b16 a[116:117], v228 offset:32768
ds_read_b64_tr_b16 a[118:119], v228 offset:33280
v_mfma_f32_32x32x16_bf16 v[192:207], a[148:151], v[140:143], v[192:207]
ds_read_b64_tr_b16 a[120:121], v229 offset:32768
ds_read_b64_tr_b16 a[122:123], v229 offset:33280
s_add_u32 s74, s16, 8192
s_add_u32 m0, s17, 8192
s_nop 0
buffer_load_dwordx4 v249, s[36:39], s74 offen sc1 lds
v_mfma_f32_32x32x16_bf16 v[208:223], a[152:155], v[140:143], v[208:223]
ds_read_b64_tr_b16 a[124:125], v230 offset:32768
ds_read_b64_tr_b16 a[126:127], v230 offset:33280
s_add_u32 m0, s60, 0
s_nop 0
buffer_load_dwordx4 v250, s[96:99], s57 offen lds
s_waitcnt lgkmcnt(8)
v_mfma_f32_32x32x16_bf16 a[0:15], a[156:159], v[140:143], a[0:15]
ds_read_b64_tr_b16 a[128:129], v231 offset:33792
ds_read_b64_tr_b16 a[130:131], v231 offset:34304
s_add_u32 s57, s57, s18
buffer_load_dwordx4 v250, s[96:99], s57 offen offset:1024 lds
s_add_u32 s57, s57, s18
v_mfma_f32_32x32x16_bf16 a[16:31], a[160:163], v[140:143], a[16:31]
ds_read_b64_tr_b16 a[132:133], v232 offset:33792
ds_read_b64_tr_b16 a[134:135], v232 offset:34304
v_lshlrev_b32 v240, 16, v150
v_and_b32 v241, s67, v150
v_lshlrev_b32 v242, 16, v151
v_mfma_f32_32x32x16_bf16 a[32:47], a[164:167], v[140:143], a[32:47]
ds_read_b64_tr_b16 a[136:137], v233 offset:33792
ds_read_b64_tr_b16 a[138:139], v233 offset:34304
v_and_b32 v243, s67, v151
v_add_f32 v240, v240, v234
v_add_f32 v241, v241, v234
s_waitcnt lgkmcnt(6)
v_mfma_f32_32x32x16_bf16 v[160:175], a[112:115], v[144:147], v[160:175]
ds_read_b64_tr_b16 a[140:141], v227 offset:34816
ds_read_b64_tr_b16 a[142:143], v227 offset:35328
buffer_load_dwordx4 v250, s[96:99], s57 offen offset:2048 lds
s_add_u32 s57, s57, s18
buffer_load_dwordx4 v250, s[96:99], s57 offen offset:3072 lds
v_mfma_f32_32x32x16_bf16 v[176:191], a[116:119], v[144:147], v[176:191]
ds_read_b64_tr_b16 a[144:145], v228 offset:34816
ds_read_b64_tr_b16 a[146:147], v228 offset:35328
s_add_u32 s57, s57, s19
s_cmp_eq_u32 s23, 1
s_cselect_b32 s21, s66, 0
v_mfma_f32_32x32x16_bf16 v[192:207], a[120:123], v[144:147], v[192:207]
ds_read_b64_tr_b16 a[148:149], v229 offset:34816
ds_read_b64_tr_b16 a[150:151], v229 offset:35328
s_sub_u32 s57, s57, s21
s_add_u32 s74, s16, 9216
s_add_u32 m0, s17, 9216
v_mfma_f32_32x32x16_bf16 v[208:223], a[124:127], v[144:147], v[208:223]
ds_read_b64_tr_b16 a[152:153], v230 offset:34816
ds_read_b64_tr_b16 a[154:155], v230 offset:35328
buffer_load_dwordx4 v249, s[36:39], s74 offen sc1 lds
v_add_f32 v242, v242, v234
s_waitcnt lgkmcnt(8)
v_mfma_f32_32x32x16_bf16 a[0:15], a[128:131], v[144:147], a[0:15]
ds_read_b64_tr_b16 a[156:157], v231 offset:35840
ds_read_b64_tr_b16 a[158:159], v231 offset:36352
v_add_f32 v243, v243, v234
v_cvt_pk_bf16_f32 v150, v240, v241
v_cvt_pk_bf16_f32 v151, v242, v243
v_mfma_f32_32x32x16_bf16 a[16:31], a[132:135], v[144:147], a[16:31]
ds_read_b64_tr_b16 a[160:161], v232 offset:35840
ds_read_b64_tr_b16 a[162:163], v232 offset:36352
v_lshlrev_b32 v240, 16, v152
v_and_b32 v241, s67, v152
v_lshlrev_b32 v242, 16, v153
v_mfma_f32_32x32x16_bf16 a[32:47], a[136:139], v[144:147], a[32:47]
ds_read_b64_tr_b16 a[164:165], v233 offset:35840
ds_read_b64_tr_b16 a[166:167], v233 offset:36352
v_and_b32 v243, s67, v153
v_add_f32 v240, v240, v234
v_add_f32 v241, v241, v234
s_waitcnt lgkmcnt(6)
v_mfma_f32_32x32x16_bf16 v[160:175], a[140:143], v[148:151], v[160:175]
v_add_f32 v242, v242, v234
v_add_f32 v243, v243, v234
v_cvt_pk_bf16_f32 v152, v240, v241
v_cvt_pk_bf16_f32 v153, v242, v243
v_lshlrev_b32 v240, 16, v154
v_mfma_f32_32x32x16_bf16 v[176:191], a[144:147], v[148:151], v[176:191]
s_waitcnt vmcnt(7)
s_barrier
ds_read_b64_tr_b16 a[112:113], v227 offset:49152
ds_read_b64_tr_b16 a[114:115], v227 offset:49664
ds_read_b64_tr_b16 a[116:117], v228 offset:49152
ds_read_b64_tr_b16 a[118:119], v228 offset:49664
v_mfma_f32_32x32x16_bf16 v[192:207], a[148:151], v[148:151], v[192:207]
ds_read_b64_tr_b16 a[120:121], v229 offset:49152
ds_read_b64_tr_b16 a[122:123], v229 offset:49664
s_add_u32 s74, s16, 10240
s_add_u32 m0, s17, 10240
s_nop 0
buffer_load_dwordx4 v249, s[36:39], s74 offen sc1 lds
v_mfma_f32_32x32x16_bf16 v[208:223], a[152:155], v[148:151], v[208:223]
ds_read_b64_tr_b16 a[124:125], v230 offset:49152
ds_read_b64_tr_b16 a[126:127], v230 offset:49664
s_add_u32 m0, s60, 16384
s_nop 0
buffer_load_dwordx4 v250, s[96:99], s57 offen lds
s_waitcnt lgkmcnt(8)
v_mfma_f32_32x32x16_bf16 a[0:15], a[156:159], v[148:151], a[0:15]
ds_read_b64_tr_b16 a[128:129], v231 offset:50176
ds_read_b64_tr_b16 a[130:131], v231 offset:50688
s_add_u32 s57, s57, s18
buffer_load_dwordx4 v250, s[96:99], s57 offen offset:1024 lds
s_add_u32 s57, s57, s18
v_mfma_f32_32x32x16_bf16 a[16:31], a[160:163], v[148:151], a[16:31]
ds_read_b64_tr_b16 a[132:133], v232 offset:50176
ds_read_b64_tr_b16 a[134:135], v232 offset:50688
v_and_b32 v241, s67, v154
v_lshlrev_b32 v242, 16, v155
v_and_b32 v243, s67, v155
v_mfma_f32_32x32x16_bf16 a[32:47], a[164:167], v[148:151], a[32:47]
ds_read_b64_tr_b16 a[136:137], v233 offset:50176
ds_read_b64_tr_b16 a[138:139], v233 offset:50688
v_add_f32 v240, v240, v234
v_add_f32 v241, v241, v234
v_add_f32 v242, v242, v234
v_add_f32 v243, v243, v234
v_cvt_pk_bf16_f32 v154, v240, v241
v_cvt_pk_bf16_f32 v155, v242, v243
s_waitcnt lgkmcnt(6)
s_nop 0
v_mfma_f32_32x32x16_bf16 v[160:175], a[112:115], v[152:155], v[160:175]
ds_read_b64_tr_b16 a[140:141], v227 offset:51200
ds_read_b64_tr_b16 a[142:143], v227 offset:51712
buffer_load_dwordx4 v250, s[96:99], s57 offen offset:2048 lds
s_add_u32 s57, s57, s18
buffer_load_dwordx4 v250, s[96:99], s57 offen offset:3072 lds
v_mfma_f32_32x32x16_bf16 v[176:191], a[116:119], v[152:155], v[176:191]
ds_read_b64_tr_b16 a[144:145], v228 offset:51200
ds_read_b64_tr_b16 a[146:147], v228 offset:51712
s_add_u32 s57, s57, s19
s_cmp_eq_u32 s23, 2
s_cselect_b32 s21, s66, 0
v_mfma_f32_32x32x16_bf16 v[192:207], a[120:123], v[152:155], v[192:207]
ds_read_b64_tr_b16 a[148:149], v229 offset:51200
ds_read_b64_tr_b16 a[150:151], v229 offset:51712
s_sub_u32 s57, s57, s21
s_add_u32 s74, s16, 11264
s_add_u32 m0, s17, 11264
v_mfma_f32_32x32x16_bf16 v[208:223], a[124:127], v[152:155], v[208:223]
ds_read_b64_tr_b16 a[152:153], v230 offset:51200
ds_read_b64_tr_b16 a[154:155], v230 offset:51712
buffer_load_dwordx4 v249, s[36:39], s74 offen sc1 lds
v_lshlrev_b32 v240, 16, v156
s_waitcnt lgkmcnt(8)
v_mfma_f32_32x32x16_bf16 a[0:15], a[128:131], v[152:155], a[0:15]
ds_read_b64_tr_b16 a[156:157], v231 offset:52224
ds_read_b64_tr_b16 a[158:159], v231 offset:52736
v_and_b32 v241, s67, v156
v_lshlrev_b32 v242, 16, v157
v_and_b32 v243, s67, v157
v_mfma_f32_32x32x16_bf16 a[16:31], a[132:135], v[152:155], a[16:31]
ds_read_b64_tr_b16 a[160:161], v232 offset:52224
ds_read_b64_tr_b16 a[162:163], v232 offset:52736
v_add_f32 v240, v240, v234
v_add_f32 v241, v241, v234
v_add_f32 v242, v242, v234
v_mfma_f32_32x32x16_bf16 a[32:47], a[136:139], v[152:155], a[32:47]
ds_read_b64_tr_b16 a[164:165], v233 offset:52224
ds_read_b64_tr_b16 a[166:167], v233 offset:52736
v_add_f32 v243, v243, v234
v_cvt_pk_bf16_f32 v156, v240, v241
v_cvt_pk_bf16_f32 v157, v242, v243
v_lshlrev_b32 v240, 16, v158
v_and_b32 v241, s67, v158
v_lshlrev_b32 v242, 16, v159
v_and_b32 v243, s67, v159
v_add_f32 v240, v240, v234
v_add_f32 v241, v241, v234
v_add_f32 v242, v242, v234
v_add_f32 v243, v243, v234
v_cvt_pk_bf16_f32 v158, v240, v241
v_cvt_pk_bf16_f32 v159, v242, v243
s_waitcnt lgkmcnt(6)
s_nop 0
v_mfma_f32_32x32x16_bf16 v[160:175], a[140:143], v[156:159], v[160:175]
v_mfma_f32_32x32x16_bf16 v[176:191], a[144:147], v[156:159], v[176:191]
s_waitcnt vmcnt(7)
s_barrier
v_mfma_f32_32x32x16_bf16 v[192:207], a[148:151], v[156:159], v[192:207]
s_add_u32 s74, s16, 12288
s_add_u32 m0, s17, 12288
s_nop 0
buffer_load_dwordx4 v249, s[36:39], s74 offen sc1 lds
s_add_u32 m0, s60, 32768
s_nop 0
buffer_load_dwordx4 v250, s[96:99], s57 offen lds
v_mfma_f32_32x32x16_bf16 v[208:223], a[152:155], v[156:159], v[208:223]
s_add_u32 s57, s57, s18
buffer_load_dwordx4 v250, s[96:99], s57 offen offset:1024 lds
s_add_u32 s57, s57, s18
s_waitcnt lgkmcnt(0)
v_mfma_f32_32x32x16_bf16 a[0:15], a[156:159], v[156:159], a[0:15]
v_mfma_f32_32x32x16_bf16 a[16:31], a[160:163], v[156:159], a[16:31]
v_mfma_f32_32x32x16_bf16 a[32:47], a[164:167], v[156:159], a[32:47]
buffer_load_dwordx4 v250, s[96:99], s57 offen offset:2048 lds
s_add_u32 s57, s57, s18
buffer_load_dwordx4 v250, s[96:99], s57 offen offset:3072 lds
s_add_u32 s57, s57, s19
s_cmp_eq_u32 s23, 3
s_cselect_b32 s21, s66, 0
s_sub_u32 s57, s57, s21
s_add_u32 s74, s16, 13312
s_add_u32 m0, s17, 13312
s_nop 0
buffer_load_dwordx4 v249, s[36:39], s74 offen sc1 lds
v_lshlrev_b32 v226, 4, v224
v_add_u32 v231, 4096, v226
s_mul_i32 s78, s3, 14
s_cmp_eq_u32 s3, 3
s_cselect_b32 s78, 41, s78
s_mov_b32 s9, s78
s_mul_i32 s70, s8, 54
s_add_u32 s78, s78, s70
s_mul_i32 s78, s78, 5120
s_add_u32 s78, s78, 17563648
s_lshr_b32 s70, s54, 6
s_mul_i32 s67, s70, 221184
s_lshr_b32 s70, s54, 4
s_and_b32 s70, s70, 2
s_lshl_b32 s70, s70, 10
s_add_u32 s67, s67, s70
s_add_u32 s67, s67, 7864320
v_bfe_u32 v240, v224, 4, 1
v_lshlrev_b32 v240, 10, v240
v_lshrrev_b32 v241, 5, v224
v_lshl_add_u32 v240, v241, 8, v240
v_and_b32 v241, 15, v224
v_lshl_add_u32 v233, v241, 4, v240
s_cmp_ge_u32 s53, 15
s_cbranch_scc1 L_typeC
s_cmp_ge_u32 s53, 13
s_cbranch_scc1 L_typeB
s_nop 7
s_nop 3
s_add_u32 s71, s62, 0
s_cmp_lt_u32 s71, 20
s_cselect_b32 s68, 0x3ea52b5c, 1.0
v_mul_f32 v248, s68, v235
s_lshl_b32 s69, s71, 17
s_lshl_b32 s68, s54, 4
s_add_u32 s69, s69, s68
v_accvgpr_read_b32 v240, a0
v_accvgpr_read_b32 v241, a1
v_accvgpr_read_b32 v242, a2
v_accvgpr_read_b32 v243, a3
v_accvgpr_read_b32 v244, a4
v_accvgpr_read_b32 v245, a5
v_accvgpr_read_b32 v246, a6
v_accvgpr_read_b32 v247, a7
v_pk_mul_f32 v[240:241], v[240:241], v[248:249] op_sel:[0,0] op_sel_hi:[1,0]
v_pk_mul_f32 v[242:243], v[242:243], v[248:249] op_sel:[0,0] op_sel_hi:[1,0]
v_pk_mul_f32 v[244:245], v[244:245], v[248:249] op_sel:[0,0] op_sel_hi:[1,0]
v_pk_mul_f32 v[246:247], v[246:247], v[248:249] op_sel:[0,0] op_sel_hi:[1,0]
v_cvt_pk_bf16_f32 v240, v240, v241
v_cvt_pk_bf16_f32 v241, v242, v243
v_cvt_pk_bf16_f32 v242, v244, v245
v_cvt_pk_bf16_f32 v243, v246, v247
s_nop 0
v_permlane32_swap_b32 v240, v242
v_permlane32_swap_b32 v241, v243
buffer_store_dwordx4 v[240:243], v239, s[36:39], s69 offen sc1
s_add_u32 s69, s69, 65536
s_nop 0
v_accvgpr_read_b32 v240, a8
v_accvgpr_read_b32 v241, a9
v_accvgpr_read_b32 v242, a10
v_accvgpr_read_b32 v243, a11
v_accvgpr_read_b32 v244, a12
v_accvgpr_read_b32 v245, a13
v_accvgpr_read_b32 v246, a14
v_accvgpr_read_b32 v247, a15
v_pk_mul_f32 v[240:241], v[240:241], v[248:249] op_sel:[0,0] op_sel_hi:[1,0]
v_pk_mul_f32 v[242:243], v[242:243], v[248:249] op_sel:[0,0] op_sel_hi:[1,0]
v_pk_mul_f32 v[244:245], v[244:245], v[248:249] op_sel:[0,0] op_sel_hi:[1,0]
v_pk_mul_f32 v[246:247], v[246:247], v[248:249] op_sel:[0,0] op_sel_hi:[1,0]
v_cvt_pk_bf16_f32 v240, v240, v241
v_cvt_pk_bf16_f32 v241, v242, v243
v_cvt_pk_bf16_f32 v242, v244, v245
v_cvt_pk_bf16_f32 v243, v246, v247
s_nop 0
v_permlane32_swap_b32 v240, v242
v_permlane32_swap_b32 v241, v243
buffer_store_dwordx4 v[240:243], v239, s[36:39], s69 offen sc1
s_add_u32 s71, s62, 1
s_cmp_lt_u32 s71, 20
s_cselect_b32 s68, 0x3ea52b5c, 1.0
v_mul_f32 v248, s68, v235
s_lshl_b32 s69, s71, 17
s_lshl_b32 s68, s54, 4
s_add_u32 s69, s69, s68
v_accvgpr_read_b32 v240, a16
v_accvgpr_read_b32 v241, a17
v_accvgpr_read_b32 v242, a18
v_accvgpr_read_b32 v243, a19
v_accvgpr_read_b32 v244, a20
v_accvgpr_read_b32 v245, a21
v_accvgpr_read_b32 v246, a22
v_accvgpr_read_b32 v247, a23
v_pk_mul_f32 v[240:241], v[240:241], v[248:249] op_sel:[0,0] op_sel_hi:[1,0]
v_pk_mul_f32 v[242:243], v[242:243], v[248:249] op_sel:[0,0] op_sel_hi:[1,0]
v_pk_mul_f32 v[244:245], v[244:245], v[248:249] op_sel:[0,0] op_sel_hi:[1,0]
v_pk_mul_f32 v[246:247], v[246:247], v[248:249] op_sel:[0,0] op_sel_hi:[1,0]
v_cvt_pk_bf16_f32 v240, v240, v241
v_cvt_pk_bf16_f32 v241, v242, v243
v_cvt_pk_bf16_f32 v242, v244, v245
v_cvt_pk_bf16_f32 v243, v246, v247
s_nop 0
v_permlane32_swap_b32 v240, v242
v_permlane32_swap_b32 v241, v243
buffer_store_dwordx4 v[240:243], v239, s[36:39], s69 offen sc1
s_add_u32 s69, s69, 65536
s_nop 0
v_accvgpr_read_b32 v240, a24
v_accvgpr_read_b32 v241, a25
v_accvgpr_read_b32 v242, a26
v_accvgpr_read_b32 v243, a27
v_accvgpr_read_b32 v244, a28
v_accvgpr_read_b32 v245, a29
v_accvgpr_read_b32 v246, a30
v_accvgpr_read_b32 v247, a31
v_pk_mul_f32 v[240:241], v[240:241], v[248:249] op_sel:[0,0] op_sel_hi:[1,0]
v_pk_mul_f32 v[242:243], v[242:243], v[248:249] op_sel:[0,0] op_sel_hi:[1,0]
v_pk_mul_f32 v[244:245], v[244:245], v[248:249] op_sel:[0,0] op_sel_hi:[1,0]
v_pk_mul_f32 v[246:247], v[246:247], v[248:249] op_sel:[0,0] op_sel_hi:[1,0]
v_cvt_pk_bf16_f32 v240, v240, v241
v_cvt_pk_bf16_f32 v241, v242, v243
v_cvt_pk_bf16_f32 v242, v244, v245
v_cvt_pk_bf16_f32 v243, v246, v247
s_nop 0
v_permlane32_swap_b32 v240, v242
v_permlane32_swap_b32 v241, v243
buffer_store_dwordx4 v[240:243], v239, s[36:39], s69 offen sc1
s_add_u32 s71, s62, 2
s_cmp_lt_u32 s71, 20
s_cselect_b32 s68, 0x3ea52b5c, 1.0
v_mul_f32 v248, s68, v235
s_lshl_b32 s69, s71, 17
s_lshl_b32 s68, s54, 4
s_add_u32 s69, s69, s68
v_accvgpr_read_b32 v240, a32
v_accvgpr_read_b32 v241, a33
v_accvgpr_read_b32 v242, a34
v_accvgpr_read_b32 v243, a35
v_accvgpr_read_b32 v244, a36
v_accvgpr_read_b32 v245, a37
v_accvgpr_read_b32 v246, a38
v_accvgpr_read_b32 v247, a39
v_pk_mul_f32 v[240:241], v[240:241], v[248:249] op_sel:[0,0] op_sel_hi:[1,0]
v_pk_mul_f32 v[242:243], v[242:243], v[248:249] op_sel:[0,0] op_sel_hi:[1,0]
v_pk_mul_f32 v[244:245], v[244:245], v[248:249] op_sel:[0,0] op_sel_hi:[1,0]
v_pk_mul_f32 v[246:247], v[246:247], v[248:249] op_sel:[0,0] op_sel_hi:[1,0]
v_cvt_pk_bf16_f32 v240, v240, v241
v_cvt_pk_bf16_f32 v241, v242, v243
v_cvt_pk_bf16_f32 v242, v244, v245
v_cvt_pk_bf16_f32 v243, v246, v247
s_nop 0
v_permlane32_swap_b32 v240, v242
v_permlane32_swap_b32 v241, v243
buffer_store_dwordx4 v[240:243], v239, s[36:39], s69 offen sc1
s_add_u32 s69, s69, 65536
s_nop 0
v_accvgpr_read_b32 v240, a40
v_accvgpr_read_b32 v241, a41
v_accvgpr_read_b32 v242, a42
v_accvgpr_read_b32 v243, a43
v_accvgpr_read_b32 v244, a44
v_accvgpr_read_b32 v245, a45
v_accvgpr_read_b32 v246, a46
v_accvgpr_read_b32 v247, a47
v_pk_mul_f32 v[240:241], v[240:241], v[248:249] op_sel:[0,0] op_sel_hi:[1,0]
v_pk_mul_f32 v[242:243], v[242:243], v[248:249] op_sel:[0,0] op_sel_hi:[1,0]
v_pk_mul_f32 v[244:245], v[244:245], v[248:249] op_sel:[0,0] op_sel_hi:[1,0]
v_pk_mul_f32 v[246:247], v[246:247], v[248:249] op_sel:[0,0] op_sel_hi:[1,0]
v_cvt_pk_bf16_f32 v240, v240, v241
v_cvt_pk_bf16_f32 v241, v242, v243
v_cvt_pk_bf16_f32 v242, v244, v245
v_cvt_pk_bf16_f32 v243, v246, v247
s_nop 0
v_permlane32_swap_b32 v240, v242
v_permlane32_swap_b32 v241, v243
buffer_store_dwordx4 v[240:243], v239, s[36:39], s69 offen sc1
ds_read_b64_tr_b16 a[112:113], v227 offset:0
ds_read_b64_tr_b16 a[114:115], v227 offset:512
ds_read_b64_tr_b16 a[116:117], v228 offset:0
ds_read_b64_tr_b16 a[118:119], v228 offset:512
ds_read_b64_tr_b16 a[120:121], v229 offset:0
ds_read_b64_tr_b16 a[122:123], v229 offset:512
ds_read_b64_tr_b16 a[124:125], v230 offset:0
ds_read_b64_tr_b16 a[126:127], v230 offset:512
s_waitcnt lgkmcnt(4)
v_mfma_f32_32x32x16_bf16 a[48:63], a[112:115], v[0:3], 0
ds_read_b64_tr_b16 a[140:141], v227 offset:1024
ds_read_b64_tr_b16 a[142:143], v227 offset:1536
v_mul_f32 v240, v160, v160
v_mul_f32 v241, v161, v161
v_fma_f32 v240, v240, v237, v236
v_mfma_f32_32x32x16_bf16 a[64:79], a[116:119], v[0:3], 0
ds_read_b64_tr_b16 a[144:145], v228 offset:1024
ds_read_b64_tr_b16 a[146:147], v228 offset:1536
v_fma_f32 v241, v241, v237, v236
v_mul_f32 v240, v160, v240
s_waitcnt lgkmcnt(4)
v_mfma_f32_32x32x16_bf16 a[80:95], a[120:123], v[0:3], 0
ds_read_b64_tr_b16 a[148:149], v229 offset:1024
ds_read_b64_tr_b16 a[150:151], v229 offset:1536
v_mul_f32 v241, v161, v241
v_exp_f32 v240, v240
v_mfma_f32_32x32x16_bf16 a[96:111], a[124:127], v[0:3], 0
ds_read_b64_tr_b16 a[152:153], v230 offset:1024
ds_read_b64_tr_b16 a[154:155], v230 offset:1536
v_exp_f32 v241, v241
v_mul_f32 v168, v160, v168
s_waitcnt lgkmcnt(4)
v_mfma_f32_32x32x16_bf16 a[48:63], a[140:143], v[4:7], a[48:63]
ds_read_b64_tr_b16 a[112:113], v227 offset:2048
ds_read_b64_tr_b16 a[114:115], v227 offset:2560
v_mul_f32 v169, v161, v169
v_fma_f32 v240, v240, v238, v238
v_fma_f32 v241, v241, v238, v238
v_mfma_f32_32x32x16_bf16 a[64:79], a[144:147], v[4:7], a[64:79]
ds_read_b64_tr_b16 a[116:117], v228 offset:2048
ds_read_b64_tr_b16 a[118:119], v228 offset:2560
v_rcp_f32 v240, v240
s_waitcnt lgkmcnt(4)
v_mfma_f32_32x32x16_bf16 a[80:95], a[148:151], v[4:7], a[80:95]
ds_read_b64_tr_b16 a[120:121], v229 offset:2048
ds_read_b64_tr_b16 a[122:123], v229 offset:2560
v_rcp_f32 v241, v241
v_mul_f32 v160, v168, v240
v_mfma_f32_32x32x16_bf16 a[96:111], a[152:155], v[4:7], a[96:111]
ds_read_b64_tr_b16 a[124:125], v230 offset:2048
ds_read_b64_tr_b16 a[126:127], v230 offset:2560
v_mul_f32 v161, v169, v241
v_cvt_pk_bf16_f32 v160, v160, v161
v_mul_f32 v240, v162, v162
s_waitcnt lgkmcnt(4)
v_mfma_f32_32x32x16_bf16 a[48:63], a[112:115], v[8:11], a[48:63]
ds_read_b64_tr_b16 a[140:141], v227 offset:3072
ds_read_b64_tr_b16 a[142:143], v227 offset:3584
v_mul_f32 v241, v163, v163
v_fma_f32 v240, v240, v237, v236
v_fma_f32 v241, v241, v237, v236
v_mfma_f32_32x32x16_bf16 a[64:79], a[116:119], v[8:11], a[64:79]
ds_read_b64_tr_b16 a[144:145], v228 offset:3072
ds_read_b64_tr_b16 a[146:147], v228 offset:3584
v_mul_f32 v240, v162, v240
v_mul_f32 v241, v163, v241
s_waitcnt lgkmcnt(4)
v_mfma_f32_32x32x16_bf16 a[80:95], a[120:123], v[8:11], a[80:95]
ds_read_b64_tr_b16 a[148:149], v229 offset:3072
ds_read_b64_tr_b16 a[150:151], v229 offset:3584
v_exp_f32 v240, v240
v_mfma_f32_32x32x16_bf16 a[96:111], a[124:127], v[8:11], a[96:111]
ds_read_b64_tr_b16 a[152:153], v230 offset:3072
ds_read_b64_tr_b16 a[154:155], v230 offset:3584
v_exp_f32 v241, v241
v_mul_f32 v170, v162, v170
s_waitcnt lgkmcnt(4)
v_mfma_f32_32x32x16_bf16 a[48:63], a[140:143], v[12:15], a[48:63]
v_mul_f32 v171, v163, v171
v_fma_f32 v240, v240, v238, v238
v_fma_f32 v241, v241, v238, v238
v_rcp_f32 v240, v240
v_mfma_f32_32x32x16_bf16 a[64:79], a[144:147], v[12:15], a[64:79]
s_waitcnt vmcnt(13)
s_barrier
ds_read_b64_tr_b16 a[112:113], v227 offset:16384
ds_read_b64_tr_b16 a[114:115], v227 offset:16896
ds_read_b64_tr_b16 a[116:117], v228 offset:16384
ds_read_b64_tr_b16 a[118:119], v228 offset:16896
s_waitcnt lgkmcnt(4)
v_mfma_f32_32x32x16_bf16 a[80:95], a[148:151], v[12:15], a[80:95]
ds_read_b64_tr_b16 a[120:121], v229 offset:16384
ds_read_b64_tr_b16 a[122:123], v229 offset:16896
s_add_u32 s74, s16, 14336
s_add_u32 m0, s17, 14336
s_nop 0
buffer_load_dwordx4 v249, s[36:39], s74 offen sc1 lds
s_add_u32 m0, s60, 49152
s_nop 0
buffer_load_dwordx4 v250, s[96:99], s57 offen lds
s_add_u32 s57, s57, s18
v_mfma_f32_32x32x16_bf16 a[96:111], a[152:155], v[12:15], a[96:111]
ds_read_b64_tr_b16 a[124:125], v230 offset:16384
ds_read_b64_tr_b16 a[126:127], v230 offset:16896
v_rcp_f32 v241, v241
v_mul_f32 v162, v170, v240
s_waitcnt lgkmcnt(4)
v_mfma_f32_32x32x16_bf16 a[48:63], a[112:115], v[16:19], a[48:63]
ds_read_b64_tr_b16 a[140:141], v227 offset:17408
ds_read_b64_tr_b16 a[142:143], v227 offset:17920
v_mul_f32 v163, v171, v241
v_cvt_pk_bf16_f32 v161, v162, v163
v_mul_f32 v240, v164, v164
v_mfma_f32_32x32x16_bf16 a[64:79], a[116:119], v[16:19], a[64:79]
ds_read_b64_tr_b16 a[144:145], v228 offset:17408
ds_read_b64_tr_b16 a[146:147], v228 offset:17920
v_mul_f32 v241, v165, v165
v_fma_f32 v240, v240, v237, v236
s_waitcnt lgkmcnt(4)
v_mfma_f32_32x32x16_bf16 a[80:95], a[120:123], v[16:19], a[80:95]
ds_read_b64_tr_b16 a[148:149], v229 offset:17408
ds_read_b64_tr_b16 a[150:151], v229 offset:17920
buffer_load_dwordx4 v250, s[96:99], s57 offen offset:1024 lds
s_add_u32 s57, s57, s18
v_fma_f32 v241, v241, v237, v236
v_mfma_f32_32x32x16_bf16 a[96:111], a[124:127], v[16:19], a[96:111]
ds_read_b64_tr_b16 a[152:153], v230 offset:17408
ds_read_b64_tr_b16 a[154:155], v230 offset:17920
v_mul_f32 v240, v164, v240
v_mul_f32 v241, v165, v241
s_waitcnt lgkmcnt(4)
v_mfma_f32_32x32x16_bf16 a[48:63], a[140:143], v[20:23], a[48:63]
ds_read_b64_tr_b16 a[112:113], v227 offset:18432
ds_read_b64_tr_b16 a[114:115], v227 offset:18944
v_exp_f32 v240, v240
v_mfma_f32_32x32x16_bf16 a[64:79], a[144:147], v[20:23], a[64:79]
ds_read_b64_tr_b16 a[116:117], v228 offset:18432
ds_read_b64_tr_b16 a[118:119], v228 offset:18944
v_exp_f32 v241, v241
s_waitcnt lgkmcnt(4)
v_mfma_f32_32x32x16_bf16 a[80:95], a[148:151], v[20:23], a[80:95]
ds_read_b64_tr_b16 a[120:121], v229 offset:18432
ds_read_b64_tr_b16 a[122:123], v229 offset:18944
buffer_load_dwordx4 v250, s[96:99], s57 offen offset:2048 lds
s_add_u32 s57, s57, s18
v_mul_f32 v172, v164, v172
v_mfma_f32_32x32x16_bf16 a[96:111], a[152:155], v[20:23], a[96:111]
ds_read_b64_tr_b16 a[124:125], v230 offset:18432
ds_read_b64_tr_b16 a[126:127], v230 offset:18944
v_mul_f32 v173, v165, v173
v_fma_f32 v240, v240, v238, v238
v_fma_f32 v241, v241, v238, v238
s_waitcnt lgkmcnt(4)
v_mfma_f32_32x32x16_bf16 a[48:63], a[112:115], v[24:27], a[48:63]
ds_read_b64_tr_b16 a[140:141], v227 offset:19456
ds_read_b64_tr_b16 a[142:143], v227 offset:19968
v_rcp_f32 v240, v240
v_mfma_f32_32x32x16_bf16 a[64:79], a[116:119], v[24:27], a[64:79]
ds_read_b64_tr_b16 a[144:145], v228 offset:19456
ds_read_b64_tr_b16 a[146:147], v228 offset:19968
v_rcp_f32 v241, v241
s_waitcnt lgkmcnt(4)
v_mfma_f32_32x32x16_bf16 a[80:95], a[120:123], v[24:27], a[80:95]
ds_read_b64_tr_b16 a[148:149], v229 offset:19456
ds_read_b64_tr_b16 a[150:151], v229 offset:19968
buffer_load_dwordx4 v250, s[96:99], s57 offen offset:3072 lds
s_add_u32 s57, s57, s19
s_cmp_eq_u32 s23, 4
s_cselect_b32 s21, s66, 0
s_sub_u32 s57, s57, s21
v_mfma_f32_32x32x16_bf16 a[96:111], a[124:127], v[24:27], a[96:111]
ds_read_b64_tr_b16 a[152:153], v230 offset:19456
ds_read_b64_tr_b16 a[154:155], v230 offset:19968
v_mul_f32 v164, v172, v240
v_mul_f32 v165, v173, v241
v_cvt_pk_bf16_f32 v162, v164, v165
s_waitcnt lgkmcnt(4)
v_mfma_f32_32x32x16_bf16 a[48:63], a[140:143], v[28:31], a[48:63]
v_mul_f32 v240, v166, v166
v_mul_f32 v241, v167, v167
v_fma_f32 v240, v240, v237, v236
v_fma_f32 v241, v241, v237, v236
v_mul_f32 v240, v166, v240
v_mfma_f32_32x32x16_bf16 a[64:79], a[144:147], v[28:31], a[64:79]
s_waitcnt vmcnt(12)
s_barrier
ds_read_b64_tr_b16 a[112:113], v227 offset:32768
ds_read_b64_tr_b16 a[114:115], v227 offset:33280
ds_read_b64_tr_b16 a[116:117], v228 offset:32768
ds_read_b64_tr_b16 a[118:119], v228 offset:33280
s_waitcnt lgkmcnt(4)
v_mfma_f32_32x32x16_bf16 a[80:95], a[148:151], v[28:31], a[80:95]
ds_read_b64_tr_b16 a[120:121], v229 offset:32768
ds_read_b64_tr_b16 a[122:123], v229 offset:33280
s_add_u32 s74, s16, 15360
s_add_u32 m0, s17, 15360
s_nop 0
buffer_load_dwordx4 v249, s[36:39], s74 offen sc1 lds
s_add_u32 m0, s60, 0
s_nop 0
buffer_load_dwordx4 v250, s[96:99], s57 offen lds
s_add_u32 s57, s57, s18
v_mfma_f32_32x32x16_bf16 a[96:111], a[152:155], v[28:31], a[96:111]
ds_read_b64_tr_b16 a[124:125], v230 offset:32768
ds_read_b64_tr_b16 a[126:127], v230 offset:33280
v_mul_f32 v241, v167, v241
v_exp_f32 v240, v240
s_waitcnt lgkmcnt(4)
v_mfma_f32_32x32x16_bf16 a[48:63], a[112:115], v[32:35], a[48:63]
ds_read_b64_tr_b16 a[140:141], v227 offset:33792
ds_read_b64_tr_b16 a[142:143], v227 offset:34304
v_exp_f32 v241, v241
v_mul_f32 v174, v166, v174
v_mfma_f32_32x32x16_bf16 a[64:79], a[116:119], v[32:35], a[64:79]
ds_read_b64_tr_b16 a[144:145], v228 offset:33792
ds_read_b64_tr_b16 a[146:147], v228 offset:34304
v_mul_f32 v175, v167, v175
v_fma_f32 v240, v240, v238, v238
s_waitcnt lgkmcnt(4)
v_mfma_f32_32x32x16_bf16 a[80:95], a[120:123], v[32:35], a[80:95]
ds_read_b64_tr_b16 a[148:149], v229 offset:33792
ds_read_b64_tr_b16 a[150:151], v229 offset:34304
buffer_load_dwordx4 v250, s[96:99], s57 offen offset:1024 lds
s_add_u32 s57, s57, s18
v_fma_f32 v241, v241, v238, v238
v_mfma_f32_32x32x16_bf16 a[96:111], a[124:127], v[32:35], a[96:111]
ds_read_b64_tr_b16 a[152:153], v230 offset:33792
ds_read_b64_tr_b16 a[154:155], v230 offset:34304
v_rcp_f32 v240, v240
s_waitcnt lgkmcnt(4)
v_mfma_f32_32x32x16_bf16 a[48:63], a[140:143], v[36:39], a[48:63]
ds_read_b64_tr_b16 a[112:113], v227 offset:34816
ds_read_b64_tr_b16 a[114:115], v227 offset:35328
v_rcp_f32 v241, v241
v_mul_f32 v166, v174, v240
v_mfma_f32_32x32x16_bf16 a[64:79], a[144:147], v[36:39], a[64:79]
ds_read_b64_tr_b16 a[116:117], v228 offset:34816
ds_read_b64_tr_b16 a[118:119], v228 offset:35328
v_mul_f32 v167, v175, v241
v_cvt_pk_bf16_f32 v163, v166, v167
s_waitcnt lgkmcnt(4)
v_mfma_f32_32x32x16_bf16 a[80:95], a[148:151], v[36:39], a[80:95]
ds_read_b64_tr_b16 a[120:121], v229 offset:34816
ds_read_b64_tr_b16 a[122:123], v229 offset:35328
buffer_load_dwordx4 v250, s[96:99], s57 offen offset:2048 lds
s_add_u32 s57, s57, s18
v_mul_f32 v240, v176, v176
v_mfma_f32_32x32x16_bf16 a[96:111], a[152:155], v[36:39], a[96:111]
ds_read_b64_tr_b16 a[124:125], v230 offset:34816
ds_read_b64_tr_b16 a[126:127], v230 offset:35328
v_mul_f32 v241, v177, v177
v_fma_f32 v240, v240, v237, v236
v_fma_f32 v241, v241, v237, v236
s_waitcnt lgkmcnt(4)
v_mfma_f32_32x32x16_bf16 a[48:63], a[112:115], v[40:43], a[48:63]
ds_read_b64_tr_b16 a[140:141], v227 offset:35840
ds_read_b64_tr_b16 a[142:143], v227 offset:36352
v_mul_f32 v240, v176, v240
v_mul_f32 v241, v177, v241
v_mfma_f32_32x32x16_bf16 a[64:79], a[116:119], v[40:43], a[64:79]
ds_read_b64_tr_b16 a[144:145], v228 offset:35840
ds_read_b64_tr_b16 a[146:147], v228 offset:36352
v_exp_f32 v240, v240
s_waitcnt lgkmcnt(4)
v_mfma_f32_32x32x16_bf16 a[80:95], a[120:123], v[40:43], a[80:95]
ds_read_b64_tr_b16 a[148:149], v229 offset:35840
ds_read_b64_tr_b16 a[150:151], v229 offset:36352
buffer_load_dwordx4 v250, s[96:99], s57 offen offset:3072 lds
s_add_u32 s57, s57, s19
s_cmp_eq_u32 s23, 5
s_cselect_b32 s21, s66, 0
s_sub_u32 s57, s57, s21
v_mfma_f32_32x32x16_bf16 a[96:111], a[124:127], v[40:43], a[96:111]
ds_read_b64_tr_b16 a[152:153], v230 offset:35840
ds_read_b64_tr_b16 a[154:155], v230 offset:36352
v_exp_f32 v241, v241
v_mul_f32 v184, v176, v184
s_waitcnt lgkmcnt(4)
v_mfma_f32_32x32x16_bf16 a[48:63], a[140:143], v[44:47], a[48:63]
v_mul_f32 v185, v177, v185
v_fma_f32 v240, v240, v238, v238
v_fma_f32 v241, v241, v238, v238
v_rcp_f32 v240, v240
v_mfma_f32_32x32x16_bf16 a[64:79], a[144:147], v[44:47], a[64:79]
s_waitcnt vmcnt(5)
s_barrier
s_lshl_b32 s72, s52, 7
s_lshl_b32 s73, s53, 2
s_add_u32 s72, s72, s73
s_add_u32 s72, s72, 20594816
s_cmp_eq_u32 s3, 0
s_cselect_b32 s72, s72, 2146435072
v_lshlrev_b32 v254, 25, v224
v_mov_b32 v255, s4
buffer_store_dword v255, v254, s[36:39], s72 offen sc1
ds_read_b64_tr_b16 a[112:113], v227 offset:49152
ds_read_b64_tr_b16 a[114:115], v227 offset:49664
ds_read_b64_tr_b16 a[116:117], v228 offset:49152
ds_read_b64_tr_b16 a[118:119], v228 offset:49664
s_waitcnt lgkmcnt(4)
v_mfma_f32_32x32x16_bf16 a[80:95], a[148:151], v[44:47], a[80:95]
ds_read_b64_tr_b16 a[120:121], v229 offset:49152
ds_read_b64_tr_b16 a[122:123], v229 offset:49664
s_add_u32 s74, s16, 16384
s_add_u32 m0, s17, 16384
s_nop 0
buffer_load_dwordx4 v249, s[36:39], s74 offen sc1 lds
s_add_u32 m0, s60, 16384
s_nop 0
buffer_load_dwordx4 v250, s[96:99], s57 offen lds
s_add_u32 s57, s57, s18
v_mfma_f32_32x32x16_bf16 a[96:111], a[152:155], v[44:47], a[96:111]
ds_read_b64_tr_b16 a[124:125], v230 offset:49152
ds_read_b64_tr_b16 a[126:127], v230 offset:49664
v_rcp_f32 v241, v241
v_mul_f32 v176, v184, v240
s_waitcnt lgkmcnt(4)
v_mfma_f32_32x32x16_bf16 a[48:63], a[112:115], v[48:51], a[48:63]
ds_read_b64_tr_b16 a[140:141], v227 offset:50176
ds_read_b64_tr_b16 a[142:143], v227 offset:50688
v_mul_f32 v177, v185, v241
v_cvt_pk_bf16_f32 v176, v176, v177
v_mul_f32 v240, v178, v178
v_mfma_f32_32x32x16_bf16 a[64:79], a[116:119], v[48:51], a[64:79]
ds_read_b64_tr_b16 a[144:145], v228 offset:50176
ds_read_b64_tr_b16 a[146:147], v228 offset:50688
v_mul_f32 v241, v179, v179
v_fma_f32 v240, v240, v237, v236
s_waitcnt lgkmcnt(4)
v_mfma_f32_32x32x16_bf16 a[80:95], a[120:123], v[48:51], a[80:95]
ds_read_b64_tr_b16 a[148:149], v229 offset:50176
ds_read_b64_tr_b16 a[150:151], v229 offset:50688
buffer_load_dwordx4 v250, s[96:99], s57 offen offset:1024 lds
s_add_u32 s57, s57, s18
v_fma_f32 v241, v241, v237, v236
v_mfma_f32_32x32x16_bf16 a[96:111], a[124:127], v[48:51], a[96:111]
ds_read_b64_tr_b16 a[152:153], v230 offset:50176
ds_read_b64_tr_b16 a[154:155], v230 offset:50688
v_mul_f32 v240, v178, v240
v_mul_f32 v241, v179, v241
s_waitcnt lgkmcnt(4)
v_mfma_f32_32x32x16_bf16 a[48:63], a[140:143], v[52:55], a[48:63]
ds_read_b64_tr_b16 a[112:113], v227 offset:51200
ds_read_b64_tr_b16 a[114:115], v227 offset:51712
v_exp_f32 v240, v240
v_mfma_f32_32x32x16_bf16 a[64:79], a[144:147], v[52:55], a[64:79]
ds_read_b64_tr_b16 a[116:117], v228 offset:51200
ds_read_b64_tr_b16 a[118:119], v228 offset:51712
v_exp_f32 v241, v241
s_waitcnt lgkmcnt(4)
v_mfma_f32_32x32x16_bf16 a[80:95], a[148:151], v[52:55], a[80:95]
ds_read_b64_tr_b16 a[120:121], v229 offset:51200
ds_read_b64_tr_b16 a[122:123], v229 offset:51712
buffer_load_dwordx4 v250, s[96:99], s57 offen offset:2048 lds
s_add_u32 s57, s57, s18
v_mul_f32 v186, v178, v186
v_mfma_f32_32x32x16_bf16 a[96:111], a[152:155], v[52:55], a[96:111]
ds_read_b64_tr_b16 a[124:125], v230 offset:51200
ds_read_b64_tr_b16 a[126:127], v230 offset:51712
v_mul_f32 v187, v179, v187
v_fma_f32 v240, v240, v238, v238
v_fma_f32 v241, v241, v238, v238
s_waitcnt lgkmcnt(4)
v_mfma_f32_32x32x16_bf16 a[48:63], a[112:115], v[56:59], a[48:63]
ds_read_b64_tr_b16 a[140:141], v227 offset:52224
ds_read_b64_tr_b16 a[142:143], v227 offset:52736
v_rcp_f32 v240, v240
v_mfma_f32_32x32x16_bf16 a[64:79], a[116:119], v[56:59], a[64:79]
ds_read_b64_tr_b16 a[144:145], v228 offset:52224
ds_read_b64_tr_b16 a[146:147], v228 offset:52736
v_rcp_f32 v241, v241
s_waitcnt lgkmcnt(4)
v_mfma_f32_32x32x16_bf16 a[80:95], a[120:123], v[56:59], a[80:95]
ds_read_b64_tr_b16 a[148:149], v229 offset:52224
ds_read_b64_tr_b16 a[150:151], v229 offset:52736
buffer_load_dwordx4 v250, s[96:99], s57 offen offset:3072 lds
s_add_u32 s57, s57, s19
s_cmp_eq_u32 s23, 6
s_cselect_b32 s21, s66, 0
s_sub_u32 s57, s57, s21
v_mfma_f32_32x32x16_bf16 a[96:111], a[124:127], v[56:59], a[96:111]
ds_read_b64_tr_b16 a[152:153], v230 offset:52224
ds_read_b64_tr_b16 a[154:155], v230 offset:52736
s_add_u32 s79, s78, 0
buffer_load_dwordx4 a[168:171], v226, s[36:39], s79 offen sc1
v_mul_f32 v178, v186, v240
s_waitcnt lgkmcnt(4)
v_mfma_f32_32x32x16_bf16 a[48:63], a[140:143], v[60:63], a[48:63]
v_mul_f32 v179, v187, v241
v_cvt_pk_bf16_f32 v177, v178, v179
v_mul_f32 v240, v180, v180
v_mul_f32 v241, v181, v181
v_fma_f32 v240, v240, v237, v236
v_mfma_f32_32x32x16_bf16 a[64:79], a[144:147], v[60:63], a[64:79]
s_waitcnt vmcnt(7)
s_barrier
ds_read_b64_tr_b16 a[112:113], v227 offset:0
ds_read_b64_tr_b16 a[114:115], v227 offset:512
ds_read_b64_tr_b16 a[116:117], v228 offset:0
ds_read_b64_tr_b16 a[118:119], v228 offset:512
s_waitcnt lgkmcnt(4)
v_mfma_f32_32x32x16_bf16 a[80:95], a[148:151], v[60:63], a[80:95]
ds_read_b64_tr_b16 a[120:121], v229 offset:0
ds_read_b64_tr_b16 a[122:123], v229 offset:512
s_add_u32 s74, s16, 17408
s_add_u32 m0, s17, 17408
s_nop 0
buffer_load_dwordx4 v249, s[36:39], s74 offen sc1 lds
s_add_u32 m0, s60, 32768
s_nop 0
buffer_load_dwordx4 v250, s[96:99], s57 offen lds
s_add_u32 s57, s57, s18
v_mfma_f32_32x32x16_bf16 a[96:111], a[152:155], v[60:63], a[96:111]
ds_read_b64_tr_b16 a[124:125], v230 offset:0
ds_read_b64_tr_b16 a[126:127], v230 offset:512
buffer_load_dwordx4 a[172:175], v226, s[36:39], s79 offen offset:1024 sc1
v_fma_f32 v241, v241, v237, v236
v_mul_f32 v240, v180, v240
s_waitcnt lgkmcnt(4)
v_mfma_f32_32x32x16_bf16 a[48:63], a[112:115], v[64:67], a[48:63]
ds_read_b64_tr_b16 a[140:141], v227 offset:1024
ds_read_b64_tr_b16 a[142:143], v227 offset:1536
v_mul_f32 v241, v181, v241
v_exp_f32 v240, v240
v_mfma_f32_32x32x16_bf16 a[64:79], a[116:119], v[64:67], a[64:79]
ds_read_b64_tr_b16 a[144:145], v228 offset:1024
ds_read_b64_tr_b16 a[146:147], v228 offset:1536
v_exp_f32 v241, v241
s_waitcnt lgkmcnt(4)
v_mfma_f32_32x32x16_bf16 a[80:95], a[120:123], v[64:67], a[80:95]
ds_read_b64_tr_b16 a[148:149], v229 offset:1024
ds_read_b64_tr_b16 a[150:151], v229 offset:1536
buffer_load_dwordx4 v250, s[96:99], s57 offen offset:1024 lds
s_add_u32 s57, s57, s18
v_mul_f32 v188, v180, v188
v_mfma_f32_32x32x16_bf16 a[96:111], a[124:127], v[64:67], a[96:111]
ds_read_b64_tr_b16 a[152:153], v230 offset:1024
ds_read_b64_tr_b16 a[154:155], v230 offset:1536
buffer_load_dwordx4 a[176:179], v226, s[36:39], s79 offen offset:2048 sc1
v_mul_f32 v189, v181, v189
v_fma_f32 v240, v240, v238, v238
s_waitcnt lgkmcnt(4)
v_mfma_f32_32x32x16_bf16 a[48:63], a[140:143], v[68:71], a[48:63]
ds_read_b64_tr_b16 a[112:113], v227 offset:2048
ds_read_b64_tr_b16 a[114:115], v227 offset:2560
v_fma_f32 v241, v241, v238, v238
v_rcp_f32 v240, v240
v_mfma_f32_32x32x16_bf16 a[64:79], a[144:147], v[68:71], a[64:79]
ds_read_b64_tr_b16 a[116:117], v228 offset:2048
ds_read_b64_tr_b16 a[118:119], v228 offset:2560
v_rcp_f32 v241, v241
s_waitcnt lgkmcnt(4)
v_mfma_f32_32x32x16_bf16 a[80:95], a[148:151], v[68:71], a[80:95]
ds_read_b64_tr_b16 a[120:121], v229 offset:2048
ds_read_b64_tr_b16 a[122:123], v229 offset:2560
buffer_load_dwordx4 v250, s[96:99], s57 offen offset:2048 lds
s_add_u32 s57, s57, s18
v_mul_f32 v180, v188, v240
v_mfma_f32_32x32x16_bf16 a[96:111], a[152:155], v[68:71], a[96:111]
ds_read_b64_tr_b16 a[124:125], v230 offset:2048
ds_read_b64_tr_b16 a[126:127], v230 offset:2560
buffer_load_dwordx4 a[180:183], v226, s[36:39], s79 offen offset:3072 sc1
v_mul_f32 v181, v189, v241
v_cvt_pk_bf16_f32 v178, v180, v181
s_waitcnt lgkmcnt(4)
v_mfma_f32_32x32x16_bf16 a[48:63], a[112:115], v[72:75], a[48:63]
ds_read_b64_tr_b16 a[140:141], v227 offset:3072
ds_read_b64_tr_b16 a[142:143], v227 offset:3584
v_mul_f32 v240, v182, v182
v_mul_f32 v241, v183, v183
v_fma_f32 v240, v240, v237, v236
v_mfma_f32_32x32x16_bf16 a[64:79], a[116:119], v[72:75], a[64:79]
ds_read_b64_tr_b16 a[144:145], v228 offset:3072
ds_read_b64_tr_b16 a[146:147], v228 offset:3584
v_fma_f32 v241, v241, v237, v236
v_mul_f32 v240, v182, v240
s_waitcnt lgkmcnt(4)
v_mfma_f32_32x32x16_bf16 a[80:95], a[120:123], v[72:75], a[80:95]
ds_read_b64_tr_b16 a[148:149], v229 offset:3072
ds_read_b64_tr_b16 a[150:151], v229 offset:3584
buffer_load_dwordx4 v250, s[96:99], s57 offen offset:3072 lds
s_add_u32 s57, s57, s19
s_cmp_eq_u32 s23, 7
s_cselect_b32 s21, s66, 0
s_sub_u32 s57, s57, s21
v_mfma_f32_32x32x16_bf16 a[96:111], a[124:127], v[72:75], a[96:111]
ds_read_b64_tr_b16 a[152:153], v230 offset:3072
ds_read_b64_tr_b16 a[154:155], v230 offset:3584
buffer_load_dwordx4 a[184:187], v231, s[36:39], s79 offen sc1
v_mul_f32 v241, v183, v241
s_waitcnt lgkmcnt(4)
v_mfma_f32_32x32x16_bf16 a[48:63], a[140:143], v[76:79], a[48:63]
v_exp_f32 v240, v240
v_exp_f32 v241, v241
v_mul_f32 v190, v182, v190
v_mfma_f32_32x32x16_bf16 a[64:79], a[144:147], v[76:79], a[64:79]
s_waitcnt vmcnt(10)
s_barrier
ds_read_b64_tr_b16 a[112:113], v227 offset:16384
ds_read_b64_tr_b16 a[114:115], v227 offset:16896
ds_read_b64_tr_b16 a[116:117], v228 offset:16384
ds_read_b64_tr_b16 a[118:119], v228 offset:16896
s_waitcnt lgkmcnt(4)
v_mfma_f32_32x32x16_bf16 a[80:95], a[148:151], v[76:79], a[80:95]
ds_read_b64_tr_b16 a[120:121], v229 offset:16384
ds_read_b64_tr_b16 a[122:123], v229 offset:16896
s_add_u32 s74, s16, 18432
s_add_u32 m0, s17, 18432
s_nop 0
buffer_load_dwordx4 v249, s[36:39], s74 offen sc1 lds
s_add_u32 m0, s60, 49152
s_nop 0
buffer_load_dwordx4 v250, s[96:99], s57 offen lds
s_add_u32 s57, s57, s18
v_mfma_f32_32x32x16_bf16 a[96:111], a[152:155], v[76:79], a[96:111]
ds_read_b64_tr_b16 a[124:125], v230 offset:16384
ds_read_b64_tr_b16 a[126:127], v230 offset:16896
s_add_u32 s79, s78, 5120
buffer_load_dwordx4 a[188:191], v226, s[36:39], s79 offen sc1
v_mul_f32 v191, v183, v191
s_waitcnt lgkmcnt(4)
v_mfma_f32_32x32x16_bf16 a[48:63], a[112:115], v[80:83], a[48:63]
ds_read_b64_tr_b16 a[140:141], v227 offset:17408
ds_read_b64_tr_b16 a[142:143], v227 offset:17920
v_fma_f32 v240, v240, v238, v238
v_fma_f32 v241, v241, v238, v238
v_mfma_f32_32x32x16_bf16 a[64:79], a[116:119], v[80:83], a[64:79]
ds_read_b64_tr_b16 a[144:145], v228 offset:17408
ds_read_b64_tr_b16 a[146:147], v228 offset:17920
v_rcp_f32 v240, v240
s_waitcnt lgkmcnt(4)
v_mfma_f32_32x32x16_bf16 a[80:95], a[120:123], v[80:83], a[80:95]
ds_read_b64_tr_b16 a[148:149], v229 offset:17408
ds_read_b64_tr_b16 a[150:151], v229 offset:17920
buffer_load_dwordx4 v250, s[96:99], s57 offen offset:1024 lds
s_add_u32 s57, s57, s18
v_mfma_f32_32x32x16_bf16 a[96:111], a[124:127], v[80:83], a[96:111]
ds_read_b64_tr_b16 a[152:153], v230 offset:17408
ds_read_b64_tr_b16 a[154:155], v230 offset:17920
buffer_load_dwordx4 a[192:195], v226, s[36:39], s79 offen offset:1024 sc1
v_rcp_f32 v241, v241
s_waitcnt lgkmcnt(4)
v_mfma_f32_32x32x16_bf16 a[48:63], a[140:143], v[84:87], a[48:63]
ds_read_b64_tr_b16 a[112:113], v227 offset:18432
ds_read_b64_tr_b16 a[114:115], v227 offset:18944
v_mul_f32 v182, v190, v240
v_mul_f32 v183, v191, v241
v_cvt_pk_bf16_f32 v179, v182, v183
v_mfma_f32_32x32x16_bf16 a[64:79], a[144:147], v[84:87], a[64:79]
ds_read_b64_tr_b16 a[116:117], v228 offset:18432
ds_read_b64_tr_b16 a[118:119], v228 offset:18944
v_mul_f32 v240, v192, v192
v_mul_f32 v241, v193, v193
s_waitcnt lgkmcnt(4)
v_mfma_f32_32x32x16_bf16 a[80:95], a[148:151], v[84:87], a[80:95]
ds_read_b64_tr_b16 a[120:121], v229 offset:18432
ds_read_b64_tr_b16 a[122:123], v229 offset:18944
buffer_load_dwordx4 v250, s[96:99], s57 offen offset:2048 lds
s_add_u32 s57, s57, s18
v_fma_f32 v240, v240, v237, v236
v_mfma_f32_32x32x16_bf16 a[96:111], a[152:155], v[84:87], a[96:111]
ds_read_b64_tr_b16 a[124:125], v230 offset:18432
ds_read_b64_tr_b16 a[126:127], v230 offset:18944
buffer_load_dwordx4 a[196:199], v226, s[36:39], s79 offen offset:2048 sc1
v_fma_f32 v241, v241, v237, v236
v_mul_f32 v240, v192, v240
s_waitcnt lgkmcnt(4)
v_mfma_f32_32x32x16_bf16 a[48:63], a[112:115], v[88:91], a[48:63]
ds_read_b64_tr_b16 a[140:141], v227 offset:19456
ds_read_b64_tr_b16 a[142:143], v227 offset:19968
v_mul_f32 v241, v193, v241
v_exp_f32 v240, v240
v_mfma_f32_32x32x16_bf16 a[64:79], a[116:119], v[88:91], a[64:79]
ds_read_b64_tr_b16 a[144:145], v228 offset:19456
ds_read_b64_tr_b16 a[146:147], v228 offset:19968
v_exp_f32 v241, v241
s_waitcnt lgkmcnt(4)
v_mfma_f32_32x32x16_bf16 a[80:95], a[120:123], v[88:91], a[80:95]
ds_read_b64_tr_b16 a[148:149], v229 offset:19456
ds_read_b64_tr_b16 a[150:151], v229 offset:19968
buffer_load_dwordx4 v250, s[96:99], s57 offen offset:3072 lds
s_add_u32 s57, s57, s19
s_cmp_eq_u32 s23, 8
s_cselect_b32 s21, s66, 0
s_sub_u32 s57, s57, s21
v_mfma_f32_32x32x16_bf16 a[96:111], a[124:127], v[88:91], a[96:111]
ds_read_b64_tr_b16 a[152:153], v230 offset:19456
ds_read_b64_tr_b16 a[154:155], v230 offset:19968
buffer_load_dwordx4 a[200:203], v226, s[36:39], s79 offen offset:3072 sc1
v_mul_f32 v200, v192, v200
v_mul_f32 v201, v193, v201
s_waitcnt lgkmcnt(4)
v_mfma_f32_32x32x16_bf16 a[48:63], a[140:143], v[92:95], a[48:63]
v_fma_f32 v240, v240, v238, v238
v_fma_f32 v241, v241, v238, v238
v_rcp_f32 v240, v240
v_mfma_f32_32x32x16_bf16 a[64:79], a[144:147], v[92:95], a[64:79]
s_waitcnt vmcnt(10)
s_barrier
s_getpc_b64 s[72:73]
L_pc_6:
s_lshr_b32 s70, s2, 3
s_lshl_b32 s70, s70, 2
s_add_u32 s70, s70, s3
s_lshl_b32 s70, s70, 7
s_add_u32 s70, s70, 4096
v_and_b32 v253, 1, v224
v_lshlrev_b32 v253, 14, v253
v_add_u32 v253, s70, v253
v_min_u32 v253, L_end_of_code-L_pc_6-4, v253
global_load_dword a255, v253, s[72:73]
ds_read_b64_tr_b16 a[112:113], v227 offset:32768
ds_read_b64_tr_b16 a[114:115], v227 offset:33280
ds_read_b64_tr_b16 a[116:117], v228 offset:32768
ds_read_b64_tr_b16 a[118:119], v228 offset:33280
s_waitcnt lgkmcnt(4)
v_mfma_f32_32x32x16_bf16 a[80:95], a[148:151], v[92:95], a[80:95]
ds_read_b64_tr_b16 a[120:121], v229 offset:32768
ds_read_b64_tr_b16 a[122:123], v229 offset:33280
s_add_u32 s74, s16, 19456
s_add_u32 m0, s17, 19456
s_nop 0
buffer_load_dwordx4 v249, s[36:39], s74 offen sc1 lds
s_add_u32 m0, s60, 0
s_nop 0
buffer_load_dwordx4 v250, s[96:99], s57 offen lds
s_add_u32 s57, s57, s18
v_mfma_f32_32x32x16_bf16 a[96:111], a[152:155], v[92:95], a[96:111]
ds_read_b64_tr_b16 a[124:125], v230 offset:32768
ds_read_b64_tr_b16 a[126:127], v230 offset:33280
buffer_load_dwordx4 a[204:207], v231, s[36:39], s79 offen sc1
v_rcp_f32 v241, v241
s_waitcnt lgkmcnt(4)
v_mfma_f32_32x32x16_bf16 a[48:63], a[112:115], v[96:99], a[48:63]
ds_read_b64_tr_b16 a[140:141], v227 offset:33792
ds_read_b64_tr_b16 a[142:143], v227 offset:34304
v_mul_f32 v192, v200, v240
v_mul_f32 v193, v201, v241
v_cvt_pk_bf16_f32 v192, v192, v193
v_mfma_f32_32x32x16_bf16 a[64:79], a[116:119], v[96:99], a[64:79]
ds_read_b64_tr_b16 a[144:145], v228 offset:33792
ds_read_b64_tr_b16 a[146:147], v228 offset:34304
v_mul_f32 v240, v194, v194
v_mul_f32 v241, v195, v195
s_waitcnt lgkmcnt(4)
v_mfma_f32_32x32x16_bf16 a[80:95], a[120:123], v[96:99], a[80:95]
ds_read_b64_tr_b16 a[148:149], v229 offset:33792
ds_read_b64_tr_b16 a[150:151], v229 offset:34304
buffer_load_dwordx4 v250, s[96:99], s57 offen offset:1024 lds
s_add_u32 s57, s57, s18
v_fma_f32 v240, v240, v237, v236
v_mfma_f32_32x32x16_bf16 a[96:111], a[124:127], v[96:99], a[96:111]
ds_read_b64_tr_b16 a[152:153], v230 offset:33792
ds_read_b64_tr_b16 a[154:155], v230 offset:34304
s_add_u32 s79, s78, 10240
buffer_load_dwordx4 a[208:211], v226, s[36:39], s79 offen sc1
v_fma_f32 v241, v241, v237, v236
s_waitcnt lgkmcnt(4)
v_mfma_f32_32x32x16_bf16 a[48:63], a[140:143], v[100:103], a[48:63]
ds_read_b64_tr_b16 a[112:113], v227 offset:34816
ds_read_b64_tr_b16 a[114:115], v227 offset:35328
v_mul_f32 v240, v194, v240
v_mul_f32 v241, v195, v241
v_mfma_f32_32x32x16_bf16 a[64:79], a[144:147], v[100:103], a[64:79]
ds_read_b64_tr_b16 a[116:117], v228 offset:34816
ds_read_b64_tr_b16 a[118:119], v228 offset:35328
v_exp_f32 v240, v240
s_waitcnt lgkmcnt(4)
v_mfma_f32_32x32x16_bf16 a[80:95], a[148:151], v[100:103], a[80:95]
ds_read_b64_tr_b16 a[120:121], v229 offset:34816
ds_read_b64_tr_b16 a[122:123], v229 offset:35328
buffer_load_dwordx4 v250, s[96:99], s57 offen offset:2048 lds
s_add_u32 s57, s57, s18
v_mfma_f32_32x32x16_bf16 a[96:111], a[152:155], v[100:103], a[96:111]
ds_read_b64_tr_b16 a[124:125], v230 offset:34816
ds_read_b64_tr_b16 a[126:127], v230 offset:35328
buffer_load_dwordx4 a[212:215], v226, s[36:39], s79 offen offset:1024 sc1
v_exp_f32 v241, v241
s_waitcnt lgkmcnt(4)
v_mfma_f32_32x32x16_bf16 a[48:63], a[112:115], v[104:107], a[48:63]
ds_read_b64_tr_b16 a[140:141], v227 offset:35840
ds_read_b64_tr_b16 a[142:143], v227 offset:36352
v_mul_f32 v202, v194, v202
v_mul_f32 v203, v195, v203
v_fma_f32 v240, v240, v238, v238
v_mfma_f32_32x32x16_bf16 a[64:79], a[116:119], v[104:107], a[64:79]
ds_read_b64_tr_b16 a[144:145], v228 offset:35840
ds_read_b64_tr_b16 a[146:147], v228 offset:36352
v_fma_f32 v241, v241, v238, v238
s_waitcnt lgkmcnt(4)
v_mfma_f32_32x32x16_bf16 a[80:95], a[120:123], v[104:107], a[80:95]
ds_read_b64_tr_b16 a[148:149], v229 offset:35840
ds_read_b64_tr_b16 a[150:151], v229 offset:36352
buffer_load_dwordx4 v250, s[96:99], s57 offen offset:3072 lds
s_add_u32 s57, s57, s19
s_cmp_eq_u32 s23, 9
s_cselect_b32 s21, s66, 0
s_sub_u32 s57, s57, s21
v_mfma_f32_32x32x16_bf16 a[96:111], a[124:127], v[104:107], a[96:111]
ds_read_b64_tr_b16 a[152:153], v230 offset:35840
ds_read_b64_tr_b16 a[154:155], v230 offset:36352
buffer_load_dwordx4 a[216:219], v226, s[36:39], s79 offen offset:2048 sc1
v_rcp_f32 v240, v240
s_waitcnt lgkmcnt(4)
v_mfma_f32_32x32x16_bf16 a[48:63], a[140:143], v[108:111], a[48:63]
v_rcp_f32 v241, v241
v_mul_f32 v194, v202, v240
v_mul_f32 v195, v203, v241
v_cvt_pk_bf16_f32 v193, v194, v195
v_mfma_f32_32x32x16_bf16 a[64:79], a[144:147], v[108:111], a[64:79]
s_waitcnt vmcnt(11)
s_barrier
ds_read_b64_tr_b16 a[112:113], v227 offset:49152
ds_read_b64_tr_b16 a[114:115], v227 offset:49664
ds_read_b64_tr_b16 a[116:117], v228 offset:49152
ds_read_b64_tr_b16 a[118:119], v228 offset:49664
s_waitcnt lgkmcnt(4)
v_mfma_f32_32x32x16_bf16 a[80:95], a[148:151], v[108:111], a[80:95]
ds_read_b64_tr_b16 a[120:121], v229 offset:49152
ds_read_b64_tr_b16 a[122:123], v229 offset:49664
s_add_u32 s74, s16, 20480
s_add_u32 m0, s17, 20480
s_nop 0
buffer_load_dwordx4 v249, s[36:39], s74 offen sc1 lds
s_add_u32 m0, s60, 16384
s_nop 0
buffer_load_dwordx4 v250, s[96:99], s57 offen lds
s_add_u32 s57, s57, s18
v_mfma_f32_32x32x16_bf16 a[96:111], a[152:155], v[108:111], a[96:111]
ds_read_b64_tr_b16 a[124:125], v230 offset:49152
ds_read_b64_tr_b16 a[126:127], v230 offset:49664
buffer_load_dwordx4 a[220:223], v226, s[36:39], s79 offen offset:3072 sc1
v_mul_f32 v240, v196, v196
v_mul_f32 v241, v197, v197
s_waitcnt lgkmcnt(4)
v_mfma_f32_32x32x16_bf16 a[48:63], a[112:115], v[112:115], a[48:63]
ds_read_b64_tr_b16 a[140:141], v227 offset:50176
ds_read_b64_tr_b16 a[142:143], v227 offset:50688
v_fma_f32 v240, v240, v237, v236
v_fma_f32 v241, v241, v237, v236
v_mul_f32 v240, v196, v240
v_mfma_f32_32x32x16_bf16 a[64:79], a[116:119], v[112:115], a[64:79]
ds_read_b64_tr_b16 a[144:145], v228 offset:50176
ds_read_b64_tr_b16 a[146:147], v228 offset:50688
v_mul_f32 v241, v197, v241
s_waitcnt lgkmcnt(4)
v_mfma_f32_32x32x16_bf16 a[80:95], a[120:123], v[112:115], a[80:95]
ds_read_b64_tr_b16 a[148:149], v229 offset:50176
ds_read_b64_tr_b16 a[150:151], v229 offset:50688
buffer_load_dwordx4 v250, s[96:99], s57 offen offset:1024 lds
s_add_u32 s57, s57, s18
v_mfma_f32_32x32x16_bf16 a[96:111], a[124:127], v[112:115], a[96:111]
ds_read_b64_tr_b16 a[152:153], v230 offset:50176
ds_read_b64_tr_b16 a[154:155], v230 offset:50688
buffer_load_dwordx4 a[224:227], v231, s[36:39], s79 offen sc1
v_exp_f32 v240, v240
s_waitcnt lgkmcnt(4)
v_mfma_f32_32x32x16_bf16 a[48:63], a[140:143], v[116:119], a[48:63]
ds_read_b64_tr_b16 a[112:113], v227 offset:51200
ds_read_b64_tr_b16 a[114:115], v227 offset:51712
v_exp_f32 v241, v241
v_mul_f32 v204, v196, v204
v_mfma_f32_32x32x16_bf16 a[64:79], a[144:147], v[116:119], a[64:79]
ds_read_b64_tr_b16 a[116:117], v228 offset:51200
ds_read_b64_tr_b16 a[118:119], v228 offset:51712
v_mul_f32 v205, v197, v205
v_fma_f32 v240, v240, v238, v238
s_waitcnt lgkmcnt(4)
v_mfma_f32_32x32x16_bf16 a[80:95], a[148:151], v[116:119], a[80:95]
ds_read_b64_tr_b16 a[120:121], v229 offset:51200
ds_read_b64_tr_b16 a[122:123], v229 offset:51712
buffer_load_dwordx4 v250, s[96:99], s57 offen offset:2048 lds
s_add_u32 s57, s57, s18
v_fma_f32 v241, v241, v238, v238
v_mfma_f32_32x32x16_bf16 a[96:111], a[152:155], v[116:119], a[96:111]
ds_read_b64_tr_b16 a[124:125], v230 offset:51200
ds_read_b64_tr_b16 a[126:127], v230 offset:51712
s_add_u32 s79, s78, 15360
buffer_load_dwordx4 a[228:231], v226, s[36:39], s79 offen sc1
s_waitcnt lgkmcnt(4)
v_mfma_f32_32x32x16_bf16 a[48:63], a[112:115], v[120:123], a[48:63]
ds_read_b64_tr_b16 a[140:141], v227 offset:52224
ds_read_b64_tr_b16 a[142:143], v227 offset:52736
v_rcp_f32 v240, v240
v_mfma_f32_32x32x16_bf16 a[64:79], a[116:119], v[120:123], a[64:79]
ds_read_b64_tr_b16 a[144:145], v228 offset:52224
ds_read_b64_tr_b16 a[146:147], v228 offset:52736
v_rcp_f32 v241, v241
s_waitcnt lgkmcnt(4)
v_mfma_f32_32x32x16_bf16 a[80:95], a[120:123], v[120:123], a[80:95]
ds_read_b64_tr_b16 a[148:149], v229 offset:52224
ds_read_b64_tr_b16 a[150:151], v229 offset:52736
buffer_load_dwordx4 v250, s[96:99], s57 offen offset:3072 lds
s_add_u32 s57, s57, s19
v_mul_f32 v196, v204, v240
v_mfma_f32_32x32x16_bf16 a[96:111], a[124:127], v[120:123], a[96:111]
ds_read_b64_tr_b16 a[152:153], v230 offset:52224
ds_read_b64_tr_b16 a[154:155], v230 offset:52736
buffer_load_dwordx4 a[232:235], v226, s[36:39], s79 offen offset:1024 sc1
v_mul_f32 v197, v205, v241
v_cvt_pk_bf16_f32 v194, v196, v197
s_waitcnt lgkmcnt(4)
v_mfma_f32_32x32x16_bf16 a[48:63], a[140:143], v[124:127], a[48:63]
v_mul_f32 v240, v198, v198
v_mul_f32 v241, v199, v199
v_fma_f32 v240, v240, v237, v236
v_fma_f32 v241, v241, v237, v236
v_mul_f32 v240, v198, v240
v_mfma_f32_32x32x16_bf16 a[64:79], a[144:147], v[124:127], a[64:79]
s_waitcnt vmcnt(10)
s_barrier
ds_read_b64_tr_b16 a[112:113], v227 offset:0
ds_read_b64_tr_b16 a[114:115], v227 offset:512
ds_read_b64_tr_b16 a[116:117], v228 offset:0
ds_read_b64_tr_b16 a[118:119], v228 offset:512
s_waitcnt lgkmcnt(4)
v_mfma_f32_32x32x16_bf16 a[80:95], a[148:151], v[124:127], a[80:95]
ds_read_b64_tr_b16 a[120:121], v229 offset:0
ds_read_b64_tr_b16 a[122:123], v229 offset:512
v_mul_f32 v241, v199, v241
v_exp_f32 v240, v240
v_mfma_f32_32x32x16_bf16 a[96:111], a[152:155], v[124:127], a[96:111]
ds_read_b64_tr_b16 a[124:125], v230 offset:0
ds_read_b64_tr_b16 a[126:127], v230 offset:512
buffer_load_dwordx4 a[236:239], v226, s[36:39], s79 offen offset:2048 sc1
v_exp_f32 v241, v241
s_waitcnt lgkmcnt(4)
v_mfma_f32_32x32x16_bf16 a[48:63], a[112:115], v[128:131], a[48:63]
ds_read_b64_tr_b16 a[140:141], v227 offset:1024
ds_read_b64_tr_b16 a[142:143], v227 offset:1536
v_mul_f32 v206, v198, v206
v_mul_f32 v207, v199, v207
v_fma_f32 v240, v240, v238, v238
v_mfma_f32_32x32x16_bf16 a[64:79], a[116:119], v[128:131], a[64:79]
ds_read_b64_tr_b16 a[144:145], v228 offset:1024
ds_read_b64_tr_b16 a[146:147], v228 offset:1536
v_fma_f32 v241, v241, v238, v238
s_waitcnt lgkmcnt(4)
v_mfma_f32_32x32x16_bf16 a[80:95], a[120:123], v[128:131], a[80:95]
ds_read_b64_tr_b16 a[148:149], v229 offset:1024
ds_read_b64_tr_b16 a[150:151], v229 offset:1536
v_rcp_f32 v240, v240
v_mfma_f32_32x32x16_bf16 a[96:111], a[124:127], v[128:131], a[96:111]
ds_read_b64_tr_b16 a[152:153], v230 offset:1024
ds_read_b64_tr_b16 a[154:155], v230 offset:1536
buffer_load_dwordx4 a[240:243], v226, s[36:39], s79 offen offset:3072 sc1
v_rcp_f32 v241, v241
s_waitcnt lgkmcnt(4)
v_mfma_f32_32x32x16_bf16 a[48:63], a[140:143], v[132:135], a[48:63]
ds_read_b64_tr_b16 a[112:113], v227 offset:2048
ds_read_b64_tr_b16 a[114:115], v227 offset:2560
v_mul_f32 v198, v206, v240
v_mul_f32 v199, v207, v241
v_cvt_pk_bf16_f32 v195, v198, v199
v_mfma_f32_32x32x16_bf16 a[64:79], a[144:147], v[132:135], a[64:79]
ds_read_b64_tr_b16 a[116:117], v228 offset:2048
ds_read_b64_tr_b16 a[118:119], v228 offset:2560
v_mul_f32 v240, v208, v208
v_mul_f32 v241, v209, v209
s_waitcnt lgkmcnt(4)
v_mfma_f32_32x32x16_bf16 a[80:95], a[148:151], v[132:135], a[80:95]
ds_read_b64_tr_b16 a[120:121], v229 offset:2048
ds_read_b64_tr_b16 a[122:123], v229 offset:2560
v_fma_f32 v240, v240, v237, v236
v_fma_f32 v241, v241, v237, v236
v_mul_f32 v240, v208, v240
v_mfma_f32_32x32x16_bf16 a[96:111], a[152:155], v[132:135], a[96:111]
ds_read_b64_tr_b16 a[124:125], v230 offset:2048
ds_read_b64_tr_b16 a[126:127], v230 offset:2560
buffer_load_dwordx4 a[244:247], v231, s[36:39], s79 offen sc1
v_mul_f32 v241, v209, v241
s_waitcnt lgkmcnt(4)
v_mfma_f32_32x32x16_bf16 a[48:63], a[112:115], v[136:139], a[48:63]
ds_read_b64_tr_b16 a[140:141], v227 offset:3072
ds_read_b64_tr_b16 a[142:143], v227 offset:3584
s_lshl_b32 s72, s5, 2
s_sub_u32 s72, 60, s72
s_lshr_b64 s[76:77], -1, s72
v_mfma_f32_32x32x16_bf16 a[64:79], a[116:119], v[136:139], a[64:79]
ds_read_b64_tr_b16 a[144:145], v228 offset:3072
ds_read_b64_tr_b16 a[146:147], v228 offset:3584
s_waitcnt lgkmcnt(4)
v_mfma_f32_32x32x16_bf16 a[80:95], a[120:123], v[136:139], a[80:95]
ds_read_b64_tr_b16 a[148:149], v229 offset:3072
ds_read_b64_tr_b16 a[150:151], v229 offset:3584
s_sub_u32 s72, s5, 2
s_cselect_b32 s72, 0, s72
s_lshl_b32 s72, s72, 2
v_mfma_f32_32x32x16_bf16 a[96:111], a[124:127], v[136:139], a[96:111]
ds_read_b64_tr_b16 a[152:153], v230 offset:3072
ds_read_b64_tr_b16 a[154:155], v230 offset:3584
s_lshr_b64 s[76:77], s[76:77], s72
s_lshl_b64 s[76:77], s[76:77], s72
v_lshrrev_b32 v168, 2, v224
s_waitcnt lgkmcnt(4)
v_mfma_f32_32x32x16_bf16 a[48:63], a[140:143], v[140:143], a[48:63]
v_lshlrev_b32 v168, 7, v168
v_and_b32 v164, 3, v224
v_lshl_add_u32 v168, v164, 4, v168
v_mov_b32 v164, 2146435072
v_cndmask_b32 v168, v164, v168, s[76:77]
v_mfma_f32_32x32x16_bf16 a[64:79], a[144:147], v[140:143], a[64:79]
s_waitcnt vmcnt(4)
s_barrier
ds_read_b64_tr_b16 a[112:113], v227 offset:16384
ds_read_b64_tr_b16 a[114:115], v227 offset:16896
ds_read_b64_tr_b16 a[116:117], v228 offset:16384
ds_read_b64_tr_b16 a[118:119], v228 offset:16896
s_waitcnt lgkmcnt(4)
v_mfma_f32_32x32x16_bf16 a[80:95], a[148:151], v[140:143], a[80:95]
ds_read_b64_tr_b16 a[120:121], v229 offset:16384
ds_read_b64_tr_b16 a[122:123], v229 offset:16896
s_mov_b32 s72, 20594816
buffer_load_dwordx4 v[164:167], v168, s[36:39], s72 offen sc1
v_mfma_f32_32x32x16_bf16 a[96:111], a[152:155], v[140:143], a[96:111]
ds_read_b64_tr_b16 a[124:125], v230 offset:16384
ds_read_b64_tr_b16 a[126:127], v230 offset:16896
v_exp_f32 v240, v240
s_waitcnt lgkmcnt(4)
v_mfma_f32_32x32x16_bf16 a[48:63], a[112:115], v[144:147], a[48:63]
ds_read_b64_tr_b16 a[140:141], v227 offset:17408
ds_read_b64_tr_b16 a[142:143], v227 offset:17920
v_exp_f32 v241, v241
v_mul_f32 v216, v208, v216
v_mfma_f32_32x32x16_bf16 a[64:79], a[116:119], v[144:147], a[64:79]
ds_read_b64_tr_b16 a[144:145], v228 offset:17408
ds_read_b64_tr_b16 a[146:147], v228 offset:17920
v_mul_f32 v217, v209, v217
v_fma_f32 v240, v240, v238, v238
s_waitcnt lgkmcnt(4)
v_mfma_f32_32x32x16_bf16 a[80:95], a[120:123], v[144:147], a[80:95]
ds_read_b64_tr_b16 a[148:149], v229 offset:17408
ds_read_b64_tr_b16 a[150:151], v229 offset:17920
v_fma_f32 v241, v241, v238, v238
v_rcp_f32 v240, v240
v_mfma_f32_32x32x16_bf16 a[96:111], a[124:127], v[144:147], a[96:111]
ds_read_b64_tr_b16 a[152:153], v230 offset:17408
ds_read_b64_tr_b16 a[154:155], v230 offset:17920
v_rcp_f32 v241, v241
v_mul_f32 v208, v216, v240
s_waitcnt lgkmcnt(4)
v_mfma_f32_32x32x16_bf16 a[48:63], a[140:143], v[148:151], a[48:63]
ds_read_b64_tr_b16 a[112:113], v227 offset:18432
ds_read_b64_tr_b16 a[114:115], v227 offset:18944
v_mul_f32 v209, v217, v241
v_cvt_pk_bf16_f32 v208, v208, v209
v_mul_f32 v240, v210, v210
v_mfma_f32_32x32x16_bf16 a[64:79], a[144:147], v[148:151], a[64:79]
ds_read_b64_tr_b16 a[116:117], v228 offset:18432
ds_read_b64_tr_b16 a[118:119], v228 offset:18944
v_mul_f32 v241, v211, v211
v_fma_f32 v240, v240, v237, v236
s_waitcnt lgkmcnt(4)
v_mfma_f32_32x32x16_bf16 a[80:95], a[148:151], v[148:151], a[80:95]
ds_read_b64_tr_b16 a[120:121], v229 offset:18432
ds_read_b64_tr_b16 a[122:123], v229 offset:18944
v_fma_f32 v241, v241, v237, v236
v_mul_f32 v240, v210, v240
v_mul_f32 v241, v211, v241
v_mfma_f32_32x32x16_bf16 a[96:111], a[152:155], v[148:151], a[96:111]
ds_read_b64_tr_b16 a[124:125], v230 offset:18432
ds_read_b64_tr_b16 a[126:127], v230 offset:18944
v_exp_f32 v240, v240
s_waitcnt lgkmcnt(4)
v_mfma_f32_32x32x16_bf16 a[48:63], a[112:115], v[152:155], a[48:63]
ds_read_b64_tr_b16 a[140:141], v227 offset:19456
ds_read_b64_tr_b16 a[142:143], v227 offset:19968
v_exp_f32 v241, v241
v_mul_f32 v218, v210, v218
v_mfma_f32_32x32x16_bf16 a[64:79], a[116:119], v[152:155], a[64:79]
ds_read_b64_tr_b16 a[144:145], v228 offset:19456
ds_read_b64_tr_b16 a[146:147], v228 offset:19968
v_mul_f32 v219, v211, v219
v_fma_f32 v240, v240, v238, v238
s_waitcnt lgkmcnt(4)
v_mfma_f32_32x32x16_bf16 a[80:95], a[120:123], v[152:155], a[80:95]
ds_read_b64_tr_b16 a[148:149], v229 offset:19456
ds_read_b64_tr_b16 a[150:151], v229 offset:19968
v_fma_f32 v241, v241, v238, v238
v_rcp_f32 v240, v240
v_mfma_f32_32x32x16_bf16 a[96:111], a[124:127], v[152:155], a[96:111]
ds_read_b64_tr_b16 a[152:153], v230 offset:19456
ds_read_b64_tr_b16 a[154:155], v230 offset:19968
v_rcp_f32 v241, v241
v_mul_f32 v210, v218, v240
s_waitcnt lgkmcnt(4)
v_mfma_f32_32x32x16_bf16 a[48:63], a[140:143], v[156:159], a[48:63]
v_mul_f32 v211, v219, v241
v_cvt_pk_bf16_f32 v209, v210, v211
v_mul_f32 v240, v212, v212
v_mul_f32 v241, v213, v213
v_fma_f32 v240, v240, v237, v236
v_mfma_f32_32x32x16_bf16 a[64:79], a[144:147], v[156:159], a[64:79]
v_fma_f32 v241, v241, v237, v236
v_mul_f32 v240, v212, v240
v_mul_f32 v241, v213, v241
s_waitcnt lgkmcnt(0)
v_mfma_f32_32x32x16_bf16 a[80:95], a[148:151], v[156:159], a[80:95]
v_exp_f32 v240, v240
v_exp_f32 v241, v241
v_mul_f32 v220, v212, v220
v_mfma_f32_32x32x16_bf16 a[96:111], a[152:155], v[156:159], a[96:111]
v_mul_f32 v221, v213, v221
v_fma_f32 v240, v240, v238, v238
v_fma_f32 v241, v241, v238, v238
v_rcp_f32 v240, v240
v_rcp_f32 v241, v241
v_mul_f32 v212, v220, v240
v_mul_f32 v213, v221, v241
v_cvt_pk_bf16_f32 v210, v212, v213
v_mul_f32 v240, v214, v214
v_mul_f32 v241, v215, v215
v_fma_f32 v240, v240, v237, v236
v_fma_f32 v241, v241, v237, v236
v_mul_f32 v240, v214, v240
v_mul_f32 v241, v215, v241
v_exp_f32 v240, v240
v_exp_f32 v241, v241
v_mul_f32 v222, v214, v222
v_mul_f32 v223, v215, v223
v_fma_f32 v240, v240, v238, v238
v_fma_f32 v241, v241, v238, v238
v_rcp_f32 v240, v240
v_rcp_f32 v241, v241
v_mul_f32 v214, v222, v240
v_mul_f32 v215, v223, v241
v_cvt_pk_bf16_f32 v211, v214, v215
s_lshl_b32 s69, s64, 13
s_add_u32 s69, s69, s67
s_add_u32 s69, s69, 0
buffer_store_dwordx4 v[160:163], v233, s[36:39], s69 offen sc1
s_lshl_b32 s69, s64, 13
s_add_u32 s69, s69, s67
s_add_u32 s69, s69, 512
buffer_store_dwordx4 v[176:179], v233, s[36:39], s69 offen sc1
s_lshl_b32 s69, s64, 13
s_add_u32 s69, s69, s67
s_add_u32 s69, s69, 4096
buffer_store_dwordx4 v[192:195], v233, s[36:39], s69 offen sc1
s_lshl_b32 s69, s64, 13
s_add_u32 s69, s69, s67
s_add_u32 s69, s69, 4608
buffer_store_dwordx4 v[208:211], v233, s[36:39], s69 offen sc1
s_nop 3
v_accvgpr_read_b32 v242, a48
v_accvgpr_read_b32 v243, a49
v_accvgpr_read_b32 v244, a56
v_accvgpr_read_b32 v245, a57
v_pk_mul_f32 v[240:241], v[242:243], v[242:243]
v_pk_fma_f32 v[240:241], v[240:241], v[236:237], v[236:237] op_sel:[0,1,0] op_sel_hi:[1,1,0]
v_pk_mul_f32 v[240:241], v[242:243], v[240:241]
v_exp_f32 v240, v240
v_exp_f32 v241, v241
v_pk_mul_f32 v[244:245], v[242:243], v[244:245]
v_pk_fma_f32 v[240:241], v[240:241], v[238:239], v[238:239] op_sel:[0,0,0] op_sel_hi:[1,0,0]
v_rcp_f32 v240, v240
v_rcp_f32 v241, v241
s_nop 0
v_pk_mul_f32 v[242:243], v[244:245], v[240:241]
v_cvt_pk_bf16_f32 v16, v242, v243
v_accvgpr_read_b32 v242, a50
v_accvgpr_read_b32 v243, a51
v_accvgpr_read_b32 v244, a58
v_accvgpr_read_b32 v245, a59
v_pk_mul_f32 v[240:241], v[242:243], v[242:243]
v_pk_fma_f32 v[240:241], v[240:241], v[236:237], v[236:237] op_sel:[0,1,0] op_sel_hi:[1,1,0]
v_pk_mul_f32 v[240:241], v[242:243], v[240:241]
v_exp_f32 v240, v240
v_exp_f32 v241, v241
v_pk_mul_f32 v[244:245], v[242:243], v[244:245]
v_pk_fma_f32 v[240:241], v[240:241], v[238:239], v[238:239] op_sel:[0,0,0] op_sel_hi:[1,0,0]
v_rcp_f32 v240, v240
v_rcp_f32 v241, v241
s_nop 0
v_pk_mul_f32 v[242:243], v[244:245], v[240:241]
v_cvt_pk_bf16_f32 v17, v242, v243
v_accvgpr_read_b32 v242, a52
v_accvgpr_read_b32 v243, a53
v_accvgpr_read_b32 v244, a60
v_accvgpr_read_b32 v245, a61
v_pk_mul_f32 v[240:241], v[242:243], v[242:243]
v_pk_fma_f32 v[240:241], v[240:241], v[236:237], v[236:237] op_sel:[0,1,0] op_sel_hi:[1,1,0]
v_pk_mul_f32 v[240:241], v[242:243], v[240:241]
v_exp_f32 v240, v240
v_exp_f32 v241, v241
v_pk_mul_f32 v[244:245], v[242:243], v[244:245]
v_pk_fma_f32 v[240:241], v[240:241], v[238:239], v[238:239] op_sel:[0,0,0] op_sel_hi:[1,0,0]
v_rcp_f32 v240, v240
v_rcp_f32 v241, v241
s_nop 0
v_pk_mul_f32 v[242:243], v[244:245], v[240:241]
v_cvt_pk_bf16_f32 v18, v242, v243
v_accvgpr_read_b32 v242, a54
v_accvgpr_read_b32 v243, a55
v_accvgpr_read_b32 v244, a62
v_accvgpr_read_b32 v245, a63
v_pk_mul_f32 v[240:241], v[242:243], v[242:243]
v_pk_fma_f32 v[240:241], v[240:241], v[236:237], v[236:237] op_sel:[0,1,0] op_sel_hi:[1,1,0]
v_pk_mul_f32 v[240:241], v[242:243], v[240:241]
v_exp_f32 v240, v240
v_exp_f32 v241, v241
v_pk_mul_f32 v[244:245], v[242:243], v[244:245]
v_pk_fma_f32 v[240:241], v[240:241], v[238:239], v[238:239] op_sel:[0,0,0] op_sel_hi:[1,0,0]
v_rcp_f32 v240, v240
v_rcp_f32 v241, v241
s_nop 0
v_pk_mul_f32 v[242:243], v[244:245], v[240:241]
v_cvt_pk_bf16_f32 v19, v242, v243
s_waitcnt vmcnt(4)
s_mov_b32 s70, 0
L_pq_7:
v_xor_b32 v164, s4, v164
v_xor_b32 v165, s4, v165
v_xor_b32 v166, s4, v166
v_xor_b32 v167, s4, v167
v_or3_b32 v164, v164, v165, v166
v_or_b32 v164, v164, v167
v_cmp_ne_u32 vcc, 0, v164
s_nop 3
s_and_b64 vcc, vcc, s[76:77]
s_cbranch_scc0 L_pd_8
s_add_u32 s70, s70, 1
s_cmp_ge_u32 s70, 200000
s_cbranch_scc1 L_pd_8
s_sleep 2
s_mov_b32 s72, 20594816
buffer_load_dwordx4 v[164:167], v168, s[36:39], s72 offen sc1
s_waitcnt vmcnt(0)
s_branch L_pq_7
L_pd_8:
s_barrier
s_lshl_b32 s70, s5, 11
s_sub_u32 s70, s70, 4096
s_mul_i32 s71, s6, 5
s_add_u32 s72, s3, 0
s_cmp_lt_u32 s72, 5
s_mov_b32 s73, 155
s_cselect_b32 s73, 80, s73
s_add_u32 s73, s73, s71
s_add_u32 s73, s73, s72
s_lshl_b32 s73, s73, 15
s_add_u32 s73, s73, s70
s_mul_i32 s74, s72, 6208
s_add_u32 s74, s74, 0
s_cmp_lt_u32 s72, 10
s_cselect_b32 s73, s73, 2146435072
s_cselect_b32 m0, s74, 0x30000
s_cmp_lt_u32 s5, 2
s_cselect_b32 s74, 2146435072, s73
buffer_load_dwordx4 v226, s[36:39], s74 offen sc1 lds
v_accvgpr_read_b32 v242, a64
v_accvgpr_read_b32 v243, a65
v_accvgpr_read_b32 v244, a72
v_accvgpr_read_b32 v245, a73
v_pk_mul_f32 v[240:241], v[242:243], v[242:243]
v_pk_fma_f32 v[240:241], v[240:241], v[236:237], v[236:237] op_sel:[0,1,0] op_sel_hi:[1,1,0]
v_pk_mul_f32 v[240:241], v[242:243], v[240:241]
v_exp_f32 v240, v240
v_exp_f32 v241, v241
v_pk_mul_f32 v[244:245], v[242:243], v[244:245]
buffer_load_dwordx4 v226, s[36:39], s74 offen offset:1024 sc1 lds
v_pk_fma_f32 v[240:241], v[240:241], v[238:239], v[238:239] op_sel:[0,0,0] op_sel_hi:[1,0,0]
v_rcp_f32 v240, v240
v_rcp_f32 v241, v241
s_nop 0
v_pk_mul_f32 v[242:243], v[244:245], v[240:241]
v_cvt_pk_bf16_f32 v20, v242, v243
v_accvgpr_read_b32 v242, a66
v_accvgpr_read_b32 v243, a67
v_accvgpr_read_b32 v244, a74
v_accvgpr_read_b32 v245, a75
s_cmp_lt_u32 s5, 1
s_cselect_b32 s74, 2146435072, s73
buffer_load_dwordx4 v226, s[36:39], s74 offen offset:2048 sc1 lds
v_pk_mul_f32 v[240:241], v[242:243], v[242:243]
v_pk_fma_f32 v[240:241], v[240:241], v[236:237], v[236:237] op_sel:[0,1,0] op_sel_hi:[1,1,0]
v_pk_mul_f32 v[240:241], v[242:243], v[240:241]
v_exp_f32 v240, v240
v_exp_f32 v241, v241
v_pk_mul_f32 v[244:245], v[242:243], v[244:245]
v_pk_fma_f32 v[240:241], v[240:241], v[238:239], v[238:239] op_sel:[0,0,0] op_sel_hi:[1,0,0]
v_rcp_f32 v240, v240
v_rcp_f32 v241, v241
s_nop 0
buffer_load_dwordx4 v226, s[36:39], s74 offen offset:3072 sc1 lds
v_pk_mul_f32 v[242:243], v[244:245], v[240:241]
v_cvt_pk_bf16_f32 v21, v242, v243
v_accvgpr_read_b32 v242, a68
v_accvgpr_read_b32 v243, a69
v_accvgpr_read_b32 v244, a76
v_accvgpr_read_b32 v245, a77
v_pk_mul_f32 v[240:241], v[242:243], v[242:243]
v_pk_fma_f32 v[240:241], v[240:241], v[236:237], v[236:237] op_sel:[0,1,0] op_sel_hi:[1,1,0]
v_pk_mul_f32 v[240:241], v[242:243], v[240:241]
v_exp_f32 v240, v240
s_add_u32 s74, s73, 4096
s_add_u32 m0, m0, 4096
s_nop 0
buffer_load_dwordx4 v226, s[36:39], s74 offen sc1 lds
v_exp_f32 v241, v241
v_pk_mul_f32 v[244:245], v[242:243], v[244:245]
v_pk_fma_f32 v[240:241], v[240:241], v[238:239], v[238:239] op_sel:[0,0,0] op_sel_hi:[1,0,0]
v_rcp_f32 v240, v240
v_rcp_f32 v241, v241
s_nop 0
v_pk_mul_f32 v[242:243], v[244:245], v[240:241]
v_cvt_pk_bf16_f32 v22, v242, v243
v_accvgpr_read_b32 v242, a70
v_accvgpr_read_b32 v243, a71
buffer_load_dwordx4 v226, s[36:39], s74 offen offset:1024 sc1 lds
v_accvgpr_read_b32 v244, a78
v_accvgpr_read_b32 v245, a79
v_pk_mul_f32 v[240:241], v[242:243], v[242:243]
v_pk_fma_f32 v[240:241], v[240:241], v[236:237], v[236:237] op_sel:[0,1,0] op_sel_hi:[1,1,0]
v_pk_mul_f32 v[240:241], v[242:243], v[240:241]
v_exp_f32 v240, v240
v_exp_f32 v241, v241
v_pk_mul_f32 v[244:245], v[242:243], v[244:245]
v_pk_fma_f32 v[240:241], v[240:241], v[238:239], v[238:239] op_sel:[0,0,0] op_sel_hi:[1,0,0]
v_rcp_f32 v240, v240
s_add_u32 s72, s3, 4
s_cmp_lt_u32 s72, 5
s_mov_b32 s73, 155
s_cselect_b32 s73, 80, s73
s_add_u32 s73, s73, s71
s_add_u32 s73, s73, s72
s_lshl_b32 s73, s73, 15
s_add_u32 s73, s73, s70
s_mul_i32 s74, s72, 6208
s_add_u32 s74, s74, 0
s_cmp_lt_u32 s72, 10
s_cselect_b32 s73, s73, 2146435072
s_cselect_b32 m0, s74, 0x30000
s_cmp_lt_u32 s5, 2
s_cselect_b32 s74, 2146435072, s73
buffer_load_dwordx4 v226, s[36:39], s74 offen sc1 lds
v_rcp_f32 v241, v241
s_nop 0
v_pk_mul_f32 v[242:243], v[244:245], v[240:241]
v_cvt_pk_bf16_f32 v23, v242, v243
v_accvgpr_read_b32 v242, a80
v_accvgpr_read_b32 v243, a81
v_accvgpr_read_b32 v244, a88
v_accvgpr_read_b32 v245, a89
v_pk_mul_f32 v[240:241], v[242:243], v[242:243]
v_pk_fma_f32 v[240:241], v[240:241], v[236:237], v[236:237] op_sel:[0,1,0] op_sel_hi:[1,1,0]
buffer_load_dwordx4 v226, s[36:39], s74 offen offset:1024 sc1 lds
v_pk_mul_f32 v[240:241], v[242:243], v[240:241]
v_exp_f32 v240, v240
v_exp_f32 v241, v241
v_pk_mul_f32 v[244:245], v[242:243], v[244:245]
v_pk_fma_f32 v[240:241], v[240:241], v[238:239], v[238:239] op_sel:[0,0,0] op_sel_hi:[1,0,0]
v_rcp_f32 v240, v240
v_rcp_f32 v241, v241
s_nop 0
v_pk_mul_f32 v[242:243], v[244:245], v[240:241]
v_cvt_pk_bf16_f32 v24, v242, v243
s_cmp_lt_u32 s5, 1
s_cselect_b32 s74, 2146435072, s73
buffer_load_dwordx4 v226, s[36:39], s74 offen offset:2048 sc1 lds
v_accvgpr_read_b32 v242, a82
v_accvgpr_read_b32 v243, a83
v_accvgpr_read_b32 v244, a90
v_accvgpr_read_b32 v245, a91
v_pk_mul_f32 v[240:241], v[242:243], v[242:243]
v_pk_fma_f32 v[240:241], v[240:241], v[236:237], v[236:237] op_sel:[0,1,0] op_sel_hi:[1,1,0]
v_pk_mul_f32 v[240:241], v[242:243], v[240:241]
v_exp_f32 v240, v240
v_exp_f32 v241, v241
v_pk_mul_f32 v[244:245], v[242:243], v[244:245]
buffer_load_dwordx4 v226, s[36:39], s74 offen offset:3072 sc1 lds
v_pk_fma_f32 v[240:241], v[240:241], v[238:239], v[238:239] op_sel:[0,0,0] op_sel_hi:[1,0,0]
v_rcp_f32 v240, v240
v_rcp_f32 v241, v241
s_nop 0
v_pk_mul_f32 v[242:243], v[244:245], v[240:241]
v_cvt_pk_bf16_f32 v25, v242, v243
v_accvgpr_read_b32 v242, a84
v_accvgpr_read_b32 v243, a85
v_accvgpr_read_b32 v244, a92
v_accvgpr_read_b32 v245, a93
s_add_u32 s74, s73, 4096
s_add_u32 m0, m0, 4096
s_nop 0
buffer_load_dwordx4 v226, s[36:39], s74 offen sc1 lds
v_pk_mul_f32 v[240:241], v[242:243], v[242:243]
v_pk_fma_f32 v[240:241], v[240:241], v[236:237], v[236:237] op_sel:[0,1,0] op_sel_hi:[1,1,0]
v_pk_mul_f32 v[240:241], v[242:243], v[240:241]
v_exp_f32 v240, v240
v_exp_f32 v241, v241
v_pk_mul_f32 v[244:245], v[242:243], v[244:245]
v_pk_fma_f32 v[240:241], v[240:241], v[238:239], v[238:239] op_sel:[0,0,0] op_sel_hi:[1,0,0]
v_rcp_f32 v240, v240
v_rcp_f32 v241, v241
s_nop 0
buffer_load_dwordx4 v226, s[36:39], s74 offen offset:1024 sc1 lds
v_pk_mul_f32 v[242:243], v[244:245], v[240:241]
v_cvt_pk_bf16_f32 v26, v242, v243
v_accvgpr_read_b32 v242, a86
v_accvgpr_read_b32 v243, a87
v_accvgpr_read_b32 v244, a94
v_accvgpr_read_b32 v245, a95
v_pk_mul_f32 v[240:241], v[242:243], v[242:243]
v_pk_fma_f32 v[240:241], v[240:241], v[236:237], v[236:237] op_sel:[0,1,0] op_sel_hi:[1,1,0]
v_pk_mul_f32 v[240:241], v[242:243], v[240:241]
v_exp_f32 v240, v240
s_add_u32 s72, s3, 8
s_cmp_lt_u32 s72, 5
s_mov_b32 s73, 155
s_cselect_b32 s73, 80, s73
s_add_u32 s73, s73, s71
s_add_u32 s73, s73, s72
s_lshl_b32 s73, s73, 15
s_add_u32 s73, s73, s70
s_mul_i32 s74, s72, 6208
s_add_u32 s74, s74, 0
s_cmp_lt_u32 s72, 10
s_cselect_b32 s73, s73, 2146435072
s_cselect_b32 m0, s74, 0x30000
s_cmp_lt_u32 s5, 2
s_cselect_b32 s74, 2146435072, s73
buffer_load_dwordx4 v226, s[36:39], s74 offen sc1 lds
v_exp_f32 v241, v241
v_pk_mul_f32 v[244:245], v[242:243], v[244:245]
v_pk_fma_f32 v[240:241], v[240:241], v[238:239], v[238:239] op_sel:[0,0,0] op_sel_hi:[1,0,0]
v_rcp_f32 v240, v240
v_rcp_f32 v241, v241
s_nop 0
v_pk_mul_f32 v[242:243], v[244:245], v[240:241]
v_cvt_pk_bf16_f32 v27, v242, v243
v_accvgpr_read_b32 v242, a96
v_accvgpr_read_b32 v243, a97
buffer_load_dwordx4 v226, s[36:39], s74 offen offset:1024 sc1 lds
v_accvgpr_read_b32 v244, a104
v_accvgpr_read_b32 v245, a105
v_pk_mul_f32 v[240:241], v[242:243], v[242:243]
v_pk_fma_f32 v[240:241], v[240:241], v[236:237], v[236:237] op_sel:[0,1,0] op_sel_hi:[1,1,0]
v_pk_mul_f32 v[240:241], v[242:243], v[240:241]
v_exp_f32 v240, v240
v_exp_f32 v241, v241
v_pk_mul_f32 v[244:245], v[242:243], v[244:245]
v_pk_fma_f32 v[240:241], v[240:241], v[238:239], v[238:239] op_sel:[0,0,0] op_sel_hi:[1,0,0]
v_rcp_f32 v240, v240
s_cmp_lt_u32 s5, 1
s_cselect_b32 s74, 2146435072, s73
buffer_load_dwordx4 v226, s[36:39], s74 offen offset:2048 sc1 lds
v_rcp_f32 v241, v241
s_nop 0
v_pk_mul_f32 v[242:243], v[244:245], v[240:241]
v_cvt_pk_bf16_f32 v28, v242, v243
v_accvgpr_read_b32 v242, a98
v_accvgpr_read_b32 v243, a99
v_accvgpr_read_b32 v244, a106
v_accvgpr_read_b32 v245, a107
v_pk_mul_f32 v[240:241], v[242:243], v[242:243]
v_pk_fma_f32 v[240:241], v[240:241], v[236:237], v[236:237] op_sel:[0,1,0] op_sel_hi:[1,1,0]
buffer_load_dwordx4 v226, s[36:39], s74 offen offset:3072 sc1 lds
v_pk_mul_f32 v[240:241], v[242:243], v[240:241]
v_exp_f32 v240, v240
v_exp_f32 v241, v241
v_pk_mul_f32 v[244:245], v[242:243], v[244:245]
v_pk_fma_f32 v[240:241], v[240:241], v[238:239], v[238:239] op_sel:[0,0,0] op_sel_hi:[1,0,0]
v_rcp_f32 v240, v240
v_rcp_f32 v241, v241
s_nop 0
v_pk_mul_f32 v[242:243], v[244:245], v[240:241]
v_cvt_pk_bf16_f32 v29, v242, v243
s_add_u32 s74, s73, 4096
s_add_u32 m0, m0, 4096
s_nop 0
buffer_load_dwordx4 v226, s[36:39], s74 offen sc1 lds
v_accvgpr_read_b32 v242, a100
v_accvgpr_read_b32 v243, a101
v_accvgpr_read_b32 v244, a108
v_accvgpr_read_b32 v245, a109
v_pk_mul_f32 v[240:241], v[242:243], v[242:243]
v_pk_fma_f32 v[240:241], v[240:241], v[236:237], v[236:237] op_sel:[0,1,0] op_sel_hi:[1,1,0]
v_pk_mul_f32 v[240:241], v[242:243], v[240:241]
v_exp_f32 v240, v240
v_exp_f32 v241, v241
v_pk_mul_f32 v[244:245], v[242:243], v[244:245]
buffer_load_dwordx4 v226, s[36:39], s74 offen offset:1024 sc1 lds
v_pk_fma_f32 v[240:241], v[240:241], v[238:239], v[238:239] op_sel:[0,0,0] op_sel_hi:[1,0,0]
v_rcp_f32 v240, v240
v_rcp_f32 v241, v241
s_nop 0
v_pk_mul_f32 v[242:243], v[244:245], v[240:241]
v_cvt_pk_bf16_f32 v30, v242, v243
v_accvgpr_read_b32 v242, a102
v_accvgpr_read_b32 v243, a103
v_accvgpr_read_b32 v244, a110
v_accvgpr_read_b32 v245, a111
v_pk_mul_f32 v[240:241], v[242:243], v[242:243]
v_pk_fma_f32 v[240:241], v[240:241], v[236:237], v[236:237] op_sel:[0,1,0] op_sel_hi:[1,1,0]
v_pk_mul_f32 v[240:241], v[242:243], v[240:241]
v_exp_f32 v240, v240
v_exp_f32 v241, v241
v_pk_mul_f32 v[244:245], v[242:243], v[244:245]
v_pk_fma_f32 v[240:241], v[240:241], v[238:239], v[238:239] op_sel:[0,0,0] op_sel_hi:[1,0,0]
v_rcp_f32 v240, v240
v_rcp_f32 v241, v241
s_nop 0
v_pk_mul_f32 v[242:243], v[244:245], v[240:241]
v_cvt_pk_bf16_f32 v31, v242, v243
s_lshl_b32 s72, s5, 7
s_lshl_b32 s73, s3, 5
s_add_u32 s72, s72, s73
s_lshl_b32 s72, s72, 4
s_lshl_b32 s73, s71, 15
s_add_u32 s72, s72, s73
s_add_u32 s73, s72, 98304
s_add_u32 s74, s72, 65536
v_and_b32 v252, 31, v224
v_lshlrev_b32 v252, 4, v252
v_cmp_gt_u32 vcc, 32, v224
v_mov_b32 v253, 2146435072
s_nop 0
v_cndmask_b32 v252, v253, v252, vcc
buffer_load_dwordx4 v[128:131], v239, s[36:39], s72 offen sc1
buffer_load_dwordx4 v[138:141], v239, s[36:39], s73 offen sc1
buffer_load_dwordx2 v[132:133], v252, s[36:39], s74 offen sc1
buffer_load_dwordx2 v[136:137], v252, s[36:39], s74 offen offset:8 sc1
v_mov_b32 v253, 0x3f80
v_cndmask_b32 v134, v253, 0, vcc
v_mov_b32 v135, 0
s_lshl_b32 s69, s65, 13
s_add_u32 s69, s69, s67
s_add_u32 s69, s69, 0
buffer_store_dwordx4 v[16:19], v233, s[36:39], s69 offen sc1
s_lshl_b32 s69, s65, 13
s_add_u32 s69, s69, s67
s_add_u32 s69, s69, 512
buffer_store_dwordx4 v[20:23], v233, s[36:39], s69 offen sc1
s_lshl_b32 s69, s65, 13
s_add_u32 s69, s69, s67
s_add_u32 s69, s69, 4096
buffer_store_dwordx4 v[24:27], v233, s[36:39], s69 offen sc1
s_lshl_b32 s69, s65, 13
s_add_u32 s69, s69, s67
s_add_u32 s69, s69, 4608
buffer_store_dwordx4 v[28:31], v233, s[36:39], s69 offen sc1
s_branch L_ab_done
L_typeB:
s_nop 7
s_nop 3
s_add_u32 s71, s62, 0
s_cmp_lt_u32 s71, 20
s_cselect_b32 s68, 0x3ea52b5c, 1.0
v_mul_f32 v248, s68, v235
s_lshl_b32 s69, s71, 17
s_lshl_b32 s68, s54, 4
s_add_u32 s69, s69, s68
v_accvgpr_read_b32 v240, a0
v_accvgpr_read_b32 v241, a1
v_accvgpr_read_b32 v242, a2
v_accvgpr_read_b32 v243, a3
v_accvgpr_read_b32 v244, a4
v_accvgpr_read_b32 v245, a5
v_accvgpr_read_b32 v246, a6
v_accvgpr_read_b32 v247, a7
v_pk_mul_f32 v[240:241], v[240:241], v[248:249] op_sel:[0,0] op_sel_hi:[1,0]
v_pk_mul_f32 v[242:243], v[242:243], v[248:249] op_sel:[0,0] op_sel_hi:[1,0]
v_pk_mul_f32 v[244:245], v[244:245], v[248:249] op_sel:[0,0] op_sel_hi:[1,0]
v_pk_mul_f32 v[246:247], v[246:247], v[248:249] op_sel:[0,0] op_sel_hi:[1,0]
v_cvt_pk_bf16_f32 v240, v240, v241
v_cvt_pk_bf16_f32 v241, v242, v243
v_cvt_pk_bf16_f32 v242, v244, v245
v_cvt_pk_bf16_f32 v243, v246, v247
s_nop 0
v_permlane32_swap_b32 v240, v242
v_permlane32_swap_b32 v241, v243
buffer_store_dwordx4 v[240:243], v239, s[36:39], s69 offen sc1
s_add_u32 s69, s69, 65536
s_nop 0
v_accvgpr_read_b32 v240, a8
v_accvgpr_read_b32 v241, a9
v_accvgpr_read_b32 v242, a10
v_accvgpr_read_b32 v243, a11
v_accvgpr_read_b32 v244, a12
v_accvgpr_read_b32 v245, a13
v_accvgpr_read_b32 v246, a14
v_accvgpr_read_b32 v247, a15
v_pk_mul_f32 v[240:241], v[240:241], v[248:249] op_sel:[0,0] op_sel_hi:[1,0]
v_pk_mul_f32 v[242:243], v[242:243], v[248:249] op_sel:[0,0] op_sel_hi:[1,0]
v_pk_mul_f32 v[244:245], v[244:245], v[248:249] op_sel:[0,0] op_sel_hi:[1,0]
v_pk_mul_f32 v[246:247], v[246:247], v[248:249] op_sel:[0,0] op_sel_hi:[1,0]
v_cvt_pk_bf16_f32 v240, v240, v241
v_cvt_pk_bf16_f32 v241, v242, v243
v_cvt_pk_bf16_f32 v242, v244, v245
v_cvt_pk_bf16_f32 v243, v246, v247
s_nop 0
v_permlane32_swap_b32 v240, v242
v_permlane32_swap_b32 v241, v243
buffer_store_dwordx4 v[240:243], v239, s[36:39], s69 offen sc1
s_add_u32 s71, s62, 1
s_cmp_lt_u32 s71, 20
s_cselect_b32 s68, 0x3ea52b5c, 1.0
v_mul_f32 v248, s68, v235
s_lshl_b32 s69, s71, 17
s_lshl_b32 s68, s54, 4
s_add_u32 s69, s69, s68
v_accvgpr_read_b32 v240, a16
v_accvgpr_read_b32 v241, a17
v_accvgpr_read_b32 v242, a18
v_accvgpr_read_b32 v243, a19
v_accvgpr_read_b32 v244, a20
v_accvgpr_read_b32 v245, a21
v_accvgpr_read_b32 v246, a22
v_accvgpr_read_b32 v247, a23
v_pk_mul_f32 v[240:241], v[240:241], v[248:249] op_sel:[0,0] op_sel_hi:[1,0]
v_pk_mul_f32 v[242:243], v[242:243], v[248:249] op_sel:[0,0] op_sel_hi:[1,0]
v_pk_mul_f32 v[244:245], v[244:245], v[248:249] op_sel:[0,0] op_sel_hi:[1,0]
v_pk_mul_f32 v[246:247], v[246:247], v[248:249] op_sel:[0,0] op_sel_hi:[1,0]
v_cvt_pk_bf16_f32 v240, v240, v241
v_cvt_pk_bf16_f32 v241, v242, v243
v_cvt_pk_bf16_f32 v242, v244, v245
v_cvt_pk_bf16_f32 v243, v246, v247
s_nop 0
v_permlane32_swap_b32 v240, v242
v_permlane32_swap_b32 v241, v243
buffer_store_dwordx4 v[240:243], v239, s[36:39], s69 offen sc1
s_add_u32 s69, s69, 65536
s_nop 0
v_accvgpr_read_b32 v240, a24
v_accvgpr_read_b32 v241, a25
v_accvgpr_read_b32 v242, a26
v_accvgpr_read_b32 v243, a27
v_accvgpr_read_b32 v244, a28
v_accvgpr_read_b32 v245, a29
v_accvgpr_read_b32 v246, a30
v_accvgpr_read_b32 v247, a31
v_pk_mul_f32 v[240:241], v[240:241], v[248:249] op_sel:[0,0] op_sel_hi:[1,0]
v_pk_mul_f32 v[242:243], v[242:243], v[248:249] op_sel:[0,0] op_sel_hi:[1,0]
v_pk_mul_f32 v[244:245], v[244:245], v[248:249] op_sel:[0,0] op_sel_hi:[1,0]
v_pk_mul_f32 v[246:247], v[246:247], v[248:249] op_sel:[0,0] op_sel_hi:[1,0]
v_cvt_pk_bf16_f32 v240, v240, v241
v_cvt_pk_bf16_f32 v241, v242, v243
v_cvt_pk_bf16_f32 v242, v244, v245
v_cvt_pk_bf16_f32 v243, v246, v247
s_nop 0
v_permlane32_swap_b32 v240, v242
v_permlane32_swap_b32 v241, v243
buffer_store_dwordx4 v[240:243], v239, s[36:39], s69 offen sc1
s_add_u32 s71, s62, 2
s_cmp_lt_u32 s71, 20
s_cselect_b32 s68, 0x3ea52b5c, 1.0
v_mul_f32 v248, s68, v235
s_lshl_b32 s69, s71, 17
s_lshl_b32 s68, s54, 4
s_add_u32 s69, s69, s68
v_accvgpr_read_b32 v240, a32
v_accvgpr_read_b32 v241, a33
v_accvgpr_read_b32 v242, a34
v_accvgpr_read_b32 v243, a35
v_accvgpr_read_b32 v244, a36
v_accvgpr_read_b32 v245, a37
v_accvgpr_read_b32 v246, a38
v_accvgpr_read_b32 v247, a39
v_pk_mul_f32 v[240:241], v[240:241], v[248:249] op_sel:[0,0] op_sel_hi:[1,0]
v_pk_mul_f32 v[242:243], v[242:243], v[248:249] op_sel:[0,0] op_sel_hi:[1,0]
v_pk_mul_f32 v[244:245], v[244:245], v[248:249] op_sel:[0,0] op_sel_hi:[1,0]
v_pk_mul_f32 v[246:247], v[246:247], v[248:249] op_sel:[0,0] op_sel_hi:[1,0]
v_cvt_pk_bf16_f32 v240, v240, v241
v_cvt_pk_bf16_f32 v241, v242, v243
v_cvt_pk_bf16_f32 v242, v244, v245
v_cvt_pk_bf16_f32 v243, v246, v247
s_nop 0
v_permlane32_swap_b32 v240, v242
v_permlane32_swap_b32 v241, v243
buffer_store_dwordx4 v[240:243], v239, s[36:39], s69 offen sc1
s_add_u32 s69, s69, 65536
s_nop 0
v_accvgpr_read_b32 v240, a40
v_accvgpr_read_b32 v241, a41
v_accvgpr_read_b32 v242, a42
v_accvgpr_read_b32 v243, a43
v_accvgpr_read_b32 v244, a44
v_accvgpr_read_b32 v245, a45
v_accvgpr_read_b32 v246, a46
v_accvgpr_read_b32 v247, a47
v_pk_mul_f32 v[240:241], v[240:241], v[248:249] op_sel:[0,0] op_sel_hi:[1,0]
v_pk_mul_f32 v[242:243], v[242:243], v[248:249] op_sel:[0,0] op_sel_hi:[1,0]
v_pk_mul_f32 v[244:245], v[244:245], v[248:249] op_sel:[0,0] op_sel_hi:[1,0]
v_pk_mul_f32 v[246:247], v[246:247], v[248:249] op_sel:[0,0] op_sel_hi:[1,0]
v_cvt_pk_bf16_f32 v240, v240, v241
v_cvt_pk_bf16_f32 v241, v242, v243
v_cvt_pk_bf16_f32 v242, v244, v245
v_cvt_pk_bf16_f32 v243, v246, v247
s_nop 0
v_permlane32_swap_b32 v240, v242
v_permlane32_swap_b32 v241, v243
buffer_store_dwordx4 v[240:243], v239, s[36:39], s69 offen sc1
s_add_u32 s71, s61, 0
s_cmp_lt_u32 s71, 20
s_cselect_b32 s68, 0x3ea52b5c, 1.0
v_mul_f32 v248, s68, v235
s_lshl_b32 s69, s71, 17
s_lshl_b32 s68, s54, 4
s_add_u32 s69, s69, s68
v_pk_mul_f32 v[240:241], v[160:161], v[248:249] op_sel:[0,0] op_sel_hi:[1,0]
v_pk_mul_f32 v[242:243], v[162:163], v[248:249] op_sel:[0,0] op_sel_hi:[1,0]
v_pk_mul_f32 v[244:245], v[164:165], v[248:249] op_sel:[0,0] op_sel_hi:[1,0]
v_pk_mul_f32 v[246:247], v[166:167], v[248:249] op_sel:[0,0] op_sel_hi:[1,0]
v_cvt_pk_bf16_f32 v240, v240, v241
v_cvt_pk_bf16_f32 v241, v242, v243
v_cvt_pk_bf16_f32 v242, v244, v245
v_cvt_pk_bf16_f32 v243, v246, v247
s_nop 0
v_permlane32_swap_b32 v240, v242
v_permlane32_swap_b32 v241, v243
buffer_store_dwordx4 v[240:243], v239, s[36:39], s69 offen sc1
s_add_u32 s69, s69, 65536
s_nop 0
v_pk_mul_f32 v[240:241], v[168:169], v[248:249] op_sel:[0,0] op_sel_hi:[1,0]
v_pk_mul_f32 v[242:243], v[170:171], v[248:249] op_sel:[0,0] op_sel_hi:[1,0]
v_pk_mul_f32 v[244:245], v[172:173], v[248:249] op_sel:[0,0] op_sel_hi:[1,0]
v_pk_mul_f32 v[246:247], v[174:175], v[248:249] op_sel:[0,0] op_sel_hi:[1,0]
v_cvt_pk_bf16_f32 v240, v240, v241
v_cvt_pk_bf16_f32 v241, v242, v243
v_cvt_pk_bf16_f32 v242, v244, v245
v_cvt_pk_bf16_f32 v243, v246, v247
s_nop 0
v_permlane32_swap_b32 v240, v242
v_permlane32_swap_b32 v241, v243
buffer_store_dwordx4 v[240:243], v239, s[36:39], s69 offen sc1
s_add_u32 s71, s61, 1
s_cmp_lt_u32 s71, 20
s_cselect_b32 s68, 0x3ea52b5c, 1.0
v_mul_f32 v248, s68, v235
s_lshl_b32 s69, s71, 17
s_lshl_b32 s68, s54, 4
s_add_u32 s69, s69, s68
v_pk_mul_f32 v[240:241], v[176:177], v[248:249] op_sel:[0,0] op_sel_hi:[1,0]
v_pk_mul_f32 v[242:243], v[178:179], v[248:249] op_sel:[0,0] op_sel_hi:[1,0]
v_pk_mul_f32 v[244:245], v[180:181], v[248:249] op_sel:[0,0] op_sel_hi:[1,0]
v_pk_mul_f32 v[246:247], v[182:183], v[248:249] op_sel:[0,0] op_sel_hi:[1,0]
v_cvt_pk_bf16_f32 v240, v240, v241
v_cvt_pk_bf16_f32 v241, v242, v243
v_cvt_pk_bf16_f32 v242, v244, v245
v_cvt_pk_bf16_f32 v243, v246, v247
s_nop 0
v_permlane32_swap_b32 v240, v242
v_permlane32_swap_b32 v241, v243
buffer_store_dwordx4 v[240:243], v239, s[36:39], s69 offen sc1
s_add_u32 s69, s69, 65536
s_nop 0
v_pk_mul_f32 v[240:241], v[184:185], v[248:249] op_sel:[0,0] op_sel_hi:[1,0]
v_pk_mul_f32 v[242:243], v[186:187], v[248:249] op_sel:[0,0] op_sel_hi:[1,0]
v_pk_mul_f32 v[244:245], v[188:189], v[248:249] op_sel:[0,0] op_sel_hi:[1,0]
v_pk_mul_f32 v[246:247], v[190:191], v[248:249] op_sel:[0,0] op_sel_hi:[1,0]
v_cvt_pk_bf16_f32 v240, v240, v241
v_cvt_pk_bf16_f32 v241, v242, v243
v_cvt_pk_bf16_f32 v242, v244, v245
v_cvt_pk_bf16_f32 v243, v246, v247
s_nop 0
v_permlane32_swap_b32 v240, v242
v_permlane32_swap_b32 v241, v243
buffer_store_dwordx4 v[240:243], v239, s[36:39], s69 offen sc1
s_add_u32 s71, s61, 2
s_cmp_lt_u32 s71, 20
s_cselect_b32 s68, 0x3ea52b5c, 1.0
v_mul_f32 v248, s68, v235
s_lshl_b32 s69, s71, 17
s_lshl_b32 s68, s54, 4
s_add_u32 s69, s69, s68
v_pk_mul_f32 v[240:241], v[192:193], v[248:249] op_sel:[0,0] op_sel_hi:[1,0]
v_pk_mul_f32 v[242:243], v[194:195], v[248:249] op_sel:[0,0] op_sel_hi:[1,0]
v_pk_mul_f32 v[244:245], v[196:197], v[248:249] op_sel:[0,0] op_sel_hi:[1,0]
v_pk_mul_f32 v[246:247], v[198:199], v[248:249] op_sel:[0,0] op_sel_hi:[1,0]
v_cvt_pk_bf16_f32 v240, v240, v241
v_cvt_pk_bf16_f32 v241, v242, v243
v_cvt_pk_bf16_f32 v242, v244, v245
v_cvt_pk_bf16_f32 v243, v246, v247
s_nop 0
v_permlane32_swap_b32 v240, v242
v_permlane32_swap_b32 v241, v243
buffer_store_dwordx4 v[240:243], v239, s[36:39], s69 offen sc1
s_add_u32 s69, s69, 65536
s_nop 0
v_pk_mul_f32 v[240:241], v[200:201], v[248:249] op_sel:[0,0] op_sel_hi:[1,0]
v_pk_mul_f32 v[242:243], v[202:203], v[248:249] op_sel:[0,0] op_sel_hi:[1,0]
v_pk_mul_f32 v[244:245], v[204:205], v[248:249] op_sel:[0,0] op_sel_hi:[1,0]
v_pk_mul_f32 v[246:247], v[206:207], v[248:249] op_sel:[0,0] op_sel_hi:[1,0]
v_cvt_pk_bf16_f32 v240, v240, v241
v_cvt_pk_bf16_f32 v241, v242, v243
v_cvt_pk_bf16_f32 v242, v244, v245
v_cvt_pk_bf16_f32 v243, v246, v247
s_nop 0
v_permlane32_swap_b32 v240, v242
v_permlane32_swap_b32 v241, v243
buffer_store_dwordx4 v[240:243], v239, s[36:39], s69 offen sc1
s_add_u32 s71, s61, 3
s_cmp_lt_u32 s71, 20
s_cselect_b32 s68, 0x3ea52b5c, 1.0
v_mul_f32 v248, s68, v235
s_lshl_b32 s69, s71, 17
s_lshl_b32 s68, s54, 4
s_add_u32 s69, s69, s68
v_pk_mul_f32 v[240:241], v[208:209], v[248:249] op_sel:[0,0] op_sel_hi:[1,0]
v_pk_mul_f32 v[242:243], v[210:211], v[248:249] op_sel:[0,0] op_sel_hi:[1,0]
v_pk_mul_f32 v[244:245], v[212:213], v[248:249] op_sel:[0,0] op_sel_hi:[1,0]
v_pk_mul_f32 v[246:247], v[214:215], v[248:249] op_sel:[0,0] op_sel_hi:[1,0]
v_cvt_pk_bf16_f32 v240, v240, v241
v_cvt_pk_bf16_f32 v241, v242, v243
v_cvt_pk_bf16_f32 v242, v244, v245
v_cvt_pk_bf16_f32 v243, v246, v247
s_nop 0
v_permlane32_swap_b32 v240, v242
v_permlane32_swap_b32 v241, v243
buffer_store_dwordx4 v[240:243], v239, s[36:39], s69 offen sc1
s_add_u32 s69, s69, 65536
s_nop 0
v_pk_mul_f32 v[240:241], v[216:217], v[248:249] op_sel:[0,0] op_sel_hi:[1,0]
v_pk_mul_f32 v[242:243], v[218:219], v[248:249] op_sel:[0,0] op_sel_hi:[1,0]
v_pk_mul_f32 v[244:245], v[220:221], v[248:249] op_sel:[0,0] op_sel_hi:[1,0]
v_pk_mul_f32 v[246:247], v[222:223], v[248:249] op_sel:[0,0] op_sel_hi:[1,0]
v_cvt_pk_bf16_f32 v240, v240, v241
v_cvt_pk_bf16_f32 v241, v242, v243
v_cvt_pk_bf16_f32 v242, v244, v245
v_cvt_pk_bf16_f32 v243, v246, v247
s_nop 0
v_permlane32_swap_b32 v240, v242
v_permlane32_swap_b32 v241, v243
buffer_store_dwordx4 v[240:243], v239, s[36:39], s69 offen sc1
s_nop 1
v_lshrrev_b32 v240, 5, v224
v_lshlrev_b32 v240, 12, v240
v_bfe_u32 v241, v224, 2, 2
v_lshl_add_u32 v240, v241, 7, v240
v_and_b32 v241, 3, v224
v_lshl_add_u32 v240, v241, 3, v240
v_bfe_u32 v241, v224, 4, 1
v_bfe_u32 v242, v224, 3, 1
v_lshlrev_b32 v242, 1, v242
v_add_u32 v244, v241, v242
s_sub_u32 s73, s53, 13
s_lshl_b32 s74, s73, 12
s_add_u32 s67, s67, s74
s_lshl_b32 s73, s73, 1
s_add_u32 s74, s73, 0
v_xor_b32 v243, s74, v244
v_lshl_add_u32 v243, v243, 5, v240
v_lshl_add_u32 v227, v241, 13, v243
s_add_u32 s74, s73, 1
v_xor_b32 v243, s74, v244
v_lshl_add_u32 v243, v243, 5, v240
v_lshl_add_u32 v228, v241, 13, v243
ds_read_b64_tr_b16 a[112:113], v227 offset:0
ds_read_b64_tr_b16 a[114:115], v227 offset:512
ds_read_b64_tr_b16 a[116:117], v228 offset:0
ds_read_b64_tr_b16 a[118:119], v228 offset:512
s_waitcnt lgkmcnt(0)
v_mfma_f32_32x32x16_bf16 a[48:63], a[112:115], v[0:3], 0
ds_read_b64_tr_b16 a[140:141], v227 offset:1024
ds_read_b64_tr_b16 a[142:143], v227 offset:1536
v_mfma_f32_32x32x16_bf16 a[64:79], a[116:119], v[0:3], 0
ds_read_b64_tr_b16 a[144:145], v228 offset:1024
ds_read_b64_tr_b16 a[146:147], v228 offset:1536
s_waitcnt lgkmcnt(0)
v_mfma_f32_32x32x16_bf16 a[48:63], a[140:143], v[4:7], a[48:63]
ds_read_b64_tr_b16 a[112:113], v227 offset:2048
ds_read_b64_tr_b16 a[114:115], v227 offset:2560
v_mfma_f32_32x32x16_bf16 a[64:79], a[144:147], v[4:7], a[64:79]
ds_read_b64_tr_b16 a[116:117], v228 offset:2048
ds_read_b64_tr_b16 a[118:119], v228 offset:2560
s_waitcnt lgkmcnt(0)
v_mfma_f32_32x32x16_bf16 a[48:63], a[112:115], v[8:11], a[48:63]
ds_read_b64_tr_b16 a[140:141], v227 offset:3072
ds_read_b64_tr_b16 a[142:143], v227 offset:3584
v_mfma_f32_32x32x16_bf16 a[64:79], a[116:119], v[8:11], a[64:79]
ds_read_b64_tr_b16 a[144:145], v228 offset:3072
ds_read_b64_tr_b16 a[146:147], v228 offset:3584
s_waitcnt lgkmcnt(0)
v_mfma_f32_32x32x16_bf16 a[48:63], a[140:143], v[12:15], a[48:63]
v_mfma_f32_32x32x16_bf16 a[64:79], a[144:147], v[12:15], a[64:79]
s_waitcnt vmcnt(21)
s_barrier
ds_read_b64_tr_b16 a[112:113], v227 offset:16384
ds_read_b64_tr_b16 a[114:115], v227 offset:16896
ds_read_b64_tr_b16 a[116:117], v228 offset:16384
ds_read_b64_tr_b16 a[118:119], v228 offset:16896
s_add_u32 s74, s16, 14336
s_add_u32 m0, s17, 14336
s_nop 0
buffer_load_dwordx4 v249, s[36:39], s74 offen sc1 lds
s_add_u32 m0, s60, 49152
s_nop 0
buffer_load_dwordx4 v250, s[96:99], s57 offen lds
s_add_u32 s57, s57, s18
s_waitcnt lgkmcnt(0)
v_mfma_f32_32x32x16_bf16 a[48:63], a[112:115], v[16:19], a[48:63]
ds_read_b64_tr_b16 a[140:141], v227 offset:17408
ds_read_b64_tr_b16 a[142:143], v227 offset:17920
v_mfma_f32_32x32x16_bf16 a[64:79], a[116:119], v[16:19], a[64:79]
ds_read_b64_tr_b16 a[144:145], v228 offset:17408
ds_read_b64_tr_b16 a[146:147], v228 offset:17920
buffer_load_dwordx4 v250, s[96:99], s57 offen offset:1024 lds
s_add_u32 s57, s57, s18
s_waitcnt lgkmcnt(0)
v_mfma_f32_32x32x16_bf16 a[48:63], a[140:143], v[20:23], a[48:63]
ds_read_b64_tr_b16 a[112:113], v227 offset:18432
ds_read_b64_tr_b16 a[114:115], v227 offset:18944
v_mfma_f32_32x32x16_bf16 a[64:79], a[144:147], v[20:23], a[64:79]
ds_read_b64_tr_b16 a[116:117], v228 offset:18432
ds_read_b64_tr_b16 a[118:119], v228 offset:18944
buffer_load_dwordx4 v250, s[96:99], s57 offen offset:2048 lds
s_add_u32 s57, s57, s18
s_waitcnt lgkmcnt(0)
v_mfma_f32_32x32x16_bf16 a[48:63], a[112:115], v[24:27], a[48:63]
ds_read_b64_tr_b16 a[140:141], v227 offset:19456
ds_read_b64_tr_b16 a[142:143], v227 offset:19968
v_mfma_f32_32x32x16_bf16 a[64:79], a[116:119], v[24:27], a[64:79]
ds_read_b64_tr_b16 a[144:145], v228 offset:19456
ds_read_b64_tr_b16 a[146:147], v228 offset:19968
buffer_load_dwordx4 v250, s[96:99], s57 offen offset:3072 lds
s_add_u32 s57, s57, s19
s_cmp_eq_u32 s23, 4
s_cselect_b32 s21, s66, 0
s_sub_u32 s57, s57, s21
s_waitcnt lgkmcnt(0)
v_mfma_f32_32x32x16_bf16 a[48:63], a[140:143], v[28:31], a[48:63]
v_mfma_f32_32x32x16_bf16 a[64:79], a[144:147], v[28:31], a[64:79]
s_waitcnt vmcnt(20)
s_barrier
ds_read_b64_tr_b16 a[112:113], v227 offset:32768
ds_read_b64_tr_b16 a[114:115], v227 offset:33280
ds_read_b64_tr_b16 a[116:117], v228 offset:32768
ds_read_b64_tr_b16 a[118:119], v228 offset:33280
s_add_u32 s74, s16, 15360
s_add_u32 m0, s17, 15360
s_nop 0
buffer_load_dwordx4 v249, s[36:39], s74 offen sc1 lds
s_add_u32 m0, s60, 0
s_nop 0
buffer_load_dwordx4 v250, s[96:99], s57 offen lds
s_add_u32 s57, s57, s18
s_waitcnt lgkmcnt(0)
v_mfma_f32_32x32x16_bf16 a[48:63], a[112:115], v[32:35], a[48:63]
ds_read_b64_tr_b16 a[140:141], v227 offset:33792
ds_read_b64_tr_b16 a[142:143], v227 offset:34304
v_mfma_f32_32x32x16_bf16 a[64:79], a[116:119], v[32:35], a[64:79]
ds_read_b64_tr_b16 a[144:145], v228 offset:33792
ds_read_b64_tr_b16 a[146:147], v228 offset:34304
buffer_load_dwordx4 v250, s[96:99], s57 offen offset:1024 lds
s_add_u32 s57, s57, s18
s_waitcnt lgkmcnt(0)
v_mfma_f32_32x32x16_bf16 a[48:63], a[140:143], v[36:39], a[48:63]
ds_read_b64_tr_b16 a[112:113], v227 offset:34816
ds_read_b64_tr_b16 a[114:115], v227 offset:35328
v_mfma_f32_32x32x16_bf16 a[64:79], a[144:147], v[36:39], a[64:79]
ds_read_b64_tr_b16 a[116:117], v228 offset:34816
ds_read_b64_tr_b16 a[118:119], v228 offset:35328
buffer_load_dwordx4 v250, s[96:99], s57 offen offset:2048 lds
s_add_u32 s57, s57, s18
s_waitcnt lgkmcnt(0)
v_mfma_f32_32x32x16_bf16 a[48:63], a[112:115], v[40:43], a[48:63]
ds_read_b64_tr_b16 a[140:141], v227 offset:35840
ds_read_b64_tr_b16 a[142:143], v227 offset:36352
v_mfma_f32_32x32x16_bf16 a[64:79], a[116:119], v[40:43], a[64:79]
ds_read_b64_tr_b16 a[144:145], v228 offset:35840
ds_read_b64_tr_b16 a[146:147], v228 offset:36352
buffer_load_dwordx4 v250, s[96:99], s57 offen offset:3072 lds
s_add_u32 s57, s57, s19
s_cmp_eq_u32 s23, 5
s_cselect_b32 s21, s66, 0
s_sub_u32 s57, s57, s21
s_add_u32 s79, s78, 0
buffer_load_dwordx4 a[168:171], v226, s[36:39], s79 offen sc1
s_waitcnt lgkmcnt(0)
v_mfma_f32_32x32x16_bf16 a[48:63], a[140:143], v[44:47], a[48:63]
v_mfma_f32_32x32x16_bf16 a[64:79], a[144:147], v[44:47], a[64:79]
s_waitcnt vmcnt(6)
s_barrier
s_lshl_b32 s72, s52, 7
s_lshl_b32 s73, s53, 2
s_add_u32 s72, s72, s73
s_add_u32 s72, s72, 20594816
s_cmp_eq_u32 s3, 0
s_cselect_b32 s72, s72, 2146435072
v_lshlrev_b32 v254, 25, v224
v_mov_b32 v255, s4
buffer_store_dword v255, v254, s[36:39], s72 offen sc1
ds_read_b64_tr_b16 a[112:113], v227 offset:49152
ds_read_b64_tr_b16 a[114:115], v227 offset:49664
ds_read_b64_tr_b16 a[116:117], v228 offset:49152
ds_read_b64_tr_b16 a[118:119], v228 offset:49664
s_add_u32 s74, s16, 16384
s_add_u32 m0, s17, 16384
s_nop 0
buffer_load_dwordx4 v249, s[36:39], s74 offen sc1 lds
s_add_u32 m0, s60, 16384
s_nop 0
buffer_load_dwordx4 v250, s[96:99], s57 offen lds
s_add_u32 s57, s57, s18
buffer_load_dwordx4 a[172:175], v226, s[36:39], s79 offen offset:1024 sc1
s_waitcnt lgkmcnt(0)
v_mfma_f32_32x32x16_bf16 a[48:63], a[112:115], v[48:51], a[48:63]
ds_read_b64_tr_b16 a[140:141], v227 offset:50176
ds_read_b64_tr_b16 a[142:143], v227 offset:50688
v_mfma_f32_32x32x16_bf16 a[64:79], a[116:119], v[48:51], a[64:79]
ds_read_b64_tr_b16 a[144:145], v228 offset:50176
ds_read_b64_tr_b16 a[146:147], v228 offset:50688
buffer_load_dwordx4 v250, s[96:99], s57 offen offset:1024 lds
s_add_u32 s57, s57, s18
buffer_load_dwordx4 a[176:179], v226, s[36:39], s79 offen offset:2048 sc1
s_waitcnt lgkmcnt(0)
v_mfma_f32_32x32x16_bf16 a[48:63], a[140:143], v[52:55], a[48:63]
ds_read_b64_tr_b16 a[112:113], v227 offset:51200
ds_read_b64_tr_b16 a[114:115], v227 offset:51712
v_mfma_f32_32x32x16_bf16 a[64:79], a[144:147], v[52:55], a[64:79]
ds_read_b64_tr_b16 a[116:117], v228 offset:51200
ds_read_b64_tr_b16 a[118:119], v228 offset:51712
buffer_load_dwordx4 v250, s[96:99], s57 offen offset:2048 lds
s_add_u32 s57, s57, s18
buffer_load_dwordx4 a[180:183], v226, s[36:39], s79 offen offset:3072 sc1
s_waitcnt lgkmcnt(0)
v_mfma_f32_32x32x16_bf16 a[48:63], a[112:115], v[56:59], a[48:63]
ds_read_b64_tr_b16 a[140:141], v227 offset:52224
ds_read_b64_tr_b16 a[142:143], v227 offset:52736
v_mfma_f32_32x32x16_bf16 a[64:79], a[116:119], v[56:59], a[64:79]
ds_read_b64_tr_b16 a[144:145], v228 offset:52224
ds_read_b64_tr_b16 a[146:147], v228 offset:52736
buffer_load_dwordx4 v250, s[96:99], s57 offen offset:3072 lds
s_add_u32 s57, s57, s19
s_cmp_eq_u32 s23, 6
s_cselect_b32 s21, s66, 0
s_sub_u32 s57, s57, s21
buffer_load_dwordx4 a[184:187], v231, s[36:39], s79 offen sc1
s_waitcnt lgkmcnt(0)
v_mfma_f32_32x32x16_bf16 a[48:63], a[140:143], v[60:63], a[48:63]
v_mfma_f32_32x32x16_bf16 a[64:79], a[144:147], v[60:63], a[64:79]
s_waitcnt vmcnt(11)
s_barrier
ds_read_b64_tr_b16 a[112:113], v227 offset:0
ds_read_b64_tr_b16 a[114:115], v227 offset:512
ds_read_b64_tr_b16 a[116:117], v228 offset:0
ds_read_b64_tr_b16 a[118:119], v228 offset:512
s_add_u32 s74, s16, 17408
s_add_u32 m0, s17, 17408
s_nop 0
buffer_load_dwordx4 v249, s[36:39], s74 offen sc1 lds
s_add_u32 m0, s60, 32768
s_nop 0
buffer_load_dwordx4 v250, s[96:99], s57 offen lds
s_add_u32 s57, s57, s18
s_add_u32 s79, s78, 5120
buffer_load_dwordx4 a[188:191], v226, s[36:39], s79 offen sc1
s_waitcnt lgkmcnt(0)
v_mfma_f32_32x32x16_bf16 a[48:63], a[112:115], v[64:67], a[48:63]
ds_read_b64_tr_b16 a[140:141], v227 offset:1024
ds_read_b64_tr_b16 a[142:143], v227 offset:1536
v_mfma_f32_32x32x16_bf16 a[64:79], a[116:119], v[64:67], a[64:79]
ds_read_b64_tr_b16 a[144:145], v228 offset:1024
ds_read_b64_tr_b16 a[146:147], v228 offset:1536
buffer_load_dwordx4 v250, s[96:99], s57 offen offset:1024 lds
s_add_u32 s57, s57, s18
buffer_load_dwordx4 a[192:195], v226, s[36:39], s79 offen offset:1024 sc1
s_waitcnt lgkmcnt(0)
v_mfma_f32_32x32x16_bf16 a[48:63], a[140:143], v[68:71], a[48:63]
ds_read_b64_tr_b16 a[112:113], v227 offset:2048
ds_read_b64_tr_b16 a[114:115], v227 offset:2560
v_mfma_f32_32x32x16_bf16 a[64:79], a[144:147], v[68:71], a[64:79]
ds_read_b64_tr_b16 a[116:117], v228 offset:2048
ds_read_b64_tr_b16 a[118:119], v228 offset:2560
buffer_load_dwordx4 v250, s[96:99], s57 offen offset:2048 lds
s_add_u32 s57, s57, s18
buffer_load_dwordx4 a[196:199], v226, s[36:39], s79 offen offset:2048 sc1
s_waitcnt lgkmcnt(0)
v_mfma_f32_32x32x16_bf16 a[48:63], a[112:115], v[72:75], a[48:63]
ds_read_b64_tr_b16 a[140:141], v227 offset:3072
ds_read_b64_tr_b16 a[142:143], v227 offset:3584
v_mfma_f32_32x32x16_bf16 a[64:79], a[116:119], v[72:75], a[64:79]
ds_read_b64_tr_b16 a[144:145], v228 offset:3072
ds_read_b64_tr_b16 a[146:147], v228 offset:3584
buffer_load_dwordx4 v250, s[96:99], s57 offen offset:3072 lds
s_add_u32 s57, s57, s19
s_cmp_eq_u32 s23, 7
s_cselect_b32 s21, s66, 0
s_sub_u32 s57, s57, s21
buffer_load_dwordx4 a[200:203], v226, s[36:39], s79 offen offset:3072 sc1
s_waitcnt lgkmcnt(0)
v_mfma_f32_32x32x16_bf16 a[48:63], a[140:143], v[76:79], a[48:63]
v_mfma_f32_32x32x16_bf16 a[64:79], a[144:147], v[76:79], a[64:79]
s_waitcnt vmcnt(10)
s_barrier
ds_read_b64_tr_b16 a[112:113], v227 offset:16384
ds_read_b64_tr_b16 a[114:115], v227 offset:16896
ds_read_b64_tr_b16 a[116:117], v228 offset:16384
ds_read_b64_tr_b16 a[118:119], v228 offset:16896
s_add_u32 s74, s16, 18432
s_add_u32 m0, s17, 18432
s_nop 0
buffer_load_dwordx4 v249, s[36:39], s74 offen sc1 lds
s_add_u32 m0, s60, 49152
s_nop 0
buffer_load_dwordx4 v250, s[96:99], s57 offen lds
s_add_u32 s57, s57, s18
buffer_load_dwordx4 a[204:207], v231, s[36:39], s79 offen sc1
s_waitcnt lgkmcnt(0)
v_mfma_f32_32x32x16_bf16 a[48:63], a[112:115], v[80:83], a[48:63]
ds_read_b64_tr_b16 a[140:141], v227 offset:17408
ds_read_b64_tr_b16 a[142:143], v227 offset:17920
v_mfma_f32_32x32x16_bf16 a[64:79], a[116:119], v[80:83], a[64:79]
ds_read_b64_tr_b16 a[144:145], v228 offset:17408
ds_read_b64_tr_b16 a[146:147], v228 offset:17920
buffer_load_dwordx4 v250, s[96:99], s57 offen offset:1024 lds
s_add_u32 s57, s57, s18
s_add_u32 s79, s78, 10240
buffer_load_dwordx4 a[208:211], v226, s[36:39], s79 offen sc1
s_waitcnt lgkmcnt(0)
v_mfma_f32_32x32x16_bf16 a[48:63], a[140:143], v[84:87], a[48:63]
ds_read_b64_tr_b16 a[112:113], v227 offset:18432
ds_read_b64_tr_b16 a[114:115], v227 offset:18944
v_mfma_f32_32x32x16_bf16 a[64:79], a[144:147], v[84:87], a[64:79]
ds_read_b64_tr_b16 a[116:117], v228 offset:18432
ds_read_b64_tr_b16 a[118:119], v228 offset:18944
buffer_load_dwordx4 v250, s[96:99], s57 offen offset:2048 lds
s_add_u32 s57, s57, s18
buffer_load_dwordx4 a[212:215], v226, s[36:39], s79 offen offset:1024 sc1
s_waitcnt lgkmcnt(0)
v_mfma_f32_32x32x16_bf16 a[48:63], a[112:115], v[88:91], a[48:63]
ds_read_b64_tr_b16 a[140:141], v227 offset:19456
ds_read_b64_tr_b16 a[142:143], v227 offset:19968
v_mfma_f32_32x32x16_bf16 a[64:79], a[116:119], v[88:91], a[64:79]
ds_read_b64_tr_b16 a[144:145], v228 offset:19456
ds_read_b64_tr_b16 a[146:147], v228 offset:19968
buffer_load_dwordx4 v250, s[96:99], s57 offen offset:3072 lds
s_add_u32 s57, s57, s19
s_cmp_eq_u32 s23, 8
s_cselect_b32 s21, s66, 0
s_sub_u32 s57, s57, s21
buffer_load_dwordx4 a[216:219], v226, s[36:39], s79 offen offset:2048 sc1
s_waitcnt lgkmcnt(0)
v_mfma_f32_32x32x16_bf16 a[48:63], a[140:143], v[92:95], a[48:63]
v_mfma_f32_32x32x16_bf16 a[64:79], a[144:147], v[92:95], a[64:79]
s_waitcnt vmcnt(10)
s_barrier
s_getpc_b64 s[72:73]
L_pc_9:
s_lshr_b32 s70, s2, 3
s_lshl_b32 s70, s70, 2
s_add_u32 s70, s70, s3
s_lshl_b32 s70, s70, 7
s_add_u32 s70, s70, 2048
v_and_b32 v253, 1, v224
v_lshlrev_b32 v253, 14, v253
v_add_u32 v253, s70, v253
v_min_u32 v253, L_end_of_code-L_pc_9-4, v253
global_load_dword a255, v253, s[72:73]
ds_read_b64_tr_b16 a[112:113], v227 offset:32768
ds_read_b64_tr_b16 a[114:115], v227 offset:33280
ds_read_b64_tr_b16 a[116:117], v228 offset:32768
ds_read_b64_tr_b16 a[118:119], v228 offset:33280
s_add_u32 s74, s16, 19456
s_add_u32 m0, s17, 19456
s_nop 0
buffer_load_dwordx4 v249, s[36:39], s74 offen sc1 lds
s_add_u32 m0, s60, 0
s_nop 0
buffer_load_dwordx4 v250, s[96:99], s57 offen lds
s_add_u32 s57, s57, s18
buffer_load_dwordx4 a[220:223], v226, s[36:39], s79 offen offset:3072 sc1
s_waitcnt lgkmcnt(0)
v_mfma_f32_32x32x16_bf16 a[48:63], a[112:115], v[96:99], a[48:63]
ds_read_b64_tr_b16 a[140:141], v227 offset:33792
ds_read_b64_tr_b16 a[142:143], v227 offset:34304
v_mfma_f32_32x32x16_bf16 a[64:79], a[116:119], v[96:99], a[64:79]
ds_read_b64_tr_b16 a[144:145], v228 offset:33792
ds_read_b64_tr_b16 a[146:147], v228 offset:34304
buffer_load_dwordx4 v250, s[96:99], s57 offen offset:1024 lds
s_add_u32 s57, s57, s18
buffer_load_dwordx4 a[224:227], v231, s[36:39], s79 offen sc1
s_waitcnt lgkmcnt(0)
v_mfma_f32_32x32x16_bf16 a[48:63], a[140:143], v[100:103], a[48:63]
ds_read_b64_tr_b16 a[112:113], v227 offset:34816
ds_read_b64_tr_b16 a[114:115], v227 offset:35328
v_mfma_f32_32x32x16_bf16 a[64:79], a[144:147], v[100:103], a[64:79]
ds_read_b64_tr_b16 a[116:117], v228 offset:34816
ds_read_b64_tr_b16 a[118:119], v228 offset:35328
buffer_load_dwordx4 v250, s[96:99], s57 offen offset:2048 lds
s_add_u32 s57, s57, s18
s_add_u32 s79, s78, 15360
buffer_load_dwordx4 a[228:231], v226, s[36:39], s79 offen sc1
s_waitcnt lgkmcnt(0)
v_mfma_f32_32x32x16_bf16 a[48:63], a[112:115], v[104:107], a[48:63]
ds_read_b64_tr_b16 a[140:141], v227 offset:35840
ds_read_b64_tr_b16 a[142:143], v227 offset:36352
v_mfma_f32_32x32x16_bf16 a[64:79], a[116:119], v[104:107], a[64:79]
ds_read_b64_tr_b16 a[144:145], v228 offset:35840
ds_read_b64_tr_b16 a[146:147], v228 offset:36352
buffer_load_dwordx4 v250, s[96:99], s57 offen offset:3072 lds
s_add_u32 s57, s57, s19
s_cmp_eq_u32 s23, 9
s_cselect_b32 s21, s66, 0
s_sub_u32 s57, s57, s21
buffer_load_dwordx4 a[232:235], v226, s[36:39], s79 offen offset:1024 sc1
s_waitcnt lgkmcnt(0)
v_mfma_f32_32x32x16_bf16 a[48:63], a[140:143], v[108:111], a[48:63]
v_mfma_f32_32x32x16_bf16 a[64:79], a[144:147], v[108:111], a[64:79]
s_waitcnt vmcnt(11)
s_barrier
ds_read_b64_tr_b16 a[112:113], v227 offset:49152
ds_read_b64_tr_b16 a[114:115], v227 offset:49664
ds_read_b64_tr_b16 a[116:117], v228 offset:49152
ds_read_b64_tr_b16 a[118:119], v228 offset:49664
s_add_u32 s74, s16, 20480
s_add_u32 m0, s17, 20480
s_nop 0
buffer_load_dwordx4 v249, s[36:39], s74 offen sc1 lds
s_add_u32 m0, s60, 16384
s_nop 0
buffer_load_dwordx4 v250, s[96:99], s57 offen lds
s_add_u32 s57, s57, s18
buffer_load_dwordx4 a[236:239], v226, s[36:39], s79 offen offset:2048 sc1
s_waitcnt lgkmcnt(0)
v_mfma_f32_32x32x16_bf16 a[48:63], a[112:115], v[112:115], a[48:63]
ds_read_b64_tr_b16 a[140:141], v227 offset:50176
ds_read_b64_tr_b16 a[142:143], v227 offset:50688
v_mfma_f32_32x32x16_bf16 a[64:79], a[116:119], v[112:115], a[64:79]
ds_read_b64_tr_b16 a[144:145], v228 offset:50176
ds_read_b64_tr_b16 a[146:147], v228 offset:50688
buffer_load_dwordx4 v250, s[96:99], s57 offen offset:1024 lds
s_add_u32 s57, s57, s18
buffer_load_dwordx4 a[240:243], v226, s[36:39], s79 offen offset:3072 sc1
s_waitcnt lgkmcnt(0)
v_mfma_f32_32x32x16_bf16 a[48:63], a[140:143], v[116:119], a[48:63]
ds_read_b64_tr_b16 a[112:113], v227 offset:51200
ds_read_b64_tr_b16 a[114:115], v227 offset:51712
v_mfma_f32_32x32x16_bf16 a[64:79], a[144:147], v[116:119], a[64:79]
ds_read_b64_tr_b16 a[116:117], v228 offset:51200
ds_read_b64_tr_b16 a[118:119], v228 offset:51712
buffer_load_dwordx4 v250, s[96:99], s57 offen offset:2048 lds
s_add_u32 s57, s57, s18
buffer_load_dwordx4 a[244:247], v231, s[36:39], s79 offen sc1
s_waitcnt lgkmcnt(0)
v_mfma_f32_32x32x16_bf16 a[48:63], a[112:115], v[120:123], a[48:63]
ds_read_b64_tr_b16 a[140:141], v227 offset:52224
ds_read_b64_tr_b16 a[142:143], v227 offset:52736
v_mfma_f32_32x32x16_bf16 a[64:79], a[116:119], v[120:123], a[64:79]
ds_read_b64_tr_b16 a[144:145], v228 offset:52224
ds_read_b64_tr_b16 a[146:147], v228 offset:52736
buffer_load_dwordx4 v250, s[96:99], s57 offen offset:3072 lds
s_add_u32 s57, s57, s19
s_waitcnt lgkmcnt(0)
v_mfma_f32_32x32x16_bf16 a[48:63], a[140:143], v[124:127], a[48:63]
v_mfma_f32_32x32x16_bf16 a[64:79], a[144:147], v[124:127], a[64:79]
s_waitcnt vmcnt(9)
s_barrier
ds_read_b64_tr_b16 a[112:113], v227 offset:0
ds_read_b64_tr_b16 a[114:115], v227 offset:512
ds_read_b64_tr_b16 a[116:117], v228 offset:0
ds_read_b64_tr_b16 a[118:119], v228 offset:512
s_waitcnt lgkmcnt(0)
v_mfma_f32_32x32x16_bf16 a[48:63], a[112:115], v[128:131], a[48:63]
ds_read_b64_tr_b16 a[140:141], v227 offset:1024
ds_read_b64_tr_b16 a[142:143], v227 offset:1536
v_mfma_f32_32x32x16_bf16 a[64:79], a[116:119], v[128:131], a[64:79]
ds_read_b64_tr_b16 a[144:145], v228 offset:1024
ds_read_b64_tr_b16 a[146:147], v228 offset:1536
s_waitcnt lgkmcnt(0)
v_mfma_f32_32x32x16_bf16 a[48:63], a[140:143], v[132:135], a[48:63]
ds_read_b64_tr_b16 a[112:113], v227 offset:2048
ds_read_b64_tr_b16 a[114:115], v227 offset:2560
v_mfma_f32_32x32x16_bf16 a[64:79], a[144:147], v[132:135], a[64:79]
ds_read_b64_tr_b16 a[116:117], v228 offset:2048
ds_read_b64_tr_b16 a[118:119], v228 offset:2560
s_waitcnt lgkmcnt(0)
v_mfma_f32_32x32x16_bf16 a[48:63], a[112:115], v[136:139], a[48:63]
ds_read_b64_tr_b16 a[140:141], v227 offset:3072
ds_read_b64_tr_b16 a[142:143], v227 offset:3584
v_mfma_f32_32x32x16_bf16 a[64:79], a[116:119], v[136:139], a[64:79]
ds_read_b64_tr_b16 a[144:145], v228 offset:3072
ds_read_b64_tr_b16 a[146:147], v228 offset:3584
s_waitcnt lgkmcnt(0)
v_mfma_f32_32x32x16_bf16 a[48:63], a[140:143], v[140:143], a[48:63]
v_mfma_f32_32x32x16_bf16 a[64:79], a[144:147], v[140:143], a[64:79]
s_waitcnt vmcnt(0)
s_barrier
ds_read_b64_tr_b16 a[112:113], v227 offset:16384
ds_read_b64_tr_b16 a[114:115], v227 offset:16896
ds_read_b64_tr_b16 a[116:117], v228 offset:16384
ds_read_b64_tr_b16 a[118:119], v228 offset:16896
s_waitcnt lgkmcnt(0)
v_mfma_f32_32x32x16_bf16 a[48:63], a[112:115], v[144:147], a[48:63]
ds_read_b64_tr_b16 a[140:141], v227 offset:17408
ds_read_b64_tr_b16 a[142:143], v227 offset:17920
v_mfma_f32_32x32x16_bf16 a[64:79], a[116:119], v[144:147], a[64:79]
ds_read_b64_tr_b16 a[144:145], v228 offset:17408
ds_read_b64_tr_b16 a[146:147], v228 offset:17920
s_waitcnt lgkmcnt(0)
v_mfma_f32_32x32x16_bf16 a[48:63], a[140:143], v[148:151], a[48:63]
ds_read_b64_tr_b16 a[112:113], v227 offset:18432
ds_read_b64_tr_b16 a[114:115], v227 offset:18944
v_mfma_f32_32x32x16_bf16 a[64:79], a[144:147], v[148:151], a[64:79]
ds_read_b64_tr_b16 a[116:117], v228 offset:18432
ds_read_b64_tr_b16 a[118:119], v228 offset:18944
s_waitcnt lgkmcnt(0)
v_mfma_f32_32x32x16_bf16 a[48:63], a[112:115], v[152:155], a[48:63]
ds_read_b64_tr_b16 a[140:141], v227 offset:19456
ds_read_b64_tr_b16 a[142:143], v227 offset:19968
s_lshl_b32 s72, s5, 2
s_sub_u32 s72, 60, s72
s_lshr_b64 s[76:77], -1, s72
v_mfma_f32_32x32x16_bf16 a[64:79], a[116:119], v[152:155], a[64:79]
ds_read_b64_tr_b16 a[144:145], v228 offset:19456
ds_read_b64_tr_b16 a[146:147], v228 offset:19968
s_sub_u32 s72, s5, 2
s_cselect_b32 s72, 0, s72
s_lshl_b32 s72, s72, 2
s_waitcnt lgkmcnt(0)
v_mfma_f32_32x32x16_bf16 a[48:63], a[140:143], v[156:159], a[48:63]
s_lshr_b64 s[76:77], s[76:77], s72
s_lshl_b64 s[76:77], s[76:77], s72
v_lshrrev_b32 v168, 2, v224
v_lshlrev_b32 v168, 7, v168
v_and_b32 v164, 3, v224
v_mfma_f32_32x32x16_bf16 a[64:79], a[144:147], v[156:159], a[64:79]
v_lshl_add_u32 v168, v164, 4, v168
v_mov_b32 v164, 2146435072
v_cndmask_b32 v168, v164, v168, s[76:77]
s_mov_b32 s72, 20594816
buffer_load_dwordx4 v[164:167], v168, s[36:39], s72 offen sc1
s_nop 7
s_nop 3
v_accvgpr_read_b32 v242, a48
v_accvgpr_read_b32 v243, a49
v_accvgpr_read_b32 v244, a56
v_accvgpr_read_b32 v245, a57
v_pk_mul_f32 v[240:241], v[242:243], v[242:243]
v_pk_fma_f32 v[240:241], v[240:241], v[236:237], v[236:237] op_sel:[0,1,0] op_sel_hi:[1,1,0]
v_pk_mul_f32 v[240:241], v[242:243], v[240:241]
v_exp_f32 v240, v240
v_exp_f32 v241, v241
v_pk_mul_f32 v[244:245], v[242:243], v[244:245]
v_pk_fma_f32 v[240:241], v[240:241], v[238:239], v[238:239] op_sel:[0,0,0] op_sel_hi:[1,0,0]
v_rcp_f32 v240, v240
v_rcp_f32 v241, v241
s_nop 0
v_pk_mul_f32 v[242:243], v[244:245], v[240:241]
v_cvt_pk_bf16_f32 v16, v242, v243
v_accvgpr_read_b32 v242, a50
v_accvgpr_read_b32 v243, a51
v_accvgpr_read_b32 v244, a58
v_accvgpr_read_b32 v245, a59
v_pk_mul_f32 v[240:241], v[242:243], v[242:243]
v_pk_fma_f32 v[240:241], v[240:241], v[236:237], v[236:237] op_sel:[0,1,0] op_sel_hi:[1,1,0]
v_pk_mul_f32 v[240:241], v[242:243], v[240:241]
v_exp_f32 v240, v240
v_exp_f32 v241, v241
v_pk_mul_f32 v[244:245], v[242:243], v[244:245]
v_pk_fma_f32 v[240:241], v[240:241], v[238:239], v[238:239] op_sel:[0,0,0] op_sel_hi:[1,0,0]
v_rcp_f32 v240, v240
v_rcp_f32 v241, v241
s_nop 0
v_pk_mul_f32 v[242:243], v[244:245], v[240:241]
v_cvt_pk_bf16_f32 v17, v242, v243
v_accvgpr_read_b32 v242, a52
v_accvgpr_read_b32 v243, a53
v_accvgpr_read_b32 v244, a60
v_accvgpr_read_b32 v245, a61
v_pk_mul_f32 v[240:241], v[242:243], v[242:243]
v_pk_fma_f32 v[240:241], v[240:241], v[236:237], v[236:237] op_sel:[0,1,0] op_sel_hi:[1,1,0]
v_pk_mul_f32 v[240:241], v[242:243], v[240:241]
v_exp_f32 v240, v240
v_exp_f32 v241, v241
v_pk_mul_f32 v[244:245], v[242:243], v[244:245]
v_pk_fma_f32 v[240:241], v[240:241], v[238:239], v[238:239] op_sel:[0,0,0] op_sel_hi:[1,0,0]
v_rcp_f32 v240, v240
v_rcp_f32 v241, v241
s_nop 0
v_pk_mul_f32 v[242:243], v[244:245], v[240:241]
v_cvt_pk_bf16_f32 v18, v242, v243
v_accvgpr_read_b32 v242, a54
v_accvgpr_read_b32 v243, a55
v_accvgpr_read_b32 v244, a62
v_accvgpr_read_b32 v245, a63
v_pk_mul_f32 v[240:241], v[242:243], v[242:243]
v_pk_fma_f32 v[240:241], v[240:241], v[236:237], v[236:237] op_sel:[0,1,0] op_sel_hi:[1,1,0]
v_pk_mul_f32 v[240:241], v[242:243], v[240:241]
v_exp_f32 v240, v240
v_exp_f32 v241, v241
v_pk_mul_f32 v[244:245], v[242:243], v[244:245]
v_pk_fma_f32 v[240:241], v[240:241], v[238:239], v[238:239] op_sel:[0,0,0] op_sel_hi:[1,0,0]
v_rcp_f32 v240, v240
v_rcp_f32 v241, v241
s_nop 0
v_pk_mul_f32 v[242:243], v[244:245], v[240:241]
v_cvt_pk_bf16_f32 v19, v242, v243
s_waitcnt vmcnt(0)
s_mov_b32 s70, 0
L_pq_10:
v_xor_b32 v164, s4, v164
v_xor_b32 v165, s4, v165
v_xor_b32 v166, s4, v166
v_xor_b32 v167, s4, v167
v_or3_b32 v164, v164, v165, v166
v_or_b32 v164, v164, v167
v_cmp_ne_u32 vcc, 0, v164
s_nop 3
s_and_b64 vcc, vcc, s[76:77]
s_cbranch_scc0 L_pd_11
s_add_u32 s70, s70, 1
s_cmp_ge_u32 s70, 200000
s_cbranch_scc1 L_pd_11
s_sleep 2
s_mov_b32 s72, 20594816
buffer_load_dwordx4 v[164:167], v168, s[36:39], s72 offen sc1
s_waitcnt vmcnt(0)
s_branch L_pq_10
L_pd_11:
s_barrier
s_lshl_b32 s70, s5, 11
s_sub_u32 s70, s70, 4096
s_mul_i32 s71, s6, 5
s_add_u32 s72, s3, 0
s_cmp_lt_u32 s72, 5
s_mov_b32 s73, 155
s_cselect_b32 s73, 80, s73
s_add_u32 s73, s73, s71
s_add_u32 s73, s73, s72
s_lshl_b32 s73, s73, 15
s_add_u32 s73, s73, s70
s_mul_i32 s74, s72, 6208
s_add_u32 s74, s74, 0
s_cmp_lt_u32 s72, 10
s_cselect_b32 s73, s73, 2146435072
s_cselect_b32 m0, s74, 0x30000
s_cmp_lt_u32 s5, 2
s_cselect_b32 s74, 2146435072, s73
buffer_load_dwordx4 v226, s[36:39], s74 offen sc1 lds
v_accvgpr_read_b32 v242, a64
v_accvgpr_read_b32 v243, a65
v_accvgpr_read_b32 v244, a72
buffer_load_dwordx4 v226, s[36:39], s74 offen offset:1024 sc1 lds
v_accvgpr_read_b32 v245, a73
v_pk_mul_f32 v[240:241], v[242:243], v[242:243]
v_pk_fma_f32 v[240:241], v[240:241], v[236:237], v[236:237] op_sel:[0,1,0] op_sel_hi:[1,1,0]
s_cmp_lt_u32 s5, 1
s_cselect_b32 s74, 2146435072, s73
buffer_load_dwordx4 v226, s[36:39], s74 offen offset:2048 sc1 lds
v_pk_mul_f32 v[240:241], v[242:243], v[240:241]
v_exp_f32 v240, v240
v_exp_f32 v241, v241
buffer_load_dwordx4 v226, s[36:39], s74 offen offset:3072 sc1 lds
v_pk_mul_f32 v[244:245], v[242:243], v[244:245]
v_pk_fma_f32 v[240:241], v[240:241], v[238:239], v[238:239] op_sel:[0,0,0] op_sel_hi:[1,0,0]
v_rcp_f32 v240, v240
s_add_u32 s74, s73, 4096
s_add_u32 m0, m0, 4096
s_nop 0
buffer_load_dwordx4 v226, s[36:39], s74 offen sc1 lds
v_rcp_f32 v241, v241
s_nop 0
v_pk_mul_f32 v[242:243], v[244:245], v[240:241]
buffer_load_dwordx4 v226, s[36:39], s74 offen offset:1024 sc1 lds
v_cvt_pk_bf16_f32 v20, v242, v243
v_accvgpr_read_b32 v242, a66
v_accvgpr_read_b32 v243, a67
s_add_u32 s72, s3, 4
s_cmp_lt_u32 s72, 5
s_mov_b32 s73, 155
s_cselect_b32 s73, 80, s73
s_add_u32 s73, s73, s71
s_add_u32 s73, s73, s72
s_lshl_b32 s73, s73, 15
s_add_u32 s73, s73, s70
s_mul_i32 s74, s72, 6208
s_add_u32 s74, s74, 0
s_cmp_lt_u32 s72, 10
s_cselect_b32 s73, s73, 2146435072
s_cselect_b32 m0, s74, 0x30000
s_cmp_lt_u32 s5, 2
s_cselect_b32 s74, 2146435072, s73
buffer_load_dwordx4 v226, s[36:39], s74 offen sc1 lds
v_accvgpr_read_b32 v244, a74
v_accvgpr_read_b32 v245, a75
v_pk_mul_f32 v[240:241], v[242:243], v[242:243]
buffer_load_dwordx4 v226, s[36:39], s74 offen offset:1024 sc1 lds
v_pk_fma_f32 v[240:241], v[240:241], v[236:237], v[236:237] op_sel:[0,1,0] op_sel_hi:[1,1,0]
v_pk_mul_f32 v[240:241], v[242:243], v[240:241]
v_exp_f32 v240, v240
s_cmp_lt_u32 s5, 1
s_cselect_b32 s74, 2146435072, s73
buffer_load_dwordx4 v226, s[36:39], s74 offen offset:2048 sc1 lds
v_exp_f32 v241, v241
v_pk_mul_f32 v[244:245], v[242:243], v[244:245]
v_pk_fma_f32 v[240:241], v[240:241], v[238:239], v[238:239] op_sel:[0,0,0] op_sel_hi:[1,0,0]
buffer_load_dwordx4 v226, s[36:39], s74 offen offset:3072 sc1 lds
v_rcp_f32 v240, v240
v_rcp_f32 v241, v241
s_nop 0
s_add_u32 s74, s73, 4096
s_add_u32 m0, m0, 4096
s_nop 0
buffer_load_dwordx4 v226, s[36:39], s74 offen sc1 lds
v_pk_mul_f32 v[242:243], v[244:245], v[240:241]
v_cvt_pk_bf16_f32 v21, v242, v243
v_accvgpr_read_b32 v242, a68
buffer_load_dwordx4 v226, s[36:39], s74 offen offset:1024 sc1 lds
v_accvgpr_read_b32 v243, a69
v_accvgpr_read_b32 v244, a76
v_accvgpr_read_b32 v245, a77
s_add_u32 s72, s3, 8
s_cmp_lt_u32 s72, 5
s_mov_b32 s73, 155
s_cselect_b32 s73, 80, s73
s_add_u32 s73, s73, s71
s_add_u32 s73, s73, s72
s_lshl_b32 s73, s73, 15
s_add_u32 s73, s73, s70
s_mul_i32 s74, s72, 6208
s_add_u32 s74, s74, 0
s_cmp_lt_u32 s72, 10
s_cselect_b32 s73, s73, 2146435072
s_cselect_b32 m0, s74, 0x30000
s_cmp_lt_u32 s5, 2
s_cselect_b32 s74, 2146435072, s73
buffer_load_dwordx4 v226, s[36:39], s74 offen sc1 lds
v_pk_mul_f32 v[240:241], v[242:243], v[242:243]
v_pk_fma_f32 v[240:241], v[240:241], v[236:237], v[236:237] op_sel:[0,1,0] op_sel_hi:[1,1,0]
v_pk_mul_f32 v[240:241], v[242:243], v[240:241]
buffer_load_dwordx4 v226, s[36:39], s74 offen offset:1024 sc1 lds
v_exp_f32 v240, v240
v_exp_f32 v241, v241
v_pk_mul_f32 v[244:245], v[242:243], v[244:245]
s_cmp_lt_u32 s5, 1
s_cselect_b32 s74, 2146435072, s73
buffer_load_dwordx4 v226, s[36:39], s74 offen offset:2048 sc1 lds
v_pk_fma_f32 v[240:241], v[240:241], v[238:239], v[238:239] op_sel:[0,0,0] op_sel_hi:[1,0,0]
v_rcp_f32 v240, v240
v_rcp_f32 v241, v241
buffer_load_dwordx4 v226, s[36:39], s74 offen offset:3072 sc1 lds
s_nop 0
v_pk_mul_f32 v[242:243], v[244:245], v[240:241]
v_cvt_pk_bf16_f32 v22, v242, v243
s_add_u32 s74, s73, 4096
s_add_u32 m0, m0, 4096
s_nop 0
buffer_load_dwordx4 v226, s[36:39], s74 offen sc1 lds
v_accvgpr_read_b32 v242, a70
v_accvgpr_read_b32 v243, a71
v_accvgpr_read_b32 v244, a78
buffer_load_dwordx4 v226, s[36:39], s74 offen offset:1024 sc1 lds
v_accvgpr_read_b32 v245, a79
v_pk_mul_f32 v[240:241], v[242:243], v[242:243]
v_pk_fma_f32 v[240:241], v[240:241], v[236:237], v[236:237] op_sel:[0,1,0] op_sel_hi:[1,1,0]
v_pk_mul_f32 v[240:241], v[242:243], v[240:241]
v_exp_f32 v240, v240
v_exp_f32 v241, v241
v_pk_mul_f32 v[244:245], v[242:243], v[244:245]
v_pk_fma_f32 v[240:241], v[240:241], v[238:239], v[238:239] op_sel:[0,0,0] op_sel_hi:[1,0,0]
v_rcp_f32 v240, v240
v_rcp_f32 v241, v241
s_nop 0
v_pk_mul_f32 v[242:243], v[244:245], v[240:241]
v_cvt_pk_bf16_f32 v23, v242, v243
s_lshl_b32 s72, s5, 7
s_lshl_b32 s73, s3, 5
s_add_u32 s72, s72, s73
s_lshl_b32 s72, s72, 4
s_lshl_b32 s73, s71, 15
s_add_u32 s72, s72, s73
s_add_u32 s73, s72, 98304
s_add_u32 s74, s72, 65536
v_and_b32 v252, 31, v224
v_lshlrev_b32 v252, 4, v252
v_cmp_gt_u32 vcc, 32, v224
v_mov_b32 v253, 2146435072
s_nop 0
v_cndmask_b32 v252, v253, v252, vcc
buffer_load_dwordx4 v[128:131], v239, s[36:39], s72 offen sc1
buffer_load_dwordx4 v[138:141], v239, s[36:39], s73 offen sc1
buffer_load_dwordx2 v[132:133], v252, s[36:39], s74 offen sc1
buffer_load_dwordx2 v[136:137], v252, s[36:39], s74 offen offset:8 sc1
v_mov_b32 v253, 0x3f80
v_cndmask_b32 v134, v253, 0, vcc
v_mov_b32 v135, 0
s_lshl_b32 s69, s65, 13
s_add_u32 s69, s69, s67
s_add_u32 s69, s69, 0
buffer_store_dwordx4 v[16:19], v233, s[36:39], s69 offen sc1
s_lshl_b32 s69, s65, 13
s_add_u32 s69, s69, s67
s_add_u32 s69, s69, 512
buffer_store_dwordx4 v[20:23], v233, s[36:39], s69 offen sc1
v_mov_b32 v244, 2146435072
buffer_load_dword a250, v244, s[36:39], 0 offen
buffer_load_dword a251, v244, s[36:39], 0 offen
s_branch L_ab_done
L_typeC:
s_nop 7
s_nop 3
s_add_u32 s71, s62, 0
s_cmp_lt_u32 s71, 20
s_cselect_b32 s68, 0x3ea52b5c, 1.0
v_mul_f32 v248, s68, v235
s_lshl_b32 s69, s71, 17
s_lshl_b32 s68, s54, 4
s_add_u32 s69, s69, s68
v_accvgpr_read_b32 v240, a0
v_accvgpr_read_b32 v241, a1
v_accvgpr_read_b32 v242, a2
v_accvgpr_read_b32 v243, a3
v_accvgpr_read_b32 v244, a4
v_accvgpr_read_b32 v245, a5
v_accvgpr_read_b32 v246, a6
v_accvgpr_read_b32 v247, a7
v_pk_mul_f32 v[240:241], v[240:241], v[248:249] op_sel:[0,0] op_sel_hi:[1,0]
v_pk_mul_f32 v[242:243], v[242:243], v[248:249] op_sel:[0,0] op_sel_hi:[1,0]
v_pk_mul_f32 v[244:245], v[244:245], v[248:249] op_sel:[0,0] op_sel_hi:[1,0]
v_pk_mul_f32 v[246:247], v[246:247], v[248:249] op_sel:[0,0] op_sel_hi:[1,0]
v_cvt_pk_bf16_f32 v240, v240, v241
v_cvt_pk_bf16_f32 v241, v242, v243
v_cvt_pk_bf16_f32 v242, v244, v245
v_cvt_pk_bf16_f32 v243, v246, v247
s_nop 0
v_permlane32_swap_b32 v240, v242
v_permlane32_swap_b32 v241, v243
buffer_store_dwordx4 v[240:243], v239, s[36:39], s69 offen sc1
s_add_u32 s69, s69, 65536
s_nop 0
v_accvgpr_read_b32 v240, a8
v_accvgpr_read_b32 v241, a9
v_accvgpr_read_b32 v242, a10
v_accvgpr_read_b32 v243, a11
v_accvgpr_read_b32 v244, a12
v_accvgpr_read_b32 v245, a13
v_accvgpr_read_b32 v246, a14
v_accvgpr_read_b32 v247, a15
v_pk_mul_f32 v[240:241], v[240:241], v[248:249] op_sel:[0,0] op_sel_hi:[1,0]
v_pk_mul_f32 v[242:243], v[242:243], v[248:249] op_sel:[0,0] op_sel_hi:[1,0]
v_pk_mul_f32 v[244:245], v[244:245], v[248:249] op_sel:[0,0] op_sel_hi:[1,0]
v_pk_mul_f32 v[246:247], v[246:247], v[248:249] op_sel:[0,0] op_sel_hi:[1,0]
v_cvt_pk_bf16_f32 v240, v240, v241
v_cvt_pk_bf16_f32 v241, v242, v243
v_cvt_pk_bf16_f32 v242, v244, v245
v_cvt_pk_bf16_f32 v243, v246, v247
s_nop 0
v_permlane32_swap_b32 v240, v242
v_permlane32_swap_b32 v241, v243
buffer_store_dwordx4 v[240:243], v239, s[36:39], s69 offen sc1
s_add_u32 s71, s62, 1
s_cmp_lt_u32 s71, 20
s_cselect_b32 s68, 0x3ea52b5c, 1.0
v_mul_f32 v248, s68, v235
s_lshl_b32 s69, s71, 17
s_lshl_b32 s68, s54, 4
s_add_u32 s69, s69, s68
v_accvgpr_read_b32 v240, a16
v_accvgpr_read_b32 v241, a17
v_accvgpr_read_b32 v242, a18
v_accvgpr_read_b32 v243, a19
v_accvgpr_read_b32 v244, a20
v_accvgpr_read_b32 v245, a21
v_accvgpr_read_b32 v246, a22
v_accvgpr_read_b32 v247, a23
v_pk_mul_f32 v[240:241], v[240:241], v[248:249] op_sel:[0,0] op_sel_hi:[1,0]
v_pk_mul_f32 v[242:243], v[242:243], v[248:249] op_sel:[0,0] op_sel_hi:[1,0]
v_pk_mul_f32 v[244:245], v[244:245], v[248:249] op_sel:[0,0] op_sel_hi:[1,0]
v_pk_mul_f32 v[246:247], v[246:247], v[248:249] op_sel:[0,0] op_sel_hi:[1,0]
v_cvt_pk_bf16_f32 v240, v240, v241
v_cvt_pk_bf16_f32 v241, v242, v243
v_cvt_pk_bf16_f32 v242, v244, v245
v_cvt_pk_bf16_f32 v243, v246, v247
s_nop 0
v_permlane32_swap_b32 v240, v242
v_permlane32_swap_b32 v241, v243
buffer_store_dwordx4 v[240:243], v239, s[36:39], s69 offen sc1
s_add_u32 s69, s69, 65536
s_nop 0
v_accvgpr_read_b32 v240, a24
v_accvgpr_read_b32 v241, a25
v_accvgpr_read_b32 v242, a26
v_accvgpr_read_b32 v243, a27
v_accvgpr_read_b32 v244, a28
v_accvgpr_read_b32 v245, a29
v_accvgpr_read_b32 v246, a30
v_accvgpr_read_b32 v247, a31
v_pk_mul_f32 v[240:241], v[240:241], v[248:249] op_sel:[0,0] op_sel_hi:[1,0]
v_pk_mul_f32 v[242:243], v[242:243], v[248:249] op_sel:[0,0] op_sel_hi:[1,0]
v_pk_mul_f32 v[244:245], v[244:245], v[248:249] op_sel:[0,0] op_sel_hi:[1,0]
v_pk_mul_f32 v[246:247], v[246:247], v[248:249] op_sel:[0,0] op_sel_hi:[1,0]
v_cvt_pk_bf16_f32 v240, v240, v241
v_cvt_pk_bf16_f32 v241, v242, v243
v_cvt_pk_bf16_f32 v242, v244, v245
v_cvt_pk_bf16_f32 v243, v246, v247
s_nop 0
v_permlane32_swap_b32 v240, v242
v_permlane32_swap_b32 v241, v243
buffer_store_dwordx4 v[240:243], v239, s[36:39], s69 offen sc1
s_add_u32 s71, s62, 2
s_cmp_lt_u32 s71, 20
s_cselect_b32 s68, 0x3ea52b5c, 1.0
v_mul_f32 v248, s68, v235
s_lshl_b32 s69, s71, 17
s_lshl_b32 s68, s54, 4
s_add_u32 s69, s69, s68
v_accvgpr_read_b32 v240, a32
v_accvgpr_read_b32 v241, a33
v_accvgpr_read_b32 v242, a34
v_accvgpr_read_b32 v243, a35
v_accvgpr_read_b32 v244, a36
v_accvgpr_read_b32 v245, a37
v_accvgpr_read_b32 v246, a38
v_accvgpr_read_b32 v247, a39
v_pk_mul_f32 v[240:241], v[240:241], v[248:249] op_sel:[0,0] op_sel_hi:[1,0]
v_pk_mul_f32 v[242:243], v[242:243], v[248:249] op_sel:[0,0] op_sel_hi:[1,0]
v_pk_mul_f32 v[244:245], v[244:245], v[248:249] op_sel:[0,0] op_sel_hi:[1,0]
v_pk_mul_f32 v[246:247], v[246:247], v[248:249] op_sel:[0,0] op_sel_hi:[1,0]
v_cvt_pk_bf16_f32 v240, v240, v241
v_cvt_pk_bf16_f32 v241, v242, v243
v_cvt_pk_bf16_f32 v242, v244, v245
v_cvt_pk_bf16_f32 v243, v246, v247
s_nop 0
v_permlane32_swap_b32 v240, v242
v_permlane32_swap_b32 v241, v243
buffer_store_dwordx4 v[240:243], v239, s[36:39], s69 offen sc1
s_add_u32 s69, s69, 65536
s_nop 0
v_accvgpr_read_b32 v240, a40
v_accvgpr_read_b32 v241, a41
v_accvgpr_read_b32 v242, a42
v_accvgpr_read_b32 v243, a43
v_accvgpr_read_b32 v244, a44
v_accvgpr_read_b32 v245, a45
v_accvgpr_read_b32 v246, a46
v_accvgpr_read_b32 v247, a47
v_pk_mul_f32 v[240:241], v[240:241], v[248:249] op_sel:[0,0] op_sel_hi:[1,0]
v_pk_mul_f32 v[242:243], v[242:243], v[248:249] op_sel:[0,0] op_sel_hi:[1,0]
v_pk_mul_f32 v[244:245], v[244:245], v[248:249] op_sel:[0,0] op_sel_hi:[1,0]
v_pk_mul_f32 v[246:247], v[246:247], v[248:249] op_sel:[0,0] op_sel_hi:[1,0]
v_cvt_pk_bf16_f32 v240, v240, v241
v_cvt_pk_bf16_f32 v241, v242, v243
v_cvt_pk_bf16_f32 v242, v244, v245
v_cvt_pk_bf16_f32 v243, v246, v247
s_nop 0
v_permlane32_swap_b32 v240, v242
v_permlane32_swap_b32 v241, v243
buffer_store_dwordx4 v[240:243], v239, s[36:39], s69 offen sc1
s_add_u32 s71, s61, 0
s_cmp_lt_u32 s71, 20
s_cselect_b32 s68, 0x3ea52b5c, 1.0
v_mul_f32 v248, s68, v235
s_lshl_b32 s69, s71, 17
s_lshl_b32 s68, s54, 4
s_add_u32 s69, s69, s68
v_pk_mul_f32 v[240:241], v[160:161], v[248:249] op_sel:[0,0] op_sel_hi:[1,0]
v_pk_mul_f32 v[242:243], v[162:163], v[248:249] op_sel:[0,0] op_sel_hi:[1,0]
v_pk_mul_f32 v[244:245], v[164:165], v[248:249] op_sel:[0,0] op_sel_hi:[1,0]
v_pk_mul_f32 v[246:247], v[166:167], v[248:249] op_sel:[0,0] op_sel_hi:[1,0]
v_cvt_pk_bf16_f32 v240, v240, v241
v_cvt_pk_bf16_f32 v241, v242, v243
v_cvt_pk_bf16_f32 v242, v244, v245
v_cvt_pk_bf16_f32 v243, v246, v247
s_nop 0
v_permlane32_swap_b32 v240, v242
v_permlane32_swap_b32 v241, v243
buffer_store_dwordx4 v[240:243], v239, s[36:39], s69 offen sc1
s_add_u32 s69, s69, 65536
s_nop 0
v_pk_mul_f32 v[240:241], v[168:169], v[248:249] op_sel:[0,0] op_sel_hi:[1,0]
v_pk_mul_f32 v[242:243], v[170:171], v[248:249] op_sel:[0,0] op_sel_hi:[1,0]
v_pk_mul_f32 v[244:245], v[172:173], v[248:249] op_sel:[0,0] op_sel_hi:[1,0]
v_pk_mul_f32 v[246:247], v[174:175], v[248:249] op_sel:[0,0] op_sel_hi:[1,0]
v_cvt_pk_bf16_f32 v240, v240, v241
v_cvt_pk_bf16_f32 v241, v242, v243
v_cvt_pk_bf16_f32 v242, v244, v245
v_cvt_pk_bf16_f32 v243, v246, v247
s_nop 0
v_permlane32_swap_b32 v240, v242
v_permlane32_swap_b32 v241, v243
buffer_store_dwordx4 v[240:243], v239, s[36:39], s69 offen sc1
s_add_u32 s71, s61, 1
s_cmp_lt_u32 s71, 20
s_cselect_b32 s68, 0x3ea52b5c, 1.0
v_mul_f32 v248, s68, v235
s_lshl_b32 s69, s71, 17
s_lshl_b32 s68, s54, 4
s_add_u32 s69, s69, s68
v_pk_mul_f32 v[240:241], v[176:177], v[248:249] op_sel:[0,0] op_sel_hi:[1,0]
v_pk_mul_f32 v[242:243], v[178:179], v[248:249] op_sel:[0,0] op_sel_hi:[1,0]
v_pk_mul_f32 v[244:245], v[180:181], v[248:249] op_sel:[0,0] op_sel_hi:[1,0]
v_pk_mul_f32 v[246:247], v[182:183], v[248:249] op_sel:[0,0] op_sel_hi:[1,0]
v_cvt_pk_bf16_f32 v240, v240, v241
v_cvt_pk_bf16_f32 v241, v242, v243
v_cvt_pk_bf16_f32 v242, v244, v245
v_cvt_pk_bf16_f32 v243, v246, v247
s_nop 0
v_permlane32_swap_b32 v240, v242
v_permlane32_swap_b32 v241, v243
buffer_store_dwordx4 v[240:243], v239, s[36:39], s69 offen sc1
s_add_u32 s69, s69, 65536
s_nop 0
v_pk_mul_f32 v[240:241], v[184:185], v[248:249] op_sel:[0,0] op_sel_hi:[1,0]
v_pk_mul_f32 v[242:243], v[186:187], v[248:249] op_sel:[0,0] op_sel_hi:[1,0]
v_pk_mul_f32 v[244:245], v[188:189], v[248:249] op_sel:[0,0] op_sel_hi:[1,0]
v_pk_mul_f32 v[246:247], v[190:191], v[248:249] op_sel:[0,0] op_sel_hi:[1,0]
v_cvt_pk_bf16_f32 v240, v240, v241
v_cvt_pk_bf16_f32 v241, v242, v243
v_cvt_pk_bf16_f32 v242, v244, v245
v_cvt_pk_bf16_f32 v243, v246, v247
s_nop 0
v_permlane32_swap_b32 v240, v242
v_permlane32_swap_b32 v241, v243
buffer_store_dwordx4 v[240:243], v239, s[36:39], s69 offen sc1
s_add_u32 s71, s61, 2
s_cmp_lt_u32 s71, 20
s_cselect_b32 s68, 0x3ea52b5c, 1.0
v_mul_f32 v248, s68, v235
s_lshl_b32 s69, s71, 17
s_lshl_b32 s68, s54, 4
s_add_u32 s69, s69, s68
v_pk_mul_f32 v[240:241], v[192:193], v[248:249] op_sel:[0,0] op_sel_hi:[1,0]
v_pk_mul_f32 v[242:243], v[194:195], v[248:249] op_sel:[0,0] op_sel_hi:[1,0]
v_pk_mul_f32 v[244:245], v[196:197], v[248:249] op_sel:[0,0] op_sel_hi:[1,0]
v_pk_mul_f32 v[246:247], v[198:199], v[248:249] op_sel:[0,0] op_sel_hi:[1,0]
v_cvt_pk_bf16_f32 v240, v240, v241
v_cvt_pk_bf16_f32 v241, v242, v243
v_cvt_pk_bf16_f32 v242, v244, v245
v_cvt_pk_bf16_f32 v243, v246, v247
s_nop 0
v_permlane32_swap_b32 v240, v242
v_permlane32_swap_b32 v241, v243
buffer_store_dwordx4 v[240:243], v239, s[36:39], s69 offen sc1
s_add_u32 s69, s69, 65536
s_nop 0
v_pk_mul_f32 v[240:241], v[200:201], v[248:249] op_sel:[0,0] op_sel_hi:[1,0]
v_pk_mul_f32 v[242:243], v[202:203], v[248:249] op_sel:[0,0] op_sel_hi:[1,0]
v_pk_mul_f32 v[244:245], v[204:205], v[248:249] op_sel:[0,0] op_sel_hi:[1,0]
v_pk_mul_f32 v[246:247], v[206:207], v[248:249] op_sel:[0,0] op_sel_hi:[1,0]
v_cvt_pk_bf16_f32 v240, v240, v241
v_cvt_pk_bf16_f32 v241, v242, v243
v_cvt_pk_bf16_f32 v242, v244, v245
v_cvt_pk_bf16_f32 v243, v246, v247
s_nop 0
v_permlane32_swap_b32 v240, v242
v_permlane32_swap_b32 v241, v243
buffer_store_dwordx4 v[240:243], v239, s[36:39], s69 offen sc1
s_add_u32 s71, s61, 3
s_cmp_lt_u32 s71, 20
s_cselect_b32 s68, 0x3ea52b5c, 1.0
v_mul_f32 v248, s68, v235
s_lshl_b32 s69, s71, 17
s_lshl_b32 s68, s54, 4
s_add_u32 s69, s69, s68
v_pk_mul_f32 v[240:241], v[208:209], v[248:249] op_sel:[0,0] op_sel_hi:[1,0]
v_pk_mul_f32 v[242:243], v[210:211], v[248:249] op_sel:[0,0] op_sel_hi:[1,0]
v_pk_mul_f32 v[244:245], v[212:213], v[248:249] op_sel:[0,0] op_sel_hi:[1,0]
v_pk_mul_f32 v[246:247], v[214:215], v[248:249] op_sel:[0,0] op_sel_hi:[1,0]
v_cvt_pk_bf16_f32 v240, v240, v241
v_cvt_pk_bf16_f32 v241, v242, v243
v_cvt_pk_bf16_f32 v242, v244, v245
v_cvt_pk_bf16_f32 v243, v246, v247
s_nop 0
v_permlane32_swap_b32 v240, v242
v_permlane32_swap_b32 v241, v243
buffer_store_dwordx4 v[240:243], v239, s[36:39], s69 offen sc1
s_add_u32 s69, s69, 65536
s_nop 0
v_pk_mul_f32 v[240:241], v[216:217], v[248:249] op_sel:[0,0] op_sel_hi:[1,0]
v_pk_mul_f32 v[242:243], v[218:219], v[248:249] op_sel:[0,0] op_sel_hi:[1,0]
v_pk_mul_f32 v[244:245], v[220:221], v[248:249] op_sel:[0,0] op_sel_hi:[1,0]
v_pk_mul_f32 v[246:247], v[222:223], v[248:249] op_sel:[0,0] op_sel_hi:[1,0]
v_cvt_pk_bf16_f32 v240, v240, v241
v_cvt_pk_bf16_f32 v241, v242, v243
v_cvt_pk_bf16_f32 v242, v244, v245
v_cvt_pk_bf16_f32 v243, v246, v247
s_nop 0
v_permlane32_swap_b32 v240, v242
v_permlane32_swap_b32 v241, v243
buffer_store_dwordx4 v[240:243], v239, s[36:39], s69 offen sc1
s_lshl_b32 s72, s5, 2
s_sub_u32 s72, 60, s72
s_lshr_b64 s[76:77], -1, s72
s_sub_u32 s72, s5, 2
s_cselect_b32 s72, 0, s72
s_lshl_b32 s72, s72, 2
s_lshr_b64 s[76:77], s[76:77], s72
s_lshl_b64 s[76:77], s[76:77], s72
s_add_u32 s74, s16, 14336
s_add_u32 m0, s17, 14336
s_nop 0
buffer_load_dwordx4 v249, s[36:39], s74 offen sc1 lds
s_add_u32 s74, s16, 15360
s_add_u32 m0, s17, 15360
s_nop 0
buffer_load_dwordx4 v249, s[36:39], s74 offen sc1 lds
s_add_u32 s74, s16, 16384
s_add_u32 m0, s17, 16384
s_nop 0
buffer_load_dwordx4 v249, s[36:39], s74 offen sc1 lds
s_add_u32 s74, s16, 17408
s_add_u32 m0, s17, 17408
s_nop 0
buffer_load_dwordx4 v249, s[36:39], s74 offen sc1 lds
s_add_u32 s74, s16, 18432
s_add_u32 m0, s17, 18432
s_nop 0
buffer_load_dwordx4 v249, s[36:39], s74 offen sc1 lds
s_add_u32 s74, s16, 19456
s_add_u32 m0, s17, 19456
s_nop 0
buffer_load_dwordx4 v249, s[36:39], s74 offen sc1 lds
s_add_u32 s74, s16, 20480
s_add_u32 m0, s17, 20480
s_nop 0
buffer_load_dwordx4 v249, s[36:39], s74 offen sc1 lds
s_waitcnt vmcnt(7)
s_barrier
s_lshl_b32 s72, s52, 7
s_lshl_b32 s73, s53, 2
s_add_u32 s72, s72, s73
s_add_u32 s72, s72, 20594816
s_cmp_eq_u32 s3, 0
s_cselect_b32 s72, s72, 2146435072
v_lshlrev_b32 v254, 25, v224
v_mov_b32 v255, s4
buffer_store_dword v255, v254, s[36:39], s72 offen sc1
s_lshl_b32 s72, s52, 8
s_lshl_b32 s73, s53, 4
s_add_u32 s72, s72, s73
s_lshl_b32 s73, s3, 2
s_add_u32 s72, s72, s73
s_add_u32 s72, s72, 20598912
v_lshlrev_b32 v254, 25, v224
v_mov_b32 v255, s4
buffer_store_dword v255, v254, s[36:39], s72 offen sc1
s_add_u32 s79, s78, 0
buffer_load_dwordx4 a[168:171], v226, s[36:39], s79 offen sc1
buffer_load_dwordx4 a[172:175], v226, s[36:39], s79 offen offset:1024 sc1
buffer_load_dwordx4 a[176:179], v226, s[36:39], s79 offen offset:2048 sc1
buffer_load_dwordx4 a[180:183], v226, s[36:39], s79 offen offset:3072 sc1
buffer_load_dwordx4 a[184:187], v231, s[36:39], s79 offen sc1
s_add_u32 s79, s78, 5120
buffer_load_dwordx4 a[188:191], v226, s[36:39], s79 offen sc1
buffer_load_dwordx4 a[192:195], v226, s[36:39], s79 offen offset:1024 sc1
buffer_load_dwordx4 a[196:199], v226, s[36:39], s79 offen offset:2048 sc1
buffer_load_dwordx4 a[200:203], v226, s[36:39], s79 offen offset:3072 sc1
buffer_load_dwordx4 a[204:207], v231, s[36:39], s79 offen sc1
s_add_u32 s79, s78, 10240
buffer_load_dwordx4 a[208:211], v226, s[36:39], s79 offen sc1
buffer_load_dwordx4 a[212:215], v226, s[36:39], s79 offen offset:1024 sc1
buffer_load_dwordx4 a[216:219], v226, s[36:39], s79 offen offset:2048 sc1
buffer_load_dwordx4 a[220:223], v226, s[36:39], s79 offen offset:3072 sc1
buffer_load_dwordx4 a[224:227], v231, s[36:39], s79 offen sc1
s_add_u32 s79, s78, 15360
buffer_load_dwordx4 a[228:231], v226, s[36:39], s79 offen sc1
buffer_load_dwordx4 a[232:235], v226, s[36:39], s79 offen offset:1024 sc1
buffer_load_dwordx4 a[236:239], v226, s[36:39], s79 offen offset:2048 sc1
buffer_load_dwordx4 a[240:243], v226, s[36:39], s79 offen offset:3072 sc1
buffer_load_dwordx4 a[244:247], v231, s[36:39], s79 offen sc1
v_lshrrev_b32 v168, 2, v224
v_lshlrev_b32 v168, 7, v168
v_and_b32 v164, 3, v224
v_lshl_add_u32 v168, v164, 4, v168
v_mov_b32 v164, 2146435072
v_cndmask_b32 v168, v164, v168, s[76:77]
s_mov_b32 s72, 20594816
buffer_load_dwordx4 v[164:167], v168, s[36:39], s72 offen sc1
s_waitcnt vmcnt(0)
s_mov_b32 s70, 0
L_pq_12:
v_xor_b32 v164, s4, v164
v_xor_b32 v165, s4, v165
v_xor_b32 v166, s4, v166
v_xor_b32 v167, s4, v167
v_or3_b32 v164, v164, v165, v166
v_or_b32 v164, v164, v167
v_cmp_ne_u32 vcc, 0, v164
s_nop 3
s_and_b64 vcc, vcc, s[76:77]
s_cbranch_scc0 L_pd_13
s_add_u32 s70, s70, 1
s_cmp_ge_u32 s70, 200000
s_cbranch_scc1 L_pd_13
s_sleep 2
s_mov_b32 s72, 20594816
buffer_load_dwordx4 v[164:167], v168, s[36:39], s72 offen sc1
s_waitcnt vmcnt(0)
s_branch L_pq_12
L_pd_13:
s_lshl_b32 s70, s5, 11
s_sub_u32 s70, s70, 4096
s_mul_i32 s71, s6, 5
s_add_u32 s72, s3, 0
s_cmp_lt_u32 s72, 5
s_mov_b32 s73, 155
s_cselect_b32 s73, 80, s73
s_add_u32 s73, s73, s71
s_add_u32 s73, s73, s72
s_lshl_b32 s73, s73, 15
s_add_u32 s73, s73, s70
s_mul_i32 s74, s72, 6208
s_add_u32 s74, s74, 0
s_cmp_lt_u32 s72, 10
s_cselect_b32 s73, s73, 2146435072
s_cselect_b32 m0, s74, 0x30000
s_cmp_lt_u32 s5, 2
s_cselect_b32 s74, 2146435072, s73
buffer_load_dwordx4 v226, s[36:39], s74 offen sc1 lds
buffer_load_dwordx4 v226, s[36:39], s74 offen offset:1024 sc1 lds
s_cmp_lt_u32 s5, 1
s_cselect_b32 s74, 2146435072, s73
buffer_load_dwordx4 v226, s[36:39], s74 offen offset:2048 sc1 lds
buffer_load_dwordx4 v226, s[36:39], s74 offen offset:3072 sc1 lds
s_add_u32 s74, s73, 4096
s_add_u32 m0, m0, 4096
s_nop 0
buffer_load_dwordx4 v226, s[36:39], s74 offen sc1 lds
buffer_load_dwordx4 v226, s[36:39], s74 offen offset:1024 sc1 lds
s_add_u32 s72, s3, 4
s_cmp_lt_u32 s72, 5
s_mov_b32 s73, 155
s_cselect_b32 s73, 80, s73
s_add_u32 s73, s73, s71
s_add_u32 s73, s73, s72
s_lshl_b32 s73, s73, 15
s_add_u32 s73, s73, s70
s_mul_i32 s74, s72, 6208
s_add_u32 s74, s74, 0
s_cmp_lt_u32 s72, 10
s_cselect_b32 s73, s73, 2146435072
s_cselect_b32 m0, s74, 0x30000
s_cmp_lt_u32 s5, 2
s_cselect_b32 s74, 2146435072, s73
buffer_load_dwordx4 v226, s[36:39], s74 offen sc1 lds
buffer_load_dwordx4 v226, s[36:39], s74 offen offset:1024 sc1 lds
s_cmp_lt_u32 s5, 1
s_cselect_b32 s74, 2146435072, s73
buffer_load_dwordx4 v226, s[36:39], s74 offen offset:2048 sc1 lds
buffer_load_dwordx4 v226, s[36:39], s74 offen offset:3072 sc1 lds
s_add_u32 s74, s73, 4096
s_add_u32 m0, m0, 4096
s_nop 0
buffer_load_dwordx4 v226, s[36:39], s74 offen sc1 lds
buffer_load_dwordx4 v226, s[36:39], s74 offen offset:1024 sc1 lds
s_add_u32 s72, s3, 8
s_cmp_lt_u32 s72, 5
s_mov_b32 s73, 155
s_cselect_b32 s73, 80, s73
s_add_u32 s73, s73, s71
s_add_u32 s73, s73, s72
s_lshl_b32 s73, s73, 15
s_add_u32 s73, s73, s70
s_mul_i32 s74, s72, 6208
s_add_u32 s74, s74, 0
s_cmp_lt_u32 s72, 10
s_cselect_b32 s73, s73, 2146435072
s_cselect_b32 m0, s74, 0x30000
s_cmp_lt_u32 s5, 2
s_cselect_b32 s74, 2146435072, s73
buffer_load_dwordx4 v226, s[36:39], s74 offen sc1 lds
buffer_load_dwordx4 v226, s[36:39], s74 offen offset:1024 sc1 lds
s_cmp_lt_u32 s5, 1
s_cselect_b32 s74, 2146435072, s73
buffer_load_dwordx4 v226, s[36:39], s74 offen offset:2048 sc1 lds
buffer_load_dwordx4 v226, s[36:39], s74 offen offset:3072 sc1 lds
s_add_u32 s74, s73, 4096
s_add_u32 m0, m0, 4096
s_nop 0
buffer_load_dwordx4 v226, s[36:39], s74 offen sc1 lds
buffer_load_dwordx4 v226, s[36:39], s74 offen offset:1024 sc1 lds
s_lshl_b32 s72, s5, 7
s_lshl_b32 s73, s3, 5
s_add_u32 s72, s72, s73
s_lshl_b32 s72, s72, 4
s_lshl_b32 s73, s71, 15
s_add_u32 s72, s72, s73
s_add_u32 s73, s72, 98304
s_add_u32 s74, s72, 65536
v_and_b32 v252, 31, v224
v_lshlrev_b32 v252, 4, v252
v_cmp_gt_u32 vcc, 32, v224
v_mov_b32 v253, 2146435072
s_nop 0
v_cndmask_b32 v252, v253, v252, vcc
buffer_load_dwordx4 v[128:131], v239, s[36:39], s72 offen sc1
buffer_load_dwordx4 v[138:141], v239, s[36:39], s73 offen sc1
buffer_load_dwordx2 v[132:133], v252, s[36:39], s74 offen sc1
buffer_load_dwordx2 v[136:137], v252, s[36:39], s74 offen offset:8 sc1
v_mov_b32 v253, 0x3f80
v_cndmask_b32 v134, v253, 0, vcc
v_mov_b32 v135, 0
v_mov_b32 v244, 2146435072
buffer_load_dword a250, v244, s[36:39], 0 offen
buffer_load_dword a251, v244, s[36:39], 0 offen
buffer_load_dword a252, v244, s[36:39], 0 offen
buffer_load_dword a253, v244, s[36:39], 0 offen
L_ab_done:
v_mov_b32 v0, 0x3f803f80
v_mov_b32 v1, 0x3f803f80
v_mov_b32 v2, 0x3f803f80
v_mov_b32 v3, 0x3f803f80
s_lshl_b32 s76, s3, 10
s_add_u32 s76, s76, 62080
v_lshl_add_u32 v241, v224, 4, s76
ds_write_b128 v241, v[0:3]
ds_write_b128 v241, v[0:3] offset:4096
s_lshl_b32 s76, s3, 6
s_add_u32 s76, s76, 0
v_add_u32 v241, s76, v224
s_lshl_b32 s77, s5, 7
s_sub_u32 s77, 256, s77
v_cmp_gt_i32 vcc, s77, v241
v_mov_b32 v242, 0x0000f149
s_nop 0
v_cndmask_b32 v4, 0, v242, vcc
v_mov_b32 v5, 0
v_mov_b32 v6, v4
v_mov_b32 v7, 0
v_lshlrev_b32 v243, 4, v241
v_add_u32 v243, 70272, v243
v_cmp_gt_u32 vcc, 384, v241
v_mov_b32 v242, 0x30000
s_nop 0
v_cndmask_b32 v243, v242, v243, vcc
ds_write_b128 v243, v[4:7]
s_lshl_b32 s76, s3, 6
s_add_u32 s76, s76, 256
v_add_u32 v241, s76, v224
s_lshl_b32 s77, s5, 7
s_sub_u32 s77, 256, s77
v_cmp_gt_i32 vcc, s77, v241
v_mov_b32 v242, 0x0000f149
s_nop 0
v_cndmask_b32 v4, 0, v242, vcc
v_mov_b32 v5, 0
v_mov_b32 v6, v4
v_mov_b32 v7, 0
v_lshlrev_b32 v243, 4, v241
v_add_u32 v243, 70272, v243
v_cmp_gt_u32 vcc, 384, v241
v_mov_b32 v242, 0x30000
s_nop 0
v_cndmask_b32 v243, v242, v243, vcc
ds_write_b128 v243, v[4:7]
v_and_b32 v240, 31, v224
v_lshlrev_b32 v240, 4, v240
s_lshl_b32 s76, s3, 9
v_add_u32 v240, s76, v240
v_lshrrev_b32 v241, 5, v224
v_mul_u32_u24 v242, 6208, v241
v_add_u32 v242, v242, v240
v_add_u32 v152, 0, v242
v_mul_u32_u24 v242, 57856, v241
v_add_u32 v242, v242, v240
v_add_u32 v153, 12416, v242
v_lshrrev_b32 v240, 5, v224
v_lshlrev_b32 v240, 2, v240
v_bfe_u32 v241, v224, 2, 2
v_add_u32 v240, v240, v241
v_lshlrev_b32 v240, 4, v240
v_add_u32 v240, s76, v240
v_and_b32 v241, 3, v224
v_bfe_u32 v242, v224, 4, 1
v_lshl_add_u32 v241, v242, 2, v241
v_add_u32 v242, 0, v241
v_lshrrev_b32 v243, 1, v242
v_mul_u32_u24 v243, 6208, v243
v_and_b32 v242, 1, v242
v_lshl_add_u32 v243, v242, 3, v243
v_add_u32 v243, 31040, v243
v_cmp_gt_u32 vcc, 5, v241
v_mov_b32 v242, 62208
s_nop 0
v_cndmask_b32 v243, v242, v243, vcc
v_add_u32 v154, v243, v240
v_add_u32 v242, 5, v241
v_lshrrev_b32 v243, 1, v242
v_mul_u32_u24 v243, 6208, v243
v_and_b32 v242, 1, v242
v_lshl_add_u32 v243, v242, 3, v243
v_add_u32 v243, 31040, v243
v_cmp_gt_u32 vcc, 5, v241
v_mov_b32 v242, 62080
s_nop 0
v_cndmask_b32 v243, v242, v243, vcc
v_add_u32 v155, v243, v240
v_and_b32 v240, 31, v224
v_lshrrev_b32 v241, 5, v224
v_lshlrev_b32 v241, 2, v241
v_sub_u32 v240, v240, v241
v_mov_b32 v241, 0xffff
v_mov_b32 v242, 0xffff0000
v_cmp_gt_i32 vcc, 0, v240
s_nop 1
v_cndmask_b32 v144, 0, v241, vcc
v_cmp_gt_i32 vcc, 1, v240
s_nop 1
v_cndmask_b32 v243, 0, v242, vcc
v_or_b32 v144, v144, v243
v_cmp_gt_i32 vcc, 2, v240
s_nop 1
v_cndmask_b32 v145, 0, v241, vcc
v_cmp_gt_i32 vcc, 3, v240
s_nop 1
v_cndmask_b32 v243, 0, v242, vcc
v_or_b32 v145, v145, v243
v_cmp_gt_i32 vcc, 8, v240
s_nop 1
v_cndmask_b32 v146, 0, v241, vcc
v_cmp_gt_i32 vcc, 9, v240
s_nop 1
v_cndmask_b32 v243, 0, v242, vcc
v_or_b32 v146, v146, v243
v_cmp_gt_i32 vcc, 10, v240
s_nop 1
v_cndmask_b32 v147, 0, v241, vcc
v_cmp_gt_i32 vcc, 11, v240
s_nop 1
v_cndmask_b32 v243, 0, v242, vcc
v_or_b32 v147, v147, v243
v_cmp_gt_i32 vcc, 16, v240
s_nop 1
v_cndmask_b32 v148, 0, v241, vcc
v_cmp_gt_i32 vcc, 17, v240
s_nop 1
v_cndmask_b32 v243, 0, v242, vcc
v_or_b32 v148, v148, v243
v_cmp_gt_i32 vcc, 18, v240
s_nop 1
v_cndmask_b32 v149, 0, v241, vcc
v_cmp_gt_i32 vcc, 19, v240
s_nop 1
v_cndmask_b32 v243, 0, v242, vcc
v_or_b32 v149, v149, v243
v_cmp_gt_i32 vcc, 24, v240
s_nop 1
v_cndmask_b32 v150, 0, v241, vcc
v_cmp_gt_i32 vcc, 25, v240
s_nop 1
v_cndmask_b32 v243, 0, v242, vcc
v_or_b32 v150, v150, v243
v_cmp_gt_i32 vcc, 26, v240
s_nop 1
v_cndmask_b32 v151, 0, v241, vcc
v_cmp_gt_i32 vcc, 27, v240
s_nop 1
v_cndmask_b32 v243, 0, v242, vcc
v_or_b32 v151, v151, v243
v_mov_b32 v156, v240
s_waitcnt vmcnt(4) lgkmcnt(0)
s_barrier
s_add_u32 s70, s3, 0
s_and_b32 s70, s70, 3
s_lshl_b32 s70, s70, 10
v_add_u32 v228, s70, v226
s_add_u32 s70, s3, 1
s_and_b32 s70, s70, 3
s_lshl_b32 s70, s70, 10
v_add_u32 v229, s70, v226
s_add_u32 s70, s3, 2
s_and_b32 s70, s70, 3
s_lshl_b32 s70, s70, 10
v_add_u32 v230, s70, v226
s_add_u32 s70, s3, 3
s_and_b32 s70, s70, 3
s_lshl_b32 s70, s70, 10
v_add_u32 v232, s70, v226
s_mul_i32 s10, s7, 221184
s_lshl_b32 s70, s9, 12
s_add_u32 s10, s10, s70
s_add_u32 s10, s10, 7864320
v_mov_b32 v158, 0x5d800000
v_mov_b32 v159, 0x21800000
v_mov_b32 v48, 0
v_mov_b32 v49, 0
v_mov_b32 v50, 0
v_mov_b32 v51, 0
v_mov_b32 v52, 0
v_mov_b32 v53, 0
v_mov_b32 v54, 0
v_mov_b32 v55, 0
v_mov_b32 v56, 0
v_mov_b32 v57, 0
v_mov_b32 v58, 0
v_mov_b32 v59, 0
v_mov_b32 v60, 0
v_mov_b32 v61, 0
v_mov_b32 v62, 0
v_mov_b32 v63, 0
s_mov_b32 s69, 0
L_are_17:
ds_read_b128 v[96:99], v152 offset:0
ds_read_b128 v[100:103], v153 offset:0
s_waitcnt lgkmcnt(0)
v_mfma_f32_32x32x16_bf16 v[0:15], v[96:99], v[128:131], v[48:63]
v_mfma_f32_32x32x16_bf16 v[0:15], v[100:103], v[132:135], v[0:15]
ds_read_b128 v[104:107], v152 offset:512
ds_read_b128 v[108:111], v153 offset:512
ds_read_b64_tr_b16 v[112:113], v154 offset:0
ds_read_b64_tr_b16 v[114:115], v154 offset:128
ds_read_b64_tr_b16 v[116:117], v154 offset:256
ds_read_b64_tr_b16 v[118:119], v154 offset:384
s_waitcnt lgkmcnt(4)
v_mfma_f32_32x32x16_bf16 v[16:31], v[104:107], v[128:131], v[48:63]
s_nop 3
v_exp_f32 v0, v0
v_exp_f32 v1, v1
v_exp_f32 v2, v2
v_exp_f32 v3, v3
v_mfma_f32_32x32x16_bf16 v[16:31], v[108:111], v[132:135], v[16:31]
ds_read_b128 v[96:99], v152 offset:1024
ds_read_b128 v[100:103], v153 offset:1024
v_exp_f32 v4, v4
v_cvt_pk_bf16_f32 v32, v0, v1
v_exp_f32 v5, v5
v_cvt_pk_bf16_f32 v33, v2, v3
s_add_u32 s79, s78, 20480
buffer_load_dwordx4 a[0:3], v226, s[36:39], s79 offen sc1
v_exp_f32 v6, v6
v_exp_f32 v7, v7
v_and_b32 v32, v144, v32
v_and_b32 v33, v145, v33
v_cvt_pk_bf16_f32 v34, v4, v5
v_exp_f32 v8, v8
v_cvt_pk_bf16_f32 v35, v6, v7
v_exp_f32 v9, v9
v_and_b32 v34, v146, v34
v_and_b32 v35, v147, v35
s_waitcnt lgkmcnt(2)
s_nop 0
v_mfma_f32_32x32x16_bf16 v[64:79], v[112:115], v[32:35], 0
buffer_load_dwordx4 a[4:7], v226, s[36:39], s79 offen offset:1024 sc1
v_exp_f32 v10, v10
v_exp_f32 v11, v11
v_cvt_pk_bf16_f32 v36, v8, v9
v_exp_f32 v12, v12
v_exp_f32 v13, v13
v_cvt_pk_bf16_f32 v37, v10, v11
buffer_load_dwordx4 a[8:11], v226, s[36:39], s79 offen offset:2048 sc1
v_exp_f32 v14, v14
v_exp_f32 v15, v15
v_cvt_pk_bf16_f32 v38, v12, v13
v_and_b32 v36, v148, v36
v_and_b32 v37, v149, v37
v_cvt_pk_bf16_f32 v39, v14, v15
v_and_b32 v38, v150, v38
v_and_b32 v39, v151, v39
s_nop 1
v_mfma_f32_32x32x16_bf16 v[64:79], v[116:119], v[36:39], v[64:79]
ds_read_b64_tr_b16 v[120:121], v154 offset:512
ds_read_b64_tr_b16 v[122:123], v154 offset:640
ds_read_b64_tr_b16 v[124:125], v154 offset:768
ds_read_b64_tr_b16 v[126:127], v154 offset:896
s_waitcnt lgkmcnt(4)
v_mfma_f32_32x32x16_bf16 v[0:15], v[96:99], v[128:131], v[48:63]
s_waitcnt vmcnt(3)
s_lshl_b32 s72, s52, 8
s_lshl_b32 s73, s53, 4
s_add_u32 s72, s72, s73
s_lshl_b32 s73, s3, 2
s_add_u32 s72, s72, s73
s_add_u32 s72, s72, 20598912
v_lshlrev_b32 v254, 25, v224
v_mov_b32 v255, s4
buffer_store_dword v255, v254, s[36:39], s72 offen sc1
v_exp_f32 v16, v16
v_exp_f32 v17, v17
v_exp_f32 v18, v18
v_exp_f32 v19, v19
v_mfma_f32_32x32x16_bf16 v[0:15], v[100:103], v[132:135], v[0:15]
ds_read_b128 v[104:107], v152 offset:1536
ds_read_b128 v[108:111], v153 offset:1536
v_exp_f32 v20, v20
v_cvt_pk_bf16_f32 v40, v16, v17
v_exp_f32 v21, v21
v_cvt_pk_bf16_f32 v41, v18, v19
buffer_load_dwordx4 a[12:15], v226, s[36:39], s79 offen offset:3072 sc1
v_exp_f32 v22, v22
v_exp_f32 v23, v23
v_cvt_pk_bf16_f32 v42, v20, v21
v_exp_f32 v24, v24
v_cvt_pk_bf16_f32 v43, v22, v23
v_exp_f32 v25, v25
s_waitcnt lgkmcnt(2)
v_mfma_f32_32x32x16_bf16 v[64:79], v[120:123], v[40:43], v[64:79]
buffer_load_dwordx4 a[16:19], v231, s[36:39], s79 offen sc1
v_exp_f32 v26, v26
v_exp_f32 v27, v27
v_cvt_pk_bf16_f32 v44, v24, v25
v_exp_f32 v28, v28
v_exp_f32 v29, v29
v_cvt_pk_bf16_f32 v45, v26, v27
s_add_u32 s79, s78, 25600
buffer_load_dwordx4 a[20:23], v226, s[36:39], s79 offen sc1
v_exp_f32 v30, v30
v_exp_f32 v31, v31
v_cvt_pk_bf16_f32 v46, v28, v29
v_cvt_pk_bf16_f32 v47, v30, v31
s_nop 1
v_mfma_f32_32x32x16_bf16 v[64:79], v[124:127], v[44:47], v[64:79]
ds_read_b64_tr_b16 v[112:113], v154 offset:1024
ds_read_b64_tr_b16 v[114:115], v154 offset:1152
ds_read_b64_tr_b16 v[116:117], v154 offset:1280
ds_read_b64_tr_b16 v[118:119], v154 offset:1408
s_waitcnt lgkmcnt(4)
v_mfma_f32_32x32x16_bf16 v[16:31], v[104:107], v[128:131], v[48:63]
v_exp_f32 v0, v0
v_exp_f32 v1, v1
v_exp_f32 v2, v2
v_exp_f32 v3, v3
v_mfma_f32_32x32x16_bf16 v[16:31], v[108:111], v[132:135], v[16:31]
ds_read_b128 v[96:99], v152 offset:2048
ds_read_b128 v[100:103], v153 offset:2048
v_exp_f32 v4, v4
v_cvt_pk_bf16_f32 v32, v0, v1
v_exp_f32 v5, v5
v_cvt_pk_bf16_f32 v33, v2, v3
buffer_load_dwordx4 a[24:27], v226, s[36:39], s79 offen offset:1024 sc1
v_exp_f32 v6, v6
v_exp_f32 v7, v7
v_cvt_pk_bf16_f32 v34, v4, v5
v_exp_f32 v8, v8
v_cvt_pk_bf16_f32 v35, v6, v7
v_exp_f32 v9, v9
s_waitcnt lgkmcnt(2)
v_mfma_f32_32x32x16_bf16 v[64:79], v[112:115], v[32:35], v[64:79]
buffer_load_dwordx4 a[28:31], v226, s[36:39], s79 offen offset:2048 sc1
v_exp_f32 v10, v10
v_exp_f32 v11, v11
v_cvt_pk_bf16_f32 v36, v8, v9
v_exp_f32 v12, v12
v_exp_f32 v13, v13
v_cvt_pk_bf16_f32 v37, v10, v11
buffer_load_dwordx4 a[32:35], v226, s[36:39], s79 offen offset:3072 sc1
v_exp_f32 v14, v14
v_exp_f32 v15, v15
v_cvt_pk_bf16_f32 v38, v12, v13
v_cvt_pk_bf16_f32 v39, v14, v15
s_nop 1
v_mfma_f32_32x32x16_bf16 v[64:79], v[116:119], v[36:39], v[64:79]
ds_read_b64_tr_b16 v[120:121], v154 offset:1536
ds_read_b64_tr_b16 v[122:123], v154 offset:1664
ds_read_b64_tr_b16 v[124:125], v154 offset:1792
ds_read_b64_tr_b16 v[126:127], v154 offset:1920
s_waitcnt lgkmcnt(4)
v_mfma_f32_32x32x16_bf16 v[0:15], v[96:99], v[128:131], v[48:63]
v_exp_f32 v16, v16
v_exp_f32 v17, v17
v_exp_f32 v18, v18
v_exp_f32 v19, v19
v_mfma_f32_32x32x16_bf16 v[0:15], v[100:103], v[132:135], v[0:15]
ds_read_b128 v[104:107], v152 offset:2560
ds_read_b128 v[108:111], v153 offset:2560
v_exp_f32 v20, v20
v_cvt_pk_bf16_f32 v40, v16, v17
v_exp_f32 v21, v21
v_cvt_pk_bf16_f32 v41, v18, v19
buffer_load_dwordx4 a[36:39], v231, s[36:39], s79 offen sc1
v_exp_f32 v22, v22
v_exp_f32 v23, v23
v_cvt_pk_bf16_f32 v42, v20, v21
v_exp_f32 v24, v24
v_cvt_pk_bf16_f32 v43, v22, v23
v_exp_f32 v25, v25
s_waitcnt lgkmcnt(2)
v_mfma_f32_32x32x16_bf16 v[64:79], v[120:123], v[40:43], v[64:79]
s_add_u32 s79, s78, 30720
buffer_load_dwordx4 a[40:43], v226, s[36:39], s79 offen sc1
v_exp_f32 v26, v26
v_exp_f32 v27, v27
v_cvt_pk_bf16_f32 v44, v24, v25
v_exp_f32 v28, v28
v_exp_f32 v29, v29
v_cvt_pk_bf16_f32 v45, v26, v27
buffer_load_dwordx4 a[44:47], v226, s[36:39], s79 offen offset:1024 sc1
v_exp_f32 v30, v30
v_exp_f32 v31, v31
v_cvt_pk_bf16_f32 v46, v28, v29
v_cvt_pk_bf16_f32 v47, v30, v31
s_nop 1
v_mfma_f32_32x32x16_bf16 v[64:79], v[124:127], v[44:47], v[64:79]
ds_read_b64_tr_b16 v[112:113], v154 offset:2048
ds_read_b64_tr_b16 v[114:115], v154 offset:2176
ds_read_b64_tr_b16 v[116:117], v154 offset:2304
ds_read_b64_tr_b16 v[118:119], v154 offset:2432
s_waitcnt lgkmcnt(4)
v_mfma_f32_32x32x16_bf16 v[16:31], v[104:107], v[128:131], v[48:63]
v_exp_f32 v0, v0
v_exp_f32 v1, v1
v_exp_f32 v2, v2
v_exp_f32 v3, v3
v_mfma_f32_32x32x16_bf16 v[16:31], v[108:111], v[132:135], v[16:31]
ds_read_b128 v[96:99], v152 offset:3072
ds_read_b128 v[100:103], v153 offset:3072
v_exp_f32 v4, v4
v_cvt_pk_bf16_f32 v32, v0, v1
v_exp_f32 v5, v5
v_cvt_pk_bf16_f32 v33, v2, v3
buffer_load_dwordx4 a[48:51], v226, s[36:39], s79 offen offset:2048 sc1
v_exp_f32 v6, v6
v_exp_f32 v7, v7
v_cvt_pk_bf16_f32 v34, v4, v5
v_exp_f32 v8, v8
v_cvt_pk_bf16_f32 v35, v6, v7
v_exp_f32 v9, v9
s_waitcnt lgkmcnt(2)
v_mfma_f32_32x32x16_bf16 v[64:79], v[112:115], v[32:35], v[64:79]
buffer_load_dwordx4 a[52:55], v226, s[36:39], s79 offen offset:3072 sc1
v_exp_f32 v10, v10
v_exp_f32 v11, v11
v_cvt_pk_bf16_f32 v36, v8, v9
v_exp_f32 v12, v12
v_exp_f32 v13, v13
v_cvt_pk_bf16_f32 v37, v10, v11
buffer_load_dwordx4 a[56:59], v231, s[36:39], s79 offen sc1
v_exp_f32 v14, v14
v_exp_f32 v15, v15
v_cvt_pk_bf16_f32 v38, v12, v13
v_cvt_pk_bf16_f32 v39, v14, v15
s_nop 1
v_mfma_f32_32x32x16_bf16 v[64:79], v[116:119], v[36:39], v[64:79]
ds_read_b64_tr_b16 v[120:121], v154 offset:2560
ds_read_b64_tr_b16 v[122:123], v154 offset:2688
ds_read_b64_tr_b16 v[124:125], v154 offset:2816
ds_read_b64_tr_b16 v[126:127], v154 offset:2944
s_waitcnt lgkmcnt(4)
v_mfma_f32_32x32x16_bf16 v[0:15], v[96:99], v[128:131], v[48:63]
s_getpc_b64 s[72:73]
L_pc_14:
s_lshr_b32 s70, s2, 3
s_lshl_b32 s70, s70, 2
s_add_u32 s70, s70, s3
s_lshl_b32 s70, s70, 7
s_add_u32 s70, s70, 4096
v_and_b32 v253, 1, v224
v_lshlrev_b32 v253, 14, v253
v_add_u32 v253, s70, v253
v_min_u32 v253, L_end_of_code-L_pc_14-4, v253
global_load_dword a255, v253, s[72:73]
v_exp_f32 v16, v16
v_exp_f32 v17, v17
v_exp_f32 v18, v18
v_exp_f32 v19, v19
v_mfma_f32_32x32x16_bf16 v[0:15], v[100:103], v[132:135], v[0:15]
ds_read_b128 v[104:107], v152 offset:3584
ds_read_b128 v[108:111], v153 offset:3584
v_exp_f32 v20, v20
v_cvt_pk_bf16_f32 v40, v16, v17
v_exp_f32 v21, v21
v_cvt_pk_bf16_f32 v41, v18, v19
s_add_u32 s79, s78, 35840
buffer_load_dwordx4 a[60:63], v226, s[36:39], s79 offen sc1
v_exp_f32 v22, v22
v_exp_f32 v23, v23
v_cvt_pk_bf16_f32 v42, v20, v21
v_exp_f32 v24, v24
v_cvt_pk_bf16_f32 v43, v22, v23
v_exp_f32 v25, v25
s_waitcnt lgkmcnt(2)
v_mfma_f32_32x32x16_bf16 v[64:79], v[120:123], v[40:43], v[64:79]
buffer_load_dwordx4 a[64:67], v226, s[36:39], s79 offen offset:1024 sc1
v_exp_f32 v26, v26
v_exp_f32 v27, v27
v_cvt_pk_bf16_f32 v44, v24, v25
v_exp_f32 v28, v28
v_exp_f32 v29, v29
v_cvt_pk_bf16_f32 v45, v26, v27
buffer_load_dwordx4 a[68:71], v226, s[36:39], s79 offen offset:2048 sc1
v_exp_f32 v30, v30
v_exp_f32 v31, v31
v_cvt_pk_bf16_f32 v46, v28, v29
v_cvt_pk_bf16_f32 v47, v30, v31
s_nop 1
v_mfma_f32_32x32x16_bf16 v[64:79], v[124:127], v[44:47], v[64:79]
ds_read_b64_tr_b16 v[112:113], v154 offset:3072
ds_read_b64_tr_b16 v[114:115], v154 offset:3200
ds_read_b64_tr_b16 v[116:117], v154 offset:3328
ds_read_b64_tr_b16 v[118:119], v154 offset:3456
s_waitcnt lgkmcnt(4)
v_mfma_f32_32x32x16_bf16 v[16:31], v[104:107], v[128:131], v[48:63]
v_exp_f32 v0, v0
v_exp_f32 v1, v1
v_exp_f32 v2, v2
v_exp_f32 v3, v3
v_mfma_f32_32x32x16_bf16 v[16:31], v[108:111], v[132:135], v[16:31]
ds_read_b128 v[96:99], v152 offset:4096
ds_read_b128 v[100:103], v153 offset:4096
v_exp_f32 v4, v4
v_cvt_pk_bf16_f32 v32, v0, v1
v_exp_f32 v5, v5
v_cvt_pk_bf16_f32 v33, v2, v3
buffer_load_dwordx4 a[72:75], v226, s[36:39], s79 offen offset:3072 sc1
v_exp_f32 v6, v6
v_exp_f32 v7, v7
v_cvt_pk_bf16_f32 v34, v4, v5
v_exp_f32 v8, v8
v_cvt_pk_bf16_f32 v35, v6, v7
v_exp_f32 v9, v9
s_waitcnt lgkmcnt(2)
v_mfma_f32_32x32x16_bf16 v[64:79], v[112:115], v[32:35], v[64:79]
buffer_load_dwordx4 a[76:79], v231, s[36:39], s79 offen sc1
v_exp_f32 v10, v10
v_exp_f32 v11, v11
v_cvt_pk_bf16_f32 v36, v8, v9
v_exp_f32 v12, v12
v_exp_f32 v13, v13
v_cvt_pk_bf16_f32 v37, v10, v11
s_add_u32 s79, s78, 40960
buffer_load_dwordx4 a[80:83], v226, s[36:39], s79 offen sc1
v_exp_f32 v14, v14
v_exp_f32 v15, v15
v_cvt_pk_bf16_f32 v38, v12, v13
v_cvt_pk_bf16_f32 v39, v14, v15
s_nop 1
v_mfma_f32_32x32x16_bf16 v[64:79], v[116:119], v[36:39], v[64:79]
ds_read_b64_tr_b16 v[120:121], v154 offset:3584
ds_read_b64_tr_b16 v[122:123], v154 offset:3712
ds_read_b64_tr_b16 v[124:125], v154 offset:3840
ds_read_b64_tr_b16 v[126:127], v154 offset:3968
s_waitcnt lgkmcnt(4)
v_mfma_f32_32x32x16_bf16 v[0:15], v[96:99], v[128:131], v[48:63]
v_exp_f32 v16, v16
v_exp_f32 v17, v17
v_exp_f32 v18, v18
v_exp_f32 v19, v19
v_mfma_f32_32x32x16_bf16 v[0:15], v[100:103], v[132:135], v[0:15]
v_exp_f32 v20, v20
v_cvt_pk_bf16_f32 v40, v16, v17
v_exp_f32 v21, v21
v_cvt_pk_bf16_f32 v41, v18, v19
buffer_load_dwordx4 a[84:87], v226, s[36:39], s79 offen offset:1024 sc1
v_exp_f32 v22, v22
v_exp_f32 v23, v23
v_cvt_pk_bf16_f32 v42, v20, v21
v_exp_f32 v24, v24
v_cvt_pk_bf16_f32 v43, v22, v23
v_exp_f32 v25, v25
s_waitcnt lgkmcnt(0)
v_mfma_f32_32x32x16_bf16 v[64:79], v[120:123], v[40:43], v[64:79]
buffer_load_dwordx4 a[88:91], v226, s[36:39], s79 offen offset:2048 sc1
v_exp_f32 v26, v26
v_exp_f32 v27, v27
v_cvt_pk_bf16_f32 v44, v24, v25
v_exp_f32 v28, v28
v_exp_f32 v29, v29
v_cvt_pk_bf16_f32 v45, v26, v27
buffer_load_dwordx4 a[92:95], v226, s[36:39], s79 offen offset:3072 sc1
v_exp_f32 v30, v30
v_exp_f32 v31, v31
v_cvt_pk_bf16_f32 v46, v28, v29
v_cvt_pk_bf16_f32 v47, v30, v31
s_nop 1
v_mfma_f32_32x32x16_bf16 v[64:79], v[124:127], v[44:47], v[64:79]
ds_read_b64_tr_b16 v[112:113], v154 offset:4096
ds_read_b64_tr_b16 v[114:115], v154 offset:4224
ds_read_b64_tr_b16 v[116:117], v154 offset:4352
ds_read_b64_tr_b16 v[118:119], v154 offset:4480
v_exp_f32 v0, v0
v_exp_f32 v1, v1
v_exp_f32 v2, v2
v_exp_f32 v3, v3
v_exp_f32 v4, v4
v_cvt_pk_bf16_f32 v32, v0, v1
v_exp_f32 v5, v5
v_cvt_pk_bf16_f32 v33, v2, v3
buffer_load_dwordx4 a[96:99], v231, s[36:39], s79 offen sc1
v_exp_f32 v6, v6
v_exp_f32 v7, v7
v_bfi_b32 v32, v144, 0, v32
v_bfi_b32 v33, v145, 0, v33
v_cvt_pk_bf16_f32 v34, v4, v5
v_exp_f32 v8, v8
v_cvt_pk_bf16_f32 v35, v6, v7
v_exp_f32 v9, v9
v_bfi_b32 v34, v146, 0, v34
v_bfi_b32 v35, v147, 0, v35
s_waitcnt lgkmcnt(0)
s_nop 0
v_mfma_f32_32x32x16_bf16 v[64:79], v[112:115], v[32:35], v[64:79]
s_add_u32 s79, s78, 46080
buffer_load_dwordx4 a[100:103], v226, s[36:39], s79 offen sc1
v_exp_f32 v10, v10
v_exp_f32 v11, v11
v_cvt_pk_bf16_f32 v36, v8, v9
v_exp_f32 v12, v12
v_exp_f32 v13, v13
v_cvt_pk_bf16_f32 v37, v10, v11
buffer_load_dwordx4 a[104:107], v226, s[36:39], s79 offen offset:1024 sc1
v_exp_f32 v14, v14
v_exp_f32 v15, v15
v_cvt_pk_bf16_f32 v38, v12, v13
v_bfi_b32 v36, v148, 0, v36
v_bfi_b32 v37, v149, 0, v37
v_cvt_pk_bf16_f32 v39, v14, v15
v_bfi_b32 v38, v150, 0, v38
v_bfi_b32 v39, v151, 0, v39
s_nop 1
v_mfma_f32_32x32x16_bf16 v[64:79], v[116:119], v[36:39], v[64:79]
s_nop 7
s_nop 3
v_cmp_nle_f32 vcc, v76, v158
v_cmp_nge_f32 s[72:73], v76, v159
s_nop 3
s_or_b64 vcc, vcc, s[72:73]
s_and_b64 vcc, vcc, exec
s_cbranch_scc0 L_adn_19
s_cmp_lg_u32 s69, 0
s_cbranch_scc1 L_adn_19
s_mov_b32 s69, 1
v_mov_b32 v142, 0xff7fffff
ds_read_b128 v[96:99], v152 offset:0
ds_read_b128 v[100:103], v153 offset:0
s_waitcnt lgkmcnt(0)
v_mfma_f32_32x32x16_bf16 v[0:15], v[96:99], v[128:131], 0
v_mfma_f32_32x32x16_bf16 v[0:15], v[100:103], v[132:135], v[0:15]
s_nop 7
s_nop 3
v_cmp_gt_i32 vcc, 0, v156
s_nop 1
v_cndmask_b32 v143, v142, v0, vcc
v_max_f32 v142, v142, v143
v_cmp_gt_i32 vcc, 1, v156
s_nop 1
v_cndmask_b32 v143, v142, v1, vcc
v_max_f32 v142, v142, v143
v_cmp_gt_i32 vcc, 2, v156
s_nop 1
v_cndmask_b32 v143, v142, v2, vcc
v_max_f32 v142, v142, v143
v_cmp_gt_i32 vcc, 3, v156
s_nop 1
v_cndmask_b32 v143, v142, v3, vcc
v_max_f32 v142, v142, v143
v_cmp_gt_i32 vcc, 8, v156
s_nop 1
v_cndmask_b32 v143, v142, v4, vcc
v_max_f32 v142, v142, v143
v_cmp_gt_i32 vcc, 9, v156
s_nop 1
v_cndmask_b32 v143, v142, v5, vcc
v_max_f32 v142, v142, v143
v_cmp_gt_i32 vcc, 10, v156
s_nop 1
v_cndmask_b32 v143, v142, v6, vcc
v_max_f32 v142, v142, v143
v_cmp_gt_i32 vcc, 11, v156
s_nop 1
v_cndmask_b32 v143, v142, v7, vcc
v_max_f32 v142, v142, v143
v_cmp_gt_i32 vcc, 16, v156
s_nop 1
v_cndmask_b32 v143, v142, v8, vcc
v_max_f32 v142, v142, v143
v_cmp_gt_i32 vcc, 17, v156
s_nop 1
v_cndmask_b32 v143, v142, v9, vcc
v_max_f32 v142, v142, v143
v_cmp_gt_i32 vcc, 18, v156
s_nop 1
v_cndmask_b32 v143, v142, v10, vcc
v_max_f32 v142, v142, v143
v_cmp_gt_i32 vcc, 19, v156
s_nop 1
v_cndmask_b32 v143, v142, v11, vcc
v_max_f32 v142, v142, v143
v_cmp_gt_i32 vcc, 24, v156
s_nop 1
v_cndmask_b32 v143, v142, v12, vcc
v_max_f32 v142, v142, v143
v_cmp_gt_i32 vcc, 25, v156
s_nop 1
v_cndmask_b32 v143, v142, v13, vcc
v_max_f32 v142, v142, v143
v_cmp_gt_i32 vcc, 26, v156
s_nop 1
v_cndmask_b32 v143, v142, v14, vcc
v_max_f32 v142, v142, v143
v_cmp_gt_i32 vcc, 27, v156
s_nop 1
v_cndmask_b32 v143, v142, v15, vcc
v_max_f32 v142, v142, v143
ds_read_b128 v[104:107], v152 offset:512
ds_read_b128 v[108:111], v153 offset:512
s_waitcnt lgkmcnt(0)
v_mfma_f32_32x32x16_bf16 v[16:31], v[104:107], v[128:131], 0
v_mfma_f32_32x32x16_bf16 v[16:31], v[108:111], v[132:135], v[16:31]
s_nop 7
s_nop 3
v_max_f32 v142, v142, v16
v_max_f32 v142, v142, v17
v_max_f32 v142, v142, v18
v_max_f32 v142, v142, v19
v_max_f32 v142, v142, v20
v_max_f32 v142, v142, v21
v_max_f32 v142, v142, v22
v_max_f32 v142, v142, v23
v_max_f32 v142, v142, v24
v_max_f32 v142, v142, v25
v_max_f32 v142, v142, v26
v_max_f32 v142, v142, v27
v_max_f32 v142, v142, v28
v_max_f32 v142, v142, v29
v_max_f32 v142, v142, v30
v_max_f32 v142, v142, v31
ds_read_b128 v[96:99], v152 offset:1024
ds_read_b128 v[100:103], v153 offset:1024
s_waitcnt lgkmcnt(0)
v_mfma_f32_32x32x16_bf16 v[0:15], v[96:99], v[128:131], 0
v_mfma_f32_32x32x16_bf16 v[0:15], v[100:103], v[132:135], v[0:15]
s_nop 7
s_nop 3
v_max_f32 v142, v142, v0
v_max_f32 v142, v142, v1
v_max_f32 v142, v142, v2
v_max_f32 v142, v142, v3
v_max_f32 v142, v142, v4
v_max_f32 v142, v142, v5
v_max_f32 v142, v142, v6
v_max_f32 v142, v142, v7
v_max_f32 v142, v142, v8
v_max_f32 v142, v142, v9
v_max_f32 v142, v142, v10
v_max_f32 v142, v142, v11
v_max_f32 v142, v142, v12
v_max_f32 v142, v142, v13
v_max_f32 v142, v142, v14
v_max_f32 v142, v142, v15
ds_read_b128 v[104:107], v152 offset:1536
ds_read_b128 v[108:111], v153 offset:1536
s_waitcnt lgkmcnt(0)
v_mfma_f32_32x32x16_bf16 v[16:31], v[104:107], v[128:131], 0
v_mfma_f32_32x32x16_bf16 v[16:31], v[108:111], v[132:135], v[16:31]
s_nop 7
s_nop 3
v_max_f32 v142, v142, v16
v_max_f32 v142, v142, v17
v_max_f32 v142, v142, v18
v_max_f32 v142, v142, v19
v_max_f32 v142, v142, v20
v_max_f32 v142, v142, v21
v_max_f32 v142, v142, v22
v_max_f32 v142, v142, v23
v_max_f32 v142, v142, v24
v_max_f32 v142, v142, v25
v_max_f32 v142, v142, v26
v_max_f32 v142, v142, v27
v_max_f32 v142, v142, v28
v_max_f32 v142, v142, v29
v_max_f32 v142, v142, v30
v_max_f32 v142, v142, v31
ds_read_b128 v[96:99], v152 offset:2048
ds_read_b128 v[100:103], v153 offset:2048
s_waitcnt lgkmcnt(0)
v_mfma_f32_32x32x16_bf16 v[0:15], v[96:99], v[128:131], 0
v_mfma_f32_32x32x16_bf16 v[0:15], v[100:103], v[132:135], v[0:15]
s_nop 7
s_nop 3
v_max_f32 v142, v142, v0
v_max_f32 v142, v142, v1
v_max_f32 v142, v142, v2
v_max_f32 v142, v142, v3
v_max_f32 v142, v142, v4
v_max_f32 v142, v142, v5
v_max_f32 v142, v142, v6
v_max_f32 v142, v142, v7
v_max_f32 v142, v142, v8
v_max_f32 v142, v142, v9
v_max_f32 v142, v142, v10
v_max_f32 v142, v142, v11
v_max_f32 v142, v142, v12
v_max_f32 v142, v142, v13
v_max_f32 v142, v142, v14
v_max_f32 v142, v142, v15
ds_read_b128 v[104:107], v152 offset:2560
ds_read_b128 v[108:111], v153 offset:2560
s_waitcnt lgkmcnt(0)
v_mfma_f32_32x32x16_bf16 v[16:31], v[104:107], v[128:131], 0
v_mfma_f32_32x32x16_bf16 v[16:31], v[108:111], v[132:135], v[16:31]
s_nop 7
s_nop 3
v_max_f32 v142, v142, v16
v_max_f32 v142, v142, v17
v_max_f32 v142, v142, v18
v_max_f32 v142, v142, v19
v_max_f32 v142, v142, v20
v_max_f32 v142, v142, v21
v_max_f32 v142, v142, v22
v_max_f32 v142, v142, v23
v_max_f32 v142, v142, v24
v_max_f32 v142, v142, v25
v_max_f32 v142, v142, v26
v_max_f32 v142, v142, v27
v_max_f32 v142, v142, v28
v_max_f32 v142, v142, v29
v_max_f32 v142, v142, v30
v_max_f32 v142, v142, v31
ds_read_b128 v[96:99], v152 offset:3072
ds_read_b128 v[100:103], v153 offset:3072
s_waitcnt lgkmcnt(0)
v_mfma_f32_32x32x16_bf16 v[0:15], v[96:99], v[128:131], 0
v_mfma_f32_32x32x16_bf16 v[0:15], v[100:103], v[132:135], v[0:15]
s_nop 7
s_nop 3
v_max_f32 v142, v142, v0
v_max_f32 v142, v142, v1
v_max_f32 v142, v142, v2
v_max_f32 v142, v142, v3
v_max_f32 v142, v142, v4
v_max_f32 v142, v142, v5
v_max_f32 v142, v142, v6
v_max_f32 v142, v142, v7
v_max_f32 v142, v142, v8
v_max_f32 v142, v142, v9
v_max_f32 v142, v142, v10
v_max_f32 v142, v142, v11
v_max_f32 v142, v142, v12
v_max_f32 v142, v142, v13
v_max_f32 v142, v142, v14
v_max_f32 v142, v142, v15
ds_read_b128 v[104:107], v152 offset:3584
ds_read_b128 v[108:111], v153 offset:3584
s_waitcnt lgkmcnt(0)
v_mfma_f32_32x32x16_bf16 v[16:31], v[104:107], v[128:131], 0
v_mfma_f32_32x32x16_bf16 v[16:31], v[108:111], v[132:135], v[16:31]
s_nop 7
s_nop 3
v_max_f32 v142, v142, v16
v_max_f32 v142, v142, v17
v_max_f32 v142, v142, v18
v_max_f32 v142, v142, v19
v_max_f32 v142, v142, v20
v_max_f32 v142, v142, v21
v_max_f32 v142, v142, v22
v_max_f32 v142, v142, v23
v_max_f32 v142, v142, v24
v_max_f32 v142, v142, v25
v_max_f32 v142, v142, v26
v_max_f32 v142, v142, v27
v_max_f32 v142, v142, v28
v_max_f32 v142, v142, v29
v_max_f32 v142, v142, v30
v_max_f32 v142, v142, v31
ds_read_b128 v[96:99], v152 offset:4096
ds_read_b128 v[100:103], v153 offset:4096
s_waitcnt lgkmcnt(0)
v_mfma_f32_32x32x16_bf16 v[0:15], v[96:99], v[128:131], 0
v_mfma_f32_32x32x16_bf16 v[0:15], v[100:103], v[132:135], v[0:15]
s_nop 7
s_nop 3
v_cmp_gt_i32 vcc, 0, v156
s_nop 1
v_cndmask_b32 v143, v0, v142, vcc
v_max_f32 v142, v142, v143
v_cmp_gt_i32 vcc, 1, v156
s_nop 1
v_cndmask_b32 v143, v1, v142, vcc
v_max_f32 v142, v142, v143
v_cmp_gt_i32 vcc, 2, v156
s_nop 1
v_cndmask_b32 v143, v2, v142, vcc
v_max_f32 v142, v142, v143
v_cmp_gt_i32 vcc, 3, v156
s_nop 1
v_cndmask_b32 v143, v3, v142, vcc
v_max_f32 v142, v142, v143
v_cmp_gt_i32 vcc, 8, v156
s_nop 1
v_cndmask_b32 v143, v4, v142, vcc
v_max_f32 v142, v142, v143
v_cmp_gt_i32 vcc, 9, v156
s_nop 1
v_cndmask_b32 v143, v5, v142, vcc
v_max_f32 v142, v142, v143
v_cmp_gt_i32 vcc, 10, v156
s_nop 1
v_cndmask_b32 v143, v6, v142, vcc
v_max_f32 v142, v142, v143
v_cmp_gt_i32 vcc, 11, v156
s_nop 1
v_cndmask_b32 v143, v7, v142, vcc
v_max_f32 v142, v142, v143
v_cmp_gt_i32 vcc, 16, v156
s_nop 1
v_cndmask_b32 v143, v8, v142, vcc
v_max_f32 v142, v142, v143
v_cmp_gt_i32 vcc, 17, v156
s_nop 1
v_cndmask_b32 v143, v9, v142, vcc
v_max_f32 v142, v142, v143
v_cmp_gt_i32 vcc, 18, v156
s_nop 1
v_cndmask_b32 v143, v10, v142, vcc
v_max_f32 v142, v142, v143
v_cmp_gt_i32 vcc, 19, v156
s_nop 1
v_cndmask_b32 v143, v11, v142, vcc
v_max_f32 v142, v142, v143
v_cmp_gt_i32 vcc, 24, v156
s_nop 1
v_cndmask_b32 v143, v12, v142, vcc
v_max_f32 v142, v142, v143
v_cmp_gt_i32 vcc, 25, v156
s_nop 1
v_cndmask_b32 v143, v13, v142, vcc
v_max_f32 v142, v142, v143
v_cmp_gt_i32 vcc, 26, v156
s_nop 1
v_cndmask_b32 v143, v14, v142, vcc
v_max_f32 v142, v142, v143
v_cmp_gt_i32 vcc, 27, v156
s_nop 1
v_cndmask_b32 v143, v15, v142, vcc
v_max_f32 v142, v142, v143
v_mov_b32 v143, v142
s_nop 1
v_permlane32_swap_b32 v143, v142
s_nop 0
v_max_f32 v142, v142, v143
v_sub_f32 v48, 0, v142
v_sub_f32 v49, 0, v142
v_sub_f32 v50, 0, v142
v_sub_f32 v51, 0, v142
v_sub_f32 v52, 0, v142
v_sub_f32 v53, 0, v142
v_sub_f32 v54, 0, v142
v_sub_f32 v55, 0, v142
v_sub_f32 v56, 0, v142
v_sub_f32 v57, 0, v142
v_sub_f32 v58, 0, v142
v_sub_f32 v59, 0, v142
v_sub_f32 v60, 0, v142
v_sub_f32 v61, 0, v142
v_sub_f32 v62, 0, v142
v_sub_f32 v63, 0, v142
s_branch L_are_17
L_adn_19:
v_rcp_f32 v142, v76
s_nop 0
v_mul_f32 v64, v64, v142
v_mul_f32 v65, v65, v142
v_mul_f32 v66, v66, v142
v_mul_f32 v67, v67, v142
v_mul_f32 v68, v68, v142
v_mul_f32 v69, v69, v142
v_mul_f32 v70, v70, v142
v_mul_f32 v71, v71, v142
v_mul_f32 v72, v72, v142
v_mul_f32 v73, v73, v142
v_mul_f32 v74, v74, v142
v_mul_f32 v75, v75, v142
v_mov_b32 v48, 0
v_mov_b32 v49, 0
v_mov_b32 v50, 0
v_mov_b32 v51, 0
v_mov_b32 v52, 0
v_mov_b32 v53, 0
v_mov_b32 v54, 0
v_mov_b32 v55, 0
v_mov_b32 v56, 0
v_mov_b32 v57, 0
v_mov_b32 v58, 0
v_mov_b32 v59, 0
v_mov_b32 v60, 0
v_mov_b32 v61, 0
v_mov_b32 v62, 0
v_mov_b32 v63, 0
s_mov_b32 s69, 0
L_are_20:
s_add_u32 s79, s78, 46080
ds_read_b128 v[96:99], v152 offset:18624
ds_read_b128 v[100:103], v153 offset:0
s_waitcnt lgkmcnt(0)
v_mfma_f32_32x32x16_bf16 v[0:15], v[96:99], v[138:141], v[48:63]
v_mfma_f32_32x32x16_bf16 v[0:15], v[100:103], v[134:137], v[0:15]
ds_read_b128 v[104:107], v152 offset:19136
ds_read_b128 v[108:111], v153 offset:512
ds_read_b64_tr_b16 v[112:113], v155 offset:0
ds_read_b64_tr_b16 v[114:115], v155 offset:128
ds_read_b64_tr_b16 v[116:117], v155 offset:256
ds_read_b64_tr_b16 v[118:119], v155 offset:384
s_waitcnt lgkmcnt(4)
v_mfma_f32_32x32x16_bf16 v[16:31], v[104:107], v[138:141], v[48:63]
s_nop 3
v_exp_f32 v0, v0
v_exp_f32 v1, v1
v_exp_f32 v2, v2
v_exp_f32 v3, v3
v_mfma_f32_32x32x16_bf16 v[16:31], v[108:111], v[134:137], v[16:31]
ds_read_b128 v[96:99], v152 offset:19648
ds_read_b128 v[100:103], v153 offset:1024
v_exp_f32 v4, v4
v_cvt_pk_bf16_f32 v32, v0, v1
v_exp_f32 v5, v5
v_cvt_pk_bf16_f32 v33, v2, v3
buffer_load_dwordx4 a[108:111], v226, s[36:39], s79 offen offset:2048 sc1
v_exp_f32 v6, v6
v_exp_f32 v7, v7
v_and_b32 v32, v144, v32
v_and_b32 v33, v145, v33
v_cvt_pk_bf16_f32 v34, v4, v5
v_exp_f32 v8, v8
v_cvt_pk_bf16_f32 v35, v6, v7
v_exp_f32 v9, v9
v_and_b32 v34, v146, v34
v_and_b32 v35, v147, v35
s_waitcnt lgkmcnt(2)
s_nop 0
v_mfma_f32_32x32x16_bf16 v[80:95], v[112:115], v[32:35], 0
buffer_load_dwordx4 a[112:115], v226, s[36:39], s79 offen offset:3072 sc1
v_exp_f32 v10, v10
v_exp_f32 v11, v11
v_cvt_pk_bf16_f32 v36, v8, v9
v_exp_f32 v12, v12
v_exp_f32 v13, v13
v_cvt_pk_bf16_f32 v37, v10, v11
buffer_load_dwordx4 a[116:119], v231, s[36:39], s79 offen sc1
v_exp_f32 v14, v14
v_exp_f32 v15, v15
v_cvt_pk_bf16_f32 v38, v12, v13
v_and_b32 v36, v148, v36
v_and_b32 v37, v149, v37
v_cvt_pk_bf16_f32 v39, v14, v15
v_and_b32 v38, v150, v38
v_and_b32 v39, v151, v39
s_nop 1
v_mfma_f32_32x32x16_bf16 v[80:95], v[116:119], v[36:39], v[80:95]
ds_read_b64_tr_b16 v[120:121], v155 offset:512
ds_read_b64_tr_b16 v[122:123], v155 offset:640
ds_read_b64_tr_b16 v[124:125], v155 offset:768
ds_read_b64_tr_b16 v[126:127], v155 offset:896
s_waitcnt lgkmcnt(4)
v_mfma_f32_32x32x16_bf16 v[0:15], v[96:99], v[138:141], v[48:63]
v_exp_f32 v16, v16
v_exp_f32 v17, v17
v_exp_f32 v18, v18
v_exp_f32 v19, v19
v_mfma_f32_32x32x16_bf16 v[0:15], v[100:103], v[134:137], v[0:15]
ds_read_b128 v[104:107], v152 offset:20160
ds_read_b128 v[108:111], v153 offset:1536
v_exp_f32 v20, v20
v_cvt_pk_bf16_f32 v40, v16, v17
v_exp_f32 v21, v21
v_cvt_pk_bf16_f32 v41, v18, v19
s_add_u32 s79, s78, 51200
buffer_load_dwordx4 a[120:123], v226, s[36:39], s79 offen sc1
v_exp_f32 v22, v22
v_exp_f32 v23, v23
v_cvt_pk_bf16_f32 v42, v20, v21
v_exp_f32 v24, v24
v_cvt_pk_bf16_f32 v43, v22, v23
v_exp_f32 v25, v25
s_waitcnt lgkmcnt(2)
v_mfma_f32_32x32x16_bf16 v[80:95], v[120:123], v[40:43], v[80:95]
buffer_load_dwordx4 a[124:127], v226, s[36:39], s79 offen offset:1024 sc1
v_exp_f32 v26, v26
v_exp_f32 v27, v27
v_cvt_pk_bf16_f32 v44, v24, v25
v_exp_f32 v28, v28
v_exp_f32 v29, v29
v_cvt_pk_bf16_f32 v45, v26, v27
buffer_load_dwordx4 a[128:131], v226, s[36:39], s79 offen offset:2048 sc1
v_exp_f32 v30, v30
v_exp_f32 v31, v31
v_cvt_pk_bf16_f32 v46, v28, v29
v_cvt_pk_bf16_f32 v47, v30, v31
s_nop 1
v_mfma_f32_32x32x16_bf16 v[80:95], v[124:127], v[44:47], v[80:95]
ds_read_b64_tr_b16 v[112:113], v155 offset:1024
ds_read_b64_tr_b16 v[114:115], v155 offset:1152
ds_read_b64_tr_b16 v[116:117], v155 offset:1280
ds_read_b64_tr_b16 v[118:119], v155 offset:1408
s_waitcnt lgkmcnt(4)
v_mfma_f32_32x32x16_bf16 v[16:31], v[104:107], v[138:141], v[48:63]
v_exp_f32 v0, v0
v_exp_f32 v1, v1
v_exp_f32 v2, v2
v_exp_f32 v3, v3
v_mfma_f32_32x32x16_bf16 v[16:31], v[108:111], v[134:137], v[16:31]
ds_read_b128 v[96:99], v152 offset:20672
ds_read_b128 v[100:103], v153 offset:2048
v_exp_f32 v4, v4
v_cvt_pk_bf16_f32 v32, v0, v1
v_exp_f32 v5, v5
v_cvt_pk_bf16_f32 v33, v2, v3
buffer_load_dwordx4 a[132:135], v226, s[36:39], s79 offen offset:3072 sc1
v_exp_f32 v6, v6
v_exp_f32 v7, v7
v_cvt_pk_bf16_f32 v34, v4, v5
v_exp_f32 v8, v8
v_cvt_pk_bf16_f32 v35, v6, v7
v_exp_f32 v9, v9
s_waitcnt lgkmcnt(2)
v_mfma_f32_32x32x16_bf16 v[80:95], v[112:115], v[32:35], v[80:95]
buffer_load_dwordx4 a[136:139], v231, s[36:39], s79 offen sc1
v_exp_f32 v10, v10
v_exp_f32 v11, v11
v_cvt_pk_bf16_f32 v36, v8, v9
v_exp_f32 v12, v12
v_exp_f32 v13, v13
v_cvt_pk_bf16_f32 v37, v10, v11
s_add_u32 s79, s78, 56320
buffer_load_dwordx4 a[140:143], v226, s[36:39], s79 offen sc1
v_exp_f32 v14, v14
v_exp_f32 v15, v15
v_cvt_pk_bf16_f32 v38, v12, v13
v_cvt_pk_bf16_f32 v39, v14, v15
s_nop 1
v_mfma_f32_32x32x16_bf16 v[80:95], v[116:119], v[36:39], v[80:95]
ds_read_b64_tr_b16 v[120:121], v155 offset:1536
ds_read_b64_tr_b16 v[122:123], v155 offset:1664
ds_read_b64_tr_b16 v[124:125], v155 offset:1792
ds_read_b64_tr_b16 v[126:127], v155 offset:1920
s_waitcnt lgkmcnt(4)
v_mfma_f32_32x32x16_bf16 v[0:15], v[96:99], v[138:141], v[48:63]
v_exp_f32 v16, v16
v_exp_f32 v17, v17
v_exp_f32 v18, v18
v_exp_f32 v19, v19
v_mfma_f32_32x32x16_bf16 v[0:15], v[100:103], v[134:137], v[0:15]
ds_read_b128 v[104:107], v152 offset:21184
ds_read_b128 v[108:111], v153 offset:2560
v_exp_f32 v20, v20
v_cvt_pk_bf16_f32 v40, v16, v17
v_exp_f32 v21, v21
v_cvt_pk_bf16_f32 v41, v18, v19
buffer_load_dwordx4 a[144:147], v226, s[36:39], s79 offen offset:1024 sc1
v_exp_f32 v22, v22
v_exp_f32 v23, v23
v_cvt_pk_bf16_f32 v42, v20, v21
v_exp_f32 v24, v24
v_cvt_pk_bf16_f32 v43, v22, v23
v_exp_f32 v25, v25
s_waitcnt lgkmcnt(2)
v_mfma_f32_32x32x16_bf16 v[80:95], v[120:123], v[40:43], v[80:95]
buffer_load_dwordx4 a[148:151], v226, s[36:39], s79 offen offset:2048 sc1
v_exp_f32 v26, v26
v_exp_f32 v27, v27
v_cvt_pk_bf16_f32 v44, v24, v25
v_exp_f32 v28, v28
v_exp_f32 v29, v29
v_cvt_pk_bf16_f32 v45, v26, v27
buffer_load_dwordx4 a[152:155], v226, s[36:39], s79 offen offset:3072 sc1
v_exp_f32 v30, v30
v_exp_f32 v31, v31
v_cvt_pk_bf16_f32 v46, v28, v29
v_cvt_pk_bf16_f32 v47, v30, v31
s_nop 1
v_mfma_f32_32x32x16_bf16 v[80:95], v[124:127], v[44:47], v[80:95]
ds_read_b64_tr_b16 v[112:113], v155 offset:2048
ds_read_b64_tr_b16 v[114:115], v155 offset:2176
ds_read_b64_tr_b16 v[116:117], v155 offset:2304
ds_read_b64_tr_b16 v[118:119], v155 offset:2432
s_waitcnt lgkmcnt(4)
v_mfma_f32_32x32x16_bf16 v[16:31], v[104:107], v[138:141], v[48:63]
s_and_b32 s72, s7, 1
s_cmp_eq_u32 s72, 0
s_mov_b32 s76, 0xcccccccc
s_cselect_b32 s76, 0x33333333, s76
s_mov_b32 s77, s76
s_lshr_b32 s72, s7, 1
s_lshl_b32 s72, s72, 8
s_add_u32 s75, s72, 20598912
v_lshlrev_b32 v245, 2, v224
buffer_load_dword v244, v245, s[36:39], s75 offen sc1
v_exp_f32 v0, v0
v_exp_f32 v1, v1
v_exp_f32 v2, v2
v_exp_f32 v3, v3
v_mfma_f32_32x32x16_bf16 v[16:31], v[108:111], v[134:137], v[16:31]
ds_read_b128 v[96:99], v152 offset:21696
ds_read_b128 v[100:103], v153 offset:3072
v_exp_f32 v4, v4
v_cvt_pk_bf16_f32 v32, v0, v1
v_exp_f32 v5, v5
v_cvt_pk_bf16_f32 v33, v2, v3
buffer_load_dwordx4 a[156:159], v231, s[36:39], s79 offen sc1
v_exp_f32 v6, v6
v_exp_f32 v7, v7
v_cvt_pk_bf16_f32 v34, v4, v5
v_exp_f32 v8, v8
v_cvt_pk_bf16_f32 v35, v6, v7
v_exp_f32 v9, v9
s_waitcnt lgkmcnt(2)
v_mfma_f32_32x32x16_bf16 v[80:95], v[112:115], v[32:35], v[80:95]
v_exp_f32 v10, v10
v_exp_f32 v11, v11
v_cvt_pk_bf16_f32 v36, v8, v9
v_exp_f32 v12, v12
v_exp_f32 v13, v13
v_cvt_pk_bf16_f32 v37, v10, v11
v_exp_f32 v14, v14
v_exp_f32 v15, v15
v_cvt_pk_bf16_f32 v38, v12, v13
v_cvt_pk_bf16_f32 v39, v14, v15
s_nop 1
v_mfma_f32_32x32x16_bf16 v[80:95], v[116:119], v[36:39], v[80:95]
ds_read_b64_tr_b16 v[120:121], v155 offset:2560
ds_read_b64_tr_b16 v[122:123], v155 offset:2688
ds_read_b64_tr_b16 v[124:125], v155 offset:2816
ds_read_b64_tr_b16 v[126:127], v155 offset:2944
s_waitcnt lgkmcnt(4)
v_mfma_f32_32x32x16_bf16 v[0:15], v[96:99], v[138:141], v[48:63]
v_exp_f32 v16, v16
v_exp_f32 v17, v17
v_exp_f32 v18, v18
v_exp_f32 v19, v19
v_mfma_f32_32x32x16_bf16 v[0:15], v[100:103], v[134:137], v[0:15]
ds_read_b128 v[104:107], v152 offset:22208
ds_read_b128 v[108:111], v153 offset:3584
v_exp_f32 v20, v20
v_cvt_pk_bf16_f32 v40, v16, v17
v_exp_f32 v21, v21
v_cvt_pk_bf16_f32 v41, v18, v19
v_exp_f32 v22, v22
v_exp_f32 v23, v23
v_cvt_pk_bf16_f32 v42, v20, v21
v_exp_f32 v24, v24
v_cvt_pk_bf16_f32 v43, v22, v23
v_exp_f32 v25, v25
s_waitcnt lgkmcnt(2)
v_mfma_f32_32x32x16_bf16 v[80:95], v[120:123], v[40:43], v[80:95]
v_exp_f32 v26, v26
v_exp_f32 v27, v27
v_cvt_pk_bf16_f32 v44, v24, v25
v_exp_f32 v28, v28
v_exp_f32 v29, v29
v_cvt_pk_bf16_f32 v45, v26, v27
v_exp_f32 v30, v30
v_exp_f32 v31, v31
v_cvt_pk_bf16_f32 v46, v28, v29
v_cvt_pk_bf16_f32 v47, v30, v31
s_nop 1
v_mfma_f32_32x32x16_bf16 v[80:95], v[124:127], v[44:47], v[80:95]
ds_read_b64_tr_b16 v[112:113], v155 offset:3072
ds_read_b64_tr_b16 v[114:115], v155 offset:3200
ds_read_b64_tr_b16 v[116:117], v155 offset:3328
ds_read_b64_tr_b16 v[118:119], v155 offset:3456
s_waitcnt lgkmcnt(4)
v_mfma_f32_32x32x16_bf16 v[16:31], v[104:107], v[138:141], v[48:63]
s_waitcnt vmcnt(1)
s_mov_b32 s70, 0
L_wq_15:
v_cmp_ne_u32 vcc, s4, v244
s_nop 3
s_and_b64 vcc, vcc, s[76:77]
s_cbranch_scc0 L_wd_16
s_add_u32 s70, s70, 1
s_cmp_ge_u32 s70, 200000
s_cbranch_scc1 L_wd_16
s_sleep 1
buffer_load_dword v244, v245, s[36:39], s75 offen sc1
s_waitcnt vmcnt(0)
s_branch L_wq_15
L_wd_16:
v_exp_f32 v0, v0
v_exp_f32 v1, v1
v_exp_f32 v2, v2
v_exp_f32 v3, v3
v_mfma_f32_32x32x16_bf16 v[16:31], v[108:111], v[134:137], v[16:31]
ds_read_b128 v[96:99], v152 offset:22720
ds_read_b128 v[100:103], v153 offset:4096
v_exp_f32 v4, v4
v_cvt_pk_bf16_f32 v32, v0, v1
v_exp_f32 v5, v5
v_cvt_pk_bf16_f32 v33, v2, v3
s_add_u32 s71, s10, 0
buffer_load_dwordx4 v[160:163], v228, s[36:39], s71 offen sc1
v_exp_f32 v6, v6
v_exp_f32 v7, v7
v_cvt_pk_bf16_f32 v34, v4, v5
v_exp_f32 v8, v8
v_cvt_pk_bf16_f32 v35, v6, v7
v_exp_f32 v9, v9
s_waitcnt lgkmcnt(2)
v_mfma_f32_32x32x16_bf16 v[80:95], v[112:115], v[32:35], v[80:95]
buffer_load_dwordx4 v[164:167], v229, s[36:39], s71 offen sc1
v_exp_f32 v10, v10
v_exp_f32 v11, v11
v_cvt_pk_bf16_f32 v36, v8, v9
v_exp_f32 v12, v12
v_exp_f32 v13, v13
v_cvt_pk_bf16_f32 v37, v10, v11
buffer_load_dwordx4 v[168:171], v230, s[36:39], s71 offen sc1
v_exp_f32 v14, v14
v_exp_f32 v15, v15
v_cvt_pk_bf16_f32 v38, v12, v13
v_cvt_pk_bf16_f32 v39, v14, v15
buffer_load_dwordx4 v[172:175], v232, s[36:39], s71 offen sc1
s_nop 0
v_mfma_f32_32x32x16_bf16 v[80:95], v[116:119], v[36:39], v[80:95]
ds_read_b64_tr_b16 v[120:121], v155 offset:3584
ds_read_b64_tr_b16 v[122:123], v155 offset:3712
ds_read_b64_tr_b16 v[124:125], v155 offset:3840
ds_read_b64_tr_b16 v[126:127], v155 offset:3968
s_waitcnt lgkmcnt(4)
v_mfma_f32_32x32x16_bf16 v[0:15], v[96:99], v[138:141], v[48:63]
v_exp_f32 v16, v16
v_exp_f32 v17, v17
v_exp_f32 v18, v18
v_exp_f32 v19, v19
v_mfma_f32_32x32x16_bf16 v[0:15], v[100:103], v[134:137], v[0:15]
v_exp_f32 v20, v20
v_cvt_pk_bf16_f32 v40, v16, v17
v_exp_f32 v21, v21
v_cvt_pk_bf16_f32 v41, v18, v19
s_add_u32 s71, s10, 4096
buffer_load_dwordx4 v[176:179], v228, s[36:39], s71 offen sc1
v_exp_f32 v22, v22
v_exp_f32 v23, v23
v_cvt_pk_bf16_f32 v42, v20, v21
v_exp_f32 v24, v24
v_cvt_pk_bf16_f32 v43, v22, v23
v_exp_f32 v25, v25
s_waitcnt lgkmcnt(0)
v_mfma_f32_32x32x16_bf16 v[80:95], v[120:123], v[40:43], v[80:95]
buffer_load_dwordx4 v[180:183], v229, s[36:39], s71 offen sc1
v_exp_f32 v26, v26
v_exp_f32 v27, v27
v_cvt_pk_bf16_f32 v44, v24, v25
v_exp_f32 v28, v28
v_exp_f32 v29, v29
v_cvt_pk_bf16_f32 v45, v26, v27
buffer_load_dwordx4 v[184:187], v230, s[36:39], s71 offen sc1
v_exp_f32 v30, v30
v_exp_f32 v31, v31
v_cvt_pk_bf16_f32 v46, v28, v29
v_cvt_pk_bf16_f32 v47, v30, v31
buffer_load_dwordx4 v[188:191], v232, s[36:39], s71 offen sc1
s_nop 0
v_mfma_f32_32x32x16_bf16 v[80:95], v[124:127], v[44:47], v[80:95]
ds_read_b64_tr_b16 v[112:113], v155 offset:4096
ds_read_b64_tr_b16 v[114:115], v155 offset:4224
ds_read_b64_tr_b16 v[116:117], v155 offset:4352
ds_read_b64_tr_b16 v[118:119], v155 offset:4480
v_exp_f32 v0, v0
v_exp_f32 v1, v1
v_exp_f32 v2, v2
v_exp_f32 v3, v3
v_exp_f32 v4, v4
v_cvt_pk_bf16_f32 v32, v0, v1
v_exp_f32 v5, v5
v_cvt_pk_bf16_f32 v33, v2, v3
s_add_u32 s71, s10, 8192
buffer_load_dwordx4 v[192:195], v228, s[36:39], s71 offen sc1
v_exp_f32 v6, v6
v_exp_f32 v7, v7
v_bfi_b32 v32, v144, 0, v32
v_bfi_b32 v33, v145, 0, v33
v_cvt_pk_bf16_f32 v34, v4, v5
v_exp_f32 v8, v8
v_cvt_pk_bf16_f32 v35, v6, v7
v_exp_f32 v9, v9
v_bfi_b32 v34, v146, 0, v34
v_bfi_b32 v35, v147, 0, v35
s_waitcnt lgkmcnt(0)
s_nop 0
v_mfma_f32_32x32x16_bf16 v[80:95], v[112:115], v[32:35], v[80:95]
buffer_load_dwordx4 v[196:199], v229, s[36:39], s71 offen sc1
v_exp_f32 v10, v10
v_exp_f32 v11, v11
v_cvt_pk_bf16_f32 v36, v8, v9
v_exp_f32 v12, v12
v_exp_f32 v13, v13
v_cvt_pk_bf16_f32 v37, v10, v11
buffer_load_dwordx4 v[200:203], v230, s[36:39], s71 offen sc1
v_exp_f32 v14, v14
v_exp_f32 v15, v15
v_cvt_pk_bf16_f32 v38, v12, v13
v_bfi_b32 v36, v148, 0, v36
v_bfi_b32 v37, v149, 0, v37
v_cvt_pk_bf16_f32 v39, v14, v15
v_bfi_b32 v38, v150, 0, v38
v_bfi_b32 v39, v151, 0, v39
buffer_load_dwordx4 v[204:207], v232, s[36:39], s71 offen sc1
s_nop 0
v_mfma_f32_32x32x16_bf16 v[80:95], v[116:119], v[36:39], v[80:95]
s_nop 7
s_nop 3
v_cmp_nle_f32 vcc, v92, v158
v_cmp_nge_f32 s[72:73], v92, v159
s_nop 3
s_or_b64 vcc, vcc, s[72:73]
s_and_b64 vcc, vcc, exec
s_cbranch_scc0 L_adn_22
s_cmp_lg_u32 s69, 0
s_cbranch_scc1 L_adn_22
s_mov_b32 s69, 1
v_mov_b32 v142, 0xff7fffff
ds_read_b128 v[96:99], v152 offset:18624
ds_read_b128 v[100:103], v153 offset:0
s_waitcnt lgkmcnt(0)
v_mfma_f32_32x32x16_bf16 v[0:15], v[96:99], v[138:141], 0
v_mfma_f32_32x32x16_bf16 v[0:15], v[100:103], v[134:137], v[0:15]
s_nop 7
s_nop 3
v_cmp_gt_i32 vcc, 0, v156
s_nop 1
v_cndmask_b32 v143, v142, v0, vcc
v_max_f32 v142, v142, v143
v_cmp_gt_i32 vcc, 1, v156
s_nop 1
v_cndmask_b32 v143, v142, v1, vcc
v_max_f32 v142, v142, v143
v_cmp_gt_i32 vcc, 2, v156
s_nop 1
v_cndmask_b32 v143, v142, v2, vcc
v_max_f32 v142, v142, v143
v_cmp_gt_i32 vcc, 3, v156
s_nop 1
v_cndmask_b32 v143, v142, v3, vcc
v_max_f32 v142, v142, v143
v_cmp_gt_i32 vcc, 8, v156
s_nop 1
v_cndmask_b32 v143, v142, v4, vcc
v_max_f32 v142, v142, v143
v_cmp_gt_i32 vcc, 9, v156
s_nop 1
v_cndmask_b32 v143, v142, v5, vcc
v_max_f32 v142, v142, v143
v_cmp_gt_i32 vcc, 10, v156
s_nop 1
v_cndmask_b32 v143, v142, v6, vcc
v_max_f32 v142, v142, v143
v_cmp_gt_i32 vcc, 11, v156
s_nop 1
v_cndmask_b32 v143, v142, v7, vcc
v_max_f32 v142, v142, v143
v_cmp_gt_i32 vcc, 16, v156
s_nop 1
v_cndmask_b32 v143, v142, v8, vcc
v_max_f32 v142, v142, v143
v_cmp_gt_i32 vcc, 17, v156
s_nop 1
v_cndmask_b32 v143, v142, v9, vcc
v_max_f32 v142, v142, v143
v_cmp_gt_i32 vcc, 18, v156
s_nop 1
v_cndmask_b32 v143, v142, v10, vcc
v_max_f32 v142, v142, v143
v_cmp_gt_i32 vcc, 19, v156
s_nop 1
v_cndmask_b32 v143, v142, v11, vcc
v_max_f32 v142, v142, v143
v_cmp_gt_i32 vcc, 24, v156
s_nop 1
v_cndmask_b32 v143, v142, v12, vcc
v_max_f32 v142, v142, v143
v_cmp_gt_i32 vcc, 25, v156
s_nop 1
v_cndmask_b32 v143, v142, v13, vcc
v_max_f32 v142, v142, v143
v_cmp_gt_i32 vcc, 26, v156
s_nop 1
v_cndmask_b32 v143, v142, v14, vcc
v_max_f32 v142, v142, v143
v_cmp_gt_i32 vcc, 27, v156
s_nop 1
v_cndmask_b32 v143, v142, v15, vcc
v_max_f32 v142, v142, v143
ds_read_b128 v[104:107], v152 offset:19136
ds_read_b128 v[108:111], v153 offset:512
s_waitcnt lgkmcnt(0)
v_mfma_f32_32x32x16_bf16 v[16:31], v[104:107], v[138:141], 0
v_mfma_f32_32x32x16_bf16 v[16:31], v[108:111], v[134:137], v[16:31]
s_nop 7
s_nop 3
v_max_f32 v142, v142, v16
v_max_f32 v142, v142, v17
v_max_f32 v142, v142, v18
v_max_f32 v142, v142, v19
v_max_f32 v142, v142, v20
v_max_f32 v142, v142, v21
v_max_f32 v142, v142, v22
v_max_f32 v142, v142, v23
v_max_f32 v142, v142, v24
v_max_f32 v142, v142, v25
v_max_f32 v142, v142, v26
v_max_f32 v142, v142, v27
v_max_f32 v142, v142, v28
v_max_f32 v142, v142, v29
v_max_f32 v142, v142, v30
v_max_f32 v142, v142, v31
ds_read_b128 v[96:99], v152 offset:19648
ds_read_b128 v[100:103], v153 offset:1024
s_waitcnt lgkmcnt(0)
v_mfma_f32_32x32x16_bf16 v[0:15], v[96:99], v[138:141], 0
v_mfma_f32_32x32x16_bf16 v[0:15], v[100:103], v[134:137], v[0:15]
s_nop 7
s_nop 3
v_max_f32 v142, v142, v0
v_max_f32 v142, v142, v1
v_max_f32 v142, v142, v2
v_max_f32 v142, v142, v3
v_max_f32 v142, v142, v4
v_max_f32 v142, v142, v5
v_max_f32 v142, v142, v6
v_max_f32 v142, v142, v7
v_max_f32 v142, v142, v8
v_max_f32 v142, v142, v9
v_max_f32 v142, v142, v10
v_max_f32 v142, v142, v11
v_max_f32 v142, v142, v12
v_max_f32 v142, v142, v13
v_max_f32 v142, v142, v14
v_max_f32 v142, v142, v15
ds_read_b128 v[104:107], v152 offset:20160
ds_read_b128 v[108:111], v153 offset:1536
s_waitcnt lgkmcnt(0)
v_mfma_f32_32x32x16_bf16 v[16:31], v[104:107], v[138:141], 0
v_mfma_f32_32x32x16_bf16 v[16:31], v[108:111], v[134:137], v[16:31]
s_nop 7
s_nop 3
v_max_f32 v142, v142, v16
v_max_f32 v142, v142, v17
v_max_f32 v142, v142, v18
v_max_f32 v142, v142, v19
v_max_f32 v142, v142, v20
v_max_f32 v142, v142, v21
v_max_f32 v142, v142, v22
v_max_f32 v142, v142, v23
v_max_f32 v142, v142, v24
v_max_f32 v142, v142, v25
v_max_f32 v142, v142, v26
v_max_f32 v142, v142, v27
v_max_f32 v142, v142, v28
v_max_f32 v142, v142, v29
v_max_f32 v142, v142, v30
v_max_f32 v142, v142, v31
ds_read_b128 v[96:99], v152 offset:20672
ds_read_b128 v[100:103], v153 offset:2048
s_waitcnt lgkmcnt(0)
v_mfma_f32_32x32x16_bf16 v[0:15], v[96:99], v[138:141], 0
v_mfma_f32_32x32x16_bf16 v[0:15], v[100:103], v[134:137], v[0:15]
s_nop 7
s_nop 3
v_max_f32 v142, v142, v0
v_max_f32 v142, v142, v1
v_max_f32 v142, v142, v2
v_max_f32 v142, v142, v3
v_max_f32 v142, v142, v4
v_max_f32 v142, v142, v5
v_max_f32 v142, v142, v6
v_max_f32 v142, v142, v7
v_max_f32 v142, v142, v8
v_max_f32 v142, v142, v9
v_max_f32 v142, v142, v10
v_max_f32 v142, v142, v11
v_max_f32 v142, v142, v12
v_max_f32 v142, v142, v13
v_max_f32 v142, v142, v14
v_max_f32 v142, v142, v15
ds_read_b128 v[104:107], v152 offset:21184
ds_read_b128 v[108:111], v153 offset:2560
s_waitcnt lgkmcnt(0)
v_mfma_f32_32x32x16_bf16 v[16:31], v[104:107], v[138:141], 0
v_mfma_f32_32x32x16_bf16 v[16:31], v[108:111], v[134:137], v[16:31]
s_nop 7
s_nop 3
v_max_f32 v142, v142, v16
v_max_f32 v142, v142, v17
v_max_f32 v142, v142, v18
v_max_f32 v142, v142, v19
v_max_f32 v142, v142, v20
v_max_f32 v142, v142, v21
v_max_f32 v142, v142, v22
v_max_f32 v142, v142, v23
v_max_f32 v142, v142, v24
v_max_f32 v142, v142, v25
v_max_f32 v142, v142, v26
v_max_f32 v142, v142, v27
v_max_f32 v142, v142, v28
v_max_f32 v142, v142, v29
v_max_f32 v142, v142, v30
v_max_f32 v142, v142, v31
ds_read_b128 v[96:99], v152 offset:21696
ds_read_b128 v[100:103], v153 offset:3072
s_waitcnt lgkmcnt(0)
v_mfma_f32_32x32x16_bf16 v[0:15], v[96:99], v[138:141], 0
v_mfma_f32_32x32x16_bf16 v[0:15], v[100:103], v[134:137], v[0:15]
s_nop 7
s_nop 3
v_max_f32 v142, v142, v0
v_max_f32 v142, v142, v1
v_max_f32 v142, v142, v2
v_max_f32 v142, v142, v3
v_max_f32 v142, v142, v4
v_max_f32 v142, v142, v5
v_max_f32 v142, v142, v6
v_max_f32 v142, v142, v7
v_max_f32 v142, v142, v8
v_max_f32 v142, v142, v9
v_max_f32 v142, v142, v10
v_max_f32 v142, v142, v11
v_max_f32 v142, v142, v12
v_max_f32 v142, v142, v13
v_max_f32 v142, v142, v14
v_max_f32 v142, v142, v15
ds_read_b128 v[104:107], v152 offset:22208
ds_read_b128 v[108:111], v153 offset:3584
s_waitcnt lgkmcnt(0)
v_mfma_f32_32x32x16_bf16 v[16:31], v[104:107], v[138:141], 0
v_mfma_f32_32x32x16_bf16 v[16:31], v[108:111], v[134:137], v[16:31]
s_nop 7
s_nop 3
v_max_f32 v142, v142, v16
v_max_f32 v142, v142, v17
v_max_f32 v142, v142, v18
v_max_f32 v142, v142, v19
v_max_f32 v142, v142, v20
v_max_f32 v142, v142, v21
v_max_f32 v142, v142, v22
v_max_f32 v142, v142, v23
v_max_f32 v142, v142, v24
v_max_f32 v142, v142, v25
v_max_f32 v142, v142, v26
v_max_f32 v142, v142, v27
v_max_f32 v142, v142, v28
v_max_f32 v142, v142, v29
v_max_f32 v142, v142, v30
v_max_f32 v142, v142, v31
ds_read_b128 v[96:99], v152 offset:22720
ds_read_b128 v[100:103], v153 offset:4096
s_waitcnt lgkmcnt(0)
v_mfma_f32_32x32x16_bf16 v[0:15], v[96:99], v[138:141], 0
v_mfma_f32_32x32x16_bf16 v[0:15], v[100:103], v[134:137], v[0:15]
s_nop 7
s_nop 3
v_cmp_gt_i32 vcc, 0, v156
s_nop 1
v_cndmask_b32 v143, v0, v142, vcc
v_max_f32 v142, v142, v143
v_cmp_gt_i32 vcc, 1, v156
s_nop 1
v_cndmask_b32 v143, v1, v142, vcc
v_max_f32 v142, v142, v143
v_cmp_gt_i32 vcc, 2, v156
s_nop 1
v_cndmask_b32 v143, v2, v142, vcc
v_max_f32 v142, v142, v143
v_cmp_gt_i32 vcc, 3, v156
s_nop 1
v_cndmask_b32 v143, v3, v142, vcc
v_max_f32 v142, v142, v143
v_cmp_gt_i32 vcc, 8, v156
s_nop 1
v_cndmask_b32 v143, v4, v142, vcc
v_max_f32 v142, v142, v143
v_cmp_gt_i32 vcc, 9, v156
s_nop 1
v_cndmask_b32 v143, v5, v142, vcc
v_max_f32 v142, v142, v143
v_cmp_gt_i32 vcc, 10, v156
s_nop 1
v_cndmask_b32 v143, v6, v142, vcc
v_max_f32 v142, v142, v143
v_cmp_gt_i32 vcc, 11, v156
s_nop 1
v_cndmask_b32 v143, v7, v142, vcc
v_max_f32 v142, v142, v143
v_cmp_gt_i32 vcc, 16, v156
s_nop 1
v_cndmask_b32 v143, v8, v142, vcc
v_max_f32 v142, v142, v143
v_cmp_gt_i32 vcc, 17, v156
s_nop 1
v_cndmask_b32 v143, v9, v142, vcc
v_max_f32 v142, v142, v143
v_cmp_gt_i32 vcc, 18, v156
s_nop 1
v_cndmask_b32 v143, v10, v142, vcc
v_max_f32 v142, v142, v143
v_cmp_gt_i32 vcc, 19, v156
s_nop 1
v_cndmask_b32 v143, v11, v142, vcc
v_max_f32 v142, v142, v143
v_cmp_gt_i32 vcc, 24, v156
s_nop 1
v_cndmask_b32 v143, v12, v142, vcc
v_max_f32 v142, v142, v143
v_cmp_gt_i32 vcc, 25, v156
s_nop 1
v_cndmask_b32 v143, v13, v142, vcc
v_max_f32 v142, v142, v143
v_cmp_gt_i32 vcc, 26, v156
s_nop 1
v_cndmask_b32 v143, v14, v142, vcc
v_max_f32 v142, v142, v143
v_cmp_gt_i32 vcc, 27, v156
s_nop 1
v_cndmask_b32 v143, v15, v142, vcc
v_max_f32 v142, v142, v143
v_mov_b32 v143, v142
s_nop 1
v_permlane32_swap_b32 v143, v142
s_nop 0
v_max_f32 v142, v142, v143
v_sub_f32 v48, 0, v142
v_sub_f32 v49, 0, v142
v_sub_f32 v50, 0, v142
v_sub_f32 v51, 0, v142
v_sub_f32 v52, 0, v142
v_sub_f32 v53, 0, v142
v_sub_f32 v54, 0, v142
v_sub_f32 v55, 0, v142
v_sub_f32 v56, 0, v142
v_sub_f32 v57, 0, v142
v_sub_f32 v58, 0, v142
v_sub_f32 v59, 0, v142
v_sub_f32 v60, 0, v142
v_sub_f32 v61, 0, v142
v_sub_f32 v62, 0, v142
v_sub_f32 v63, 0, v142
s_branch L_are_20
L_adn_22:
v_rcp_f32 v142, v92
s_nop 0
v_mul_f32 v80, v80, v142
v_mul_f32 v81, v81, v142
v_mul_f32 v82, v82, v142
v_mul_f32 v83, v83, v142
v_mul_f32 v84, v84, v142
v_mul_f32 v85, v85, v142
v_mul_f32 v86, v86, v142
v_mul_f32 v87, v87, v142
v_mul_f32 v88, v88, v142
v_mul_f32 v89, v89, v142
v_mul_f32 v90, v90, v142
v_mul_f32 v91, v91, v142
s_add_u32 s71, s10, 12288
buffer_load_dwordx4 v[208:211], v228, s[36:39], s71 offen sc1
buffer_load_dwordx4 v[212:215], v229, s[36:39], s71 offen sc1
buffer_load_dwordx4 v[216:219], v230, s[36:39], s71 offen sc1
buffer_load_dwordx4 v[220:223], v232, s[36:39], s71 offen sc1
v_cvt_pk_bf16_f32 v32, v64, v65
v_cvt_pk_bf16_f32 v33, v66, v67
v_cvt_pk_bf16_f32 v34, v68, v69
v_cvt_pk_bf16_f32 v35, v70, v71
v_cvt_pk_bf16_f32 v36, v80, v81
v_cvt_pk_bf16_f32 v37, v82, v83
v_cvt_pk_bf16_f32 v38, v84, v85
v_cvt_pk_bf16_f32 v39, v86, v87
v_cvt_pk_bf16_f32 v40, v72, v73
v_cvt_pk_bf16_f32 v41, v74, v75
v_cvt_pk_bf16_f32 v42, v88, v89
v_cvt_pk_bf16_f32 v43, v90, v91
s_lshl_b32 s72, s5, 7
s_lshl_b32 s73, s3, 5
s_add_u32 s72, s72, s73
s_lshr_b32 s73, s72, 6
s_mul_i32 s73, s73, 81920
s_lshr_b32 s72, s72, 4
s_and_b32 s72, s72, 2
s_lshl_b32 s72, s72, 10
s_add_u32 s72, s72, s73
s_add_u32 s72, s72, 14942208
s_mul_i32 s73, s6, 5
v_bfe_u32 v142, v224, 4, 1
v_lshlrev_b32 v142, 10, v142
v_and_b32 v143, 15, v224
v_lshl_add_u32 v142, v143, 4, v142
v_lshrrev_b32 v143, 5, v224
s_add_u32 s74, s73, 0
v_add_u32 v0, s74, v143
v_and_b32 v3, 3, v0
v_lshrrev_b32 v0, 2, v0
v_lshlrev_b32 v0, 12, v0
v_lshl_add_u32 v0, v3, 8, v0
v_add_u32 v0, v0, v142
s_add_u32 s74, s73, 3
v_add_u32 v1, s74, v143
v_and_b32 v3, 3, v1
v_lshrrev_b32 v1, 2, v1
v_lshlrev_b32 v1, 12, v1
v_lshl_add_u32 v1, v3, 8, v1
v_add_u32 v1, v1, v142
s_add_u32 s74, s73, 2
v_mov_b32 v2, s74
v_and_b32 v3, 3, v2
v_lshrrev_b32 v2, 2, v2
v_lshlrev_b32 v2, 12, v2
v_lshl_add_u32 v2, v3, 8, v2
v_add_u32 v2, v2, v142
v_cmp_gt_u32 vcc, 32, v224
v_mov_b32 v3, 2146435072
s_nop 0
v_cndmask_b32 v2, v3, v2, vcc
buffer_store_dwordx4 v[32:35], v0, s[36:39], s72 offen sc1
buffer_store_dwordx4 v[36:39], v1, s[36:39], s72 offen sc1
buffer_store_dwordx4 v[40:43], v2, s[36:39], s72 offen sc1
s_barrier
s_waitcnt vmcnt(15)
v_mfma_f32_16x16x32_bf16 v[0:3], a[168:171], v[160:163], 0
s_add_u32 s71, s10, 16384
buffer_load_dwordx4 v[80:83], v228, s[36:39], s71 offen sc1
v_mfma_f32_16x16x32_bf16 v[4:7], a[172:175], v[160:163], 0
v_mfma_f32_16x16x32_bf16 v[8:11], a[176:179], v[160:163], 0
v_mfma_f32_16x16x32_bf16 v[12:15], a[180:183], v[160:163], 0
buffer_load_dwordx4 v[84:87], v229, s[36:39], s71 offen sc1
v_mfma_f32_16x16x32_bf16 v[16:19], a[184:187], v[160:163], 0
v_mfma_f32_16x16x32_bf16 v[20:23], a[168:171], v[164:167], 0
v_mfma_f32_16x16x32_bf16 v[24:27], a[172:175], v[164:167], 0
buffer_load_dwordx4 v[88:91], v230, s[36:39], s71 offen sc1
v_mfma_f32_16x16x32_bf16 v[28:31], a[176:179], v[164:167], 0
v_mfma_f32_16x16x32_bf16 v[32:35], a[180:183], v[164:167], 0
v_mfma_f32_16x16x32_bf16 v[36:39], a[184:187], v[164:167], 0
v_mfma_f32_16x16x32_bf16 v[40:43], a[168:171], v[168:171], 0
buffer_load_dwordx4 v[92:95], v232, s[36:39], s71 offen sc1
v_mfma_f32_16x16x32_bf16 v[44:47], a[172:175], v[168:171], 0
v_mfma_f32_16x16x32_bf16 v[48:51], a[176:179], v[168:171], 0
v_mfma_f32_16x16x32_bf16 v[52:55], a[180:183], v[168:171], 0
s_mul_i32 s17, s3, 4096
s_mul_i32 s16, s8, 102400
s_add_u32 s16, s16, 19861504
s_add_u32 s16, s16, s17
s_add_u32 s74, s16, 0
s_add_u32 m0, s17, 61440
s_nop 0
buffer_load_dwordx4 v226, s[36:39], s74 offen sc1 lds
v_mfma_f32_16x16x32_bf16 v[56:59], a[184:187], v[168:171], 0
v_mfma_f32_16x16x32_bf16 v[60:63], a[168:171], v[172:175], 0
v_mfma_f32_16x16x32_bf16 v[64:67], a[172:175], v[172:175], 0
buffer_load_dwordx4 v226, s[36:39], s74 offen offset:1024 sc1 lds
v_mfma_f32_16x16x32_bf16 v[68:71], a[176:179], v[172:175], 0
v_mfma_f32_16x16x32_bf16 v[72:75], a[180:183], v[172:175], 0
v_mfma_f32_16x16x32_bf16 v[76:79], a[184:187], v[172:175], 0
s_waitcnt vmcnt(17)
v_mfma_f32_16x16x32_bf16 v[0:3], a[188:191], v[176:179], v[0:3]
s_add_u32 s71, s10, 20480
buffer_load_dwordx4 v[96:99], v228, s[36:39], s71 offen sc1
v_mfma_f32_16x16x32_bf16 v[4:7], a[192:195], v[176:179], v[4:7]
v_mfma_f32_16x16x32_bf16 v[8:11], a[196:199], v[176:179], v[8:11]
v_mfma_f32_16x16x32_bf16 v[12:15], a[200:203], v[176:179], v[12:15]
buffer_load_dwordx4 v[100:103], v229, s[36:39], s71 offen sc1
v_mfma_f32_16x16x32_bf16 v[16:19], a[204:207], v[176:179], v[16:19]
v_mfma_f32_16x16x32_bf16 v[20:23], a[188:191], v[180:183], v[20:23]
v_mfma_f32_16x16x32_bf16 v[24:27], a[192:195], v[180:183], v[24:27]
buffer_load_dwordx4 v[104:107], v230, s[36:39], s71 offen sc1
v_mfma_f32_16x16x32_bf16 v[28:31], a[196:199], v[180:183], v[28:31]
v_mfma_f32_16x16x32_bf16 v[32:35], a[200:203], v[180:183], v[32:35]
v_mfma_f32_16x16x32_bf16 v[36:39], a[204:207], v[180:183], v[36:39]
v_mfma_f32_16x16x32_bf16 v[40:43], a[188:191], v[184:187], v[40:43]
buffer_load_dwordx4 v[108:111], v232, s[36:39], s71 offen sc1
v_mfma_f32_16x16x32_bf16 v[44:47], a[192:195], v[184:187], v[44:47]
v_mfma_f32_16x16x32_bf16 v[48:51], a[196:199], v[184:187], v[48:51]
v_mfma_f32_16x16x32_bf16 v[52:55], a[200:203], v[184:187], v[52:55]
buffer_load_dwordx4 v226, s[36:39], s74 offen offset:2048 sc1 lds
v_mfma_f32_16x16x32_bf16 v[56:59], a[204:207], v[184:187], v[56:59]
v_mfma_f32_16x16x32_bf16 v[60:63], a[188:191], v[188:191], v[60:63]
v_mfma_f32_16x16x32_bf16 v[64:67], a[192:195], v[188:191], v[64:67]
buffer_load_dwordx4 v226, s[36:39], s74 offen offset:3072 sc1 lds
v_mfma_f32_16x16x32_bf16 v[68:71], a[196:199], v[188:191], v[68:71]
v_mfma_f32_16x16x32_bf16 v[72:75], a[200:203], v[188:191], v[72:75]
v_mfma_f32_16x16x32_bf16 v[76:79], a[204:207], v[188:191], v[76:79]
s_waitcnt vmcnt(12)
s_lshl_b32 s72, s5, 8
s_lshl_b32 s73, s6, 4
s_add_u32 s72, s72, s73
s_lshl_b32 s73, s3, 2
s_add_u32 s72, s72, s73
s_add_u32 s72, s72, 20603008
v_lshlrev_b32 v254, 25, v224
v_mov_b32 v255, s4
buffer_store_dword v255, v254, s[36:39], s72 offen sc1
v_mfma_f32_16x16x32_bf16 v[0:3], a[208:211], v[192:195], v[0:3]
s_add_u32 s71, s10, 24576
buffer_load_dwordx4 v[112:115], v228, s[36:39], s71 offen sc1
v_mfma_f32_16x16x32_bf16 v[4:7], a[212:215], v[192:195], v[4:7]
v_mfma_f32_16x16x32_bf16 v[8:11], a[216:219], v[192:195], v[8:11]
v_mfma_f32_16x16x32_bf16 v[12:15], a[220:223], v[192:195], v[12:15]
buffer_load_dwordx4 v[116:119], v229, s[36:39], s71 offen sc1
v_mfma_f32_16x16x32_bf16 v[16:19], a[224:227], v[192:195], v[16:19]
v_mfma_f32_16x16x32_bf16 v[20:23], a[208:211], v[196:199], v[20:23]
v_mfma_f32_16x16x32_bf16 v[24:27], a[212:215], v[196:199], v[24:27]
buffer_load_dwordx4 v[120:123], v230, s[36:39], s71 offen sc1
v_mfma_f32_16x16x32_bf16 v[28:31], a[216:219], v[196:199], v[28:31]
v_mfma_f32_16x16x32_bf16 v[32:35], a[220:223], v[196:199], v[32:35]
v_mfma_f32_16x16x32_bf16 v[36:39], a[224:227], v[196:199], v[36:39]
v_mfma_f32_16x16x32_bf16 v[40:43], a[208:211], v[200:203], v[40:43]
buffer_load_dwordx4 v[124:127], v232, s[36:39], s71 offen sc1
v_mfma_f32_16x16x32_bf16 v[44:47], a[212:215], v[200:203], v[44:47]
v_mfma_f32_16x16x32_bf16 v[48:51], a[216:219], v[200:203], v[48:51]
v_mfma_f32_16x16x32_bf16 v[52:55], a[220:223], v[200:203], v[52:55]
s_add_u32 s79, s78, 61440
buffer_load_dwordx4 a[168:171], v226, s[36:39], s79 offen sc1
v_mfma_f32_16x16x32_bf16 v[56:59], a[224:227], v[200:203], v[56:59]
v_mfma_f32_16x16x32_bf16 v[60:63], a[208:211], v[204:207], v[60:63]
v_mfma_f32_16x16x32_bf16 v[64:67], a[212:215], v[204:207], v[64:67]
buffer_load_dwordx4 a[172:175], v226, s[36:39], s79 offen offset:1024 sc1
v_mfma_f32_16x16x32_bf16 v[68:71], a[216:219], v[204:207], v[68:71]
v_mfma_f32_16x16x32_bf16 v[72:75], a[220:223], v[204:207], v[72:75]
v_mfma_f32_16x16x32_bf16 v[76:79], a[224:227], v[204:207], v[76:79]
v_mfma_f32_16x16x32_bf16 v[0:3], a[228:231], v[208:211], v[0:3]
s_add_u32 s71, s10, 28672
buffer_load_dwordx4 v[128:131], v228, s[36:39], s71 offen sc1
v_mfma_f32_16x16x32_bf16 v[4:7], a[232:235], v[208:211], v[4:7]
v_mfma_f32_16x16x32_bf16 v[8:11], a[236:239], v[208:211], v[8:11]
v_mfma_f32_16x16x32_bf16 v[12:15], a[240:243], v[208:211], v[12:15]
buffer_load_dwordx4 v[132:135], v229, s[36:39], s71 offen sc1
v_mfma_f32_16x16x32_bf16 v[16:19], a[244:247], v[208:211], v[16:19]
v_mfma_f32_16x16x32_bf16 v[20:23], a[228:231], v[212:215], v[20:23]
v_mfma_f32_16x16x32_bf16 v[24:27], a[232:235], v[212:215], v[24:27]
buffer_load_dwordx4 v[136:139], v230, s[36:39], s71 offen sc1
v_mfma_f32_16x16x32_bf16 v[28:31], a[236:239], v[212:215], v[28:31]
v_mfma_f32_16x16x32_bf16 v[32:35], a[240:243], v[212:215], v[32:35]
v_mfma_f32_16x16x32_bf16 v[36:39], a[244:247], v[212:215], v[36:39]
v_mfma_f32_16x16x32_bf16 v[40:43], a[228:231], v[216:219], v[40:43]
buffer_load_dwordx4 v[140:143], v232, s[36:39], s71 offen sc1
v_mfma_f32_16x16x32_bf16 v[44:47], a[232:235], v[216:219], v[44:47]
v_mfma_f32_16x16x32_bf16 v[48:51], a[236:239], v[216:219], v[48:51]
v_mfma_f32_16x16x32_bf16 v[52:55], a[240:243], v[216:219], v[52:55]
buffer_load_dwordx4 a[176:179], v226, s[36:39], s79 offen offset:2048 sc1
v_mfma_f32_16x16x32_bf16 v[56:59], a[244:247], v[216:219], v[56:59]
v_mfma_f32_16x16x32_bf16 v[60:63], a[228:231], v[220:223], v[60:63]
v_mfma_f32_16x16x32_bf16 v[64:67], a[232:235], v[220:223], v[64:67]
buffer_load_dwordx4 a[180:183], v226, s[36:39], s79 offen offset:3072 sc1
v_mfma_f32_16x16x32_bf16 v[68:71], a[236:239], v[220:223], v[68:71]
v_mfma_f32_16x16x32_bf16 v[72:75], a[240:243], v[220:223], v[72:75]
v_mfma_f32_16x16x32_bf16 v[76:79], a[244:247], v[220:223], v[76:79]
s_waitcnt vmcnt(21)
v_mfma_f32_16x16x32_bf16 v[0:3], a[0:3], v[80:83], v[0:3]
s_add_u32 s71, s10, 32768
buffer_load_dwordx4 v[144:147], v228, s[36:39], s71 offen sc1
v_mfma_f32_16x16x32_bf16 v[4:7], a[4:7], v[80:83], v[4:7]
v_mfma_f32_16x16x32_bf16 v[8:11], a[8:11], v[80:83], v[8:11]
v_mfma_f32_16x16x32_bf16 v[12:15], a[12:15], v[80:83], v[12:15]
buffer_load_dwordx4 v[148:151], v229, s[36:39], s71 offen sc1
v_mfma_f32_16x16x32_bf16 v[16:19], a[16:19], v[80:83], v[16:19]
v_mfma_f32_16x16x32_bf16 v[20:23], a[0:3], v[84:87], v[20:23]
v_mfma_f32_16x16x32_bf16 v[24:27], a[4:7], v[84:87], v[24:27]
buffer_load_dwordx4 v[152:155], v230, s[36:39], s71 offen sc1
v_mfma_f32_16x16x32_bf16 v[28:31], a[8:11], v[84:87], v[28:31]
v_mfma_f32_16x16x32_bf16 v[32:35], a[12:15], v[84:87], v[32:35]
v_mfma_f32_16x16x32_bf16 v[36:39], a[16:19], v[84:87], v[36:39]
v_mfma_f32_16x16x32_bf16 v[40:43], a[0:3], v[88:91], v[40:43]
buffer_load_dwordx4 v[156:159], v232, s[36:39], s71 offen sc1
v_mfma_f32_16x16x32_bf16 v[44:47], a[4:7], v[88:91], v[44:47]
v_mfma_f32_16x16x32_bf16 v[48:51], a[8:11], v[88:91], v[48:51]
v_mfma_f32_16x16x32_bf16 v[52:55], a[12:15], v[88:91], v[52:55]
buffer_load_dwordx4 a[184:187], v231, s[36:39], s79 offen sc1
v_mfma_f32_16x16x32_bf16 v[56:59], a[16:19], v[88:91], v[56:59]
v_mfma_f32_16x16x32_bf16 v[60:63], a[0:3], v[92:95], v[60:63]
v_mfma_f32_16x16x32_bf16 v[64:67], a[4:7], v[92:95], v[64:67]
s_add_u32 s79, s78, 66560
s_cmp_ge_u32 s3, 2
s_cselect_b32 s79, 2146435072, s79
buffer_load_dwordx4 a[188:191], v226, s[36:39], s79 offen sc1
v_mfma_f32_16x16x32_bf16 v[68:71], a[8:11], v[92:95], v[68:71]
v_mfma_f32_16x16x32_bf16 v[72:75], a[12:15], v[92:95], v[72:75]
v_mfma_f32_16x16x32_bf16 v[76:79], a[16:19], v[92:95], v[76:79]
s_waitcnt vmcnt(21)
v_mfma_f32_16x16x32_bf16 v[0:3], a[20:23], v[96:99], v[0:3]
s_add_u32 s71, s10, 36864
buffer_load_dwordx4 v[160:163], v228, s[36:39], s71 offen sc1
v_mfma_f32_16x16x32_bf16 v[4:7], a[24:27], v[96:99], v[4:7]
v_mfma_f32_16x16x32_bf16 v[8:11], a[28:31], v[96:99], v[8:11]
v_mfma_f32_16x16x32_bf16 v[12:15], a[32:35], v[96:99], v[12:15]
buffer_load_dwordx4 v[164:167], v229, s[36:39], s71 offen sc1
v_mfma_f32_16x16x32_bf16 v[16:19], a[36:39], v[96:99], v[16:19]
v_mfma_f32_16x16x32_bf16 v[20:23], a[20:23], v[100:103], v[20:23]
v_mfma_f32_16x16x32_bf16 v[24:27], a[24:27], v[100:103], v[24:27]
buffer_load_dwordx4 v[168:171], v230, s[36:39], s71 offen sc1
v_mfma_f32_16x16x32_bf16 v[28:31], a[28:31], v[100:103], v[28:31]
v_mfma_f32_16x16x32_bf16 v[32:35], a[32:35], v[100:103], v[32:35]
v_mfma_f32_16x16x32_bf16 v[36:39], a[36:39], v[100:103], v[36:39]
v_mfma_f32_16x16x32_bf16 v[40:43], a[20:23], v[104:107], v[40:43]
buffer_load_dwordx4 v[172:175], v232, s[36:39], s71 offen sc1
v_mfma_f32_16x16x32_bf16 v[44:47], a[24:27], v[104:107], v[44:47]
v_mfma_f32_16x16x32_bf16 v[48:51], a[28:31], v[104:107], v[48:51]
v_mfma_f32_16x16x32_bf16 v[52:55], a[32:35], v[104:107], v[52:55]
buffer_load_dwordx4 a[192:195], v226, s[36:39], s79 offen offset:1024 sc1
v_mfma_f32_16x16x32_bf16 v[56:59], a[36:39], v[104:107], v[56:59]
v_mfma_f32_16x16x32_bf16 v[60:63], a[20:23], v[108:111], v[60:63]
v_mfma_f32_16x16x32_bf16 v[64:67], a[24:27], v[108:111], v[64:67]
buffer_load_dwordx4 a[196:199], v226, s[36:39], s79 offen offset:2048 sc1
v_mfma_f32_16x16x32_bf16 v[68:71], a[28:31], v[108:111], v[68:71]
v_mfma_f32_16x16x32_bf16 v[72:75], a[32:35], v[108:111], v[72:75]
v_mfma_f32_16x16x32_bf16 v[76:79], a[36:39], v[108:111], v[76:79]
s_waitcnt vmcnt(20)
v_mfma_f32_16x16x32_bf16 v[0:3], a[40:43], v[112:115], v[0:3]
s_add_u32 s71, s10, 40960
buffer_load_dwordx4 v[176:179], v228, s[36:39], s71 offen sc1
v_mfma_f32_16x16x32_bf16 v[4:7], a[44:47], v[112:115], v[4:7]
v_mfma_f32_16x16x32_bf16 v[8:11], a[48:51], v[112:115], v[8:11]
v_mfma_f32_16x16x32_bf16 v[12:15], a[52:55], v[112:115], v[12:15]
buffer_load_dwordx4 v[180:183], v229, s[36:39], s71 offen sc1
v_mfma_f32_16x16x32_bf16 v[16:19], a[56:59], v[112:115], v[16:19]
v_mfma_f32_16x16x32_bf16 v[20:23], a[40:43], v[116:119], v[20:23]
v_mfma_f32_16x16x32_bf16 v[24:27], a[44:47], v[116:119], v[24:27]
buffer_load_dwordx4 v[184:187], v230, s[36:39], s71 offen sc1
v_mfma_f32_16x16x32_bf16 v[28:31], a[48:51], v[116:119], v[28:31]
v_mfma_f32_16x16x32_bf16 v[32:35], a[52:55], v[116:119], v[32:35]
v_mfma_f32_16x16x32_bf16 v[36:39], a[56:59], v[116:119], v[36:39]
v_mfma_f32_16x16x32_bf16 v[40:43], a[40:43], v[120:123], v[40:43]
buffer_load_dwordx4 v[188:191], v232, s[36:39], s71 offen sc1
v_mfma_f32_16x16x32_bf16 v[44:47], a[44:47], v[120:123], v[44:47]
v_mfma_f32_16x16x32_bf16 v[48:51], a[48:51], v[120:123], v[48:51]
v_mfma_f32_16x16x32_bf16 v[52:55], a[52:55], v[120:123], v[52:55]
buffer_load_dwordx4 a[200:203], v226, s[36:39], s79 offen offset:3072 sc1
v_mfma_f32_16x16x32_bf16 v[56:59], a[56:59], v[120:123], v[56:59]
v_mfma_f32_16x16x32_bf16 v[60:63], a[40:43], v[124:127], v[60:63]
v_mfma_f32_16x16x32_bf16 v[64:67], a[44:47], v[124:127], v[64:67]
buffer_load_dwordx4 a[204:207], v231, s[36:39], s79 offen sc1
v_mfma_f32_16x16x32_bf16 v[68:71], a[48:51], v[124:127], v[68:71]
v_mfma_f32_16x16x32_bf16 v[72:75], a[52:55], v[124:127], v[72:75]
v_mfma_f32_16x16x32_bf16 v[76:79], a[56:59], v[124:127], v[76:79]
s_waitcnt vmcnt(20)
v_mfma_f32_16x16x32_bf16 v[0:3], a[60:63], v[128:131], v[0:3]
s_add_u32 s71, s10, 45056
buffer_load_dwordx4 v[192:195], v228, s[36:39], s71 offen sc1
v_mfma_f32_16x16x32_bf16 v[4:7], a[64:67], v[128:131], v[4:7]
v_mfma_f32_16x16x32_bf16 v[8:11], a[68:71], v[128:131], v[8:11]
v_mfma_f32_16x16x32_bf16 v[12:15], a[72:75], v[128:131], v[12:15]
v_mfma_f32_16x16x32_bf16 v[16:19], a[76:79], v[128:131], v[16:19]
v_mfma_f32_16x16x32_bf16 v[20:23], a[60:63], v[132:135], v[20:23]
buffer_load_dwordx4 v[196:199], v229, s[36:39], s71 offen sc1
v_mfma_f32_16x16x32_bf16 v[24:27], a[64:67], v[132:135], v[24:27]
v_mfma_f32_16x16x32_bf16 v[28:31], a[68:71], v[132:135], v[28:31]
v_mfma_f32_16x16x32_bf16 v[32:35], a[72:75], v[132:135], v[32:35]
v_mfma_f32_16x16x32_bf16 v[36:39], a[76:79], v[132:135], v[36:39]
v_mfma_f32_16x16x32_bf16 v[40:43], a[60:63], v[136:139], v[40:43]
buffer_load_dwordx4 v[200:203], v230, s[36:39], s71 offen sc1
v_mfma_f32_16x16x32_bf16 v[44:47], a[64:67], v[136:139], v[44:47]
v_mfma_f32_16x16x32_bf16 v[48:51], a[68:71], v[136:139], v[48:51]
v_mfma_f32_16x16x32_bf16 v[52:55], a[72:75], v[136:139], v[52:55]
v_mfma_f32_16x16x32_bf16 v[56:59], a[76:79], v[136:139], v[56:59]
v_mfma_f32_16x16x32_bf16 v[60:63], a[60:63], v[140:143], v[60:63]
buffer_load_dwordx4 v[204:207], v232, s[36:39], s71 offen sc1
v_mfma_f32_16x16x32_bf16 v[64:67], a[64:67], v[140:143], v[64:67]
v_mfma_f32_16x16x32_bf16 v[68:71], a[68:71], v[140:143], v[68:71]
v_mfma_f32_16x16x32_bf16 v[72:75], a[72:75], v[140:143], v[72:75]
v_mfma_f32_16x16x32_bf16 v[76:79], a[76:79], v[140:143], v[76:79]
s_waitcnt vmcnt(18)
v_mfma_f32_16x16x32_bf16 v[0:3], a[80:83], v[144:147], v[0:3]
s_add_u32 s71, s10, 49152
buffer_load_dwordx4 v[208:211], v228, s[36:39], s71 offen sc1
v_mfma_f32_16x16x32_bf16 v[4:7], a[84:87], v[144:147], v[4:7]
v_mfma_f32_16x16x32_bf16 v[8:11], a[88:91], v[144:147], v[8:11]
v_mfma_f32_16x16x32_bf16 v[12:15], a[92:95], v[144:147], v[12:15]
v_mfma_f32_16x16x32_bf16 v[16:19], a[96:99], v[144:147], v[16:19]
v_mfma_f32_16x16x32_bf16 v[20:23], a[80:83], v[148:151], v[20:23]
buffer_load_dwordx4 v[212:215], v229, s[36:39], s71 offen sc1
v_mfma_f32_16x16x32_bf16 v[24:27], a[84:87], v[148:151], v[24:27]
v_mfma_f32_16x16x32_bf16 v[28:31], a[88:91], v[148:151], v[28:31]
v_mfma_f32_16x16x32_bf16 v[32:35], a[92:95], v[148:151], v[32:35]
v_mfma_f32_16x16x32_bf16 v[36:39], a[96:99], v[148:151], v[36:39]
v_mfma_f32_16x16x32_bf16 v[40:43], a[80:83], v[152:155], v[40:43]
buffer_load_dwordx4 v[216:219], v230, s[36:39], s71 offen sc1
v_mfma_f32_16x16x32_bf16 v[44:47], a[84:87], v[152:155], v[44:47]
v_mfma_f32_16x16x32_bf16 v[48:51], a[88:91], v[152:155], v[48:51]
v_mfma_f32_16x16x32_bf16 v[52:55], a[92:95], v[152:155], v[52:55]
v_mfma_f32_16x16x32_bf16 v[56:59], a[96:99], v[152:155], v[56:59]
v_mfma_f32_16x16x32_bf16 v[60:63], a[80:83], v[156:159], v[60:63]
buffer_load_dwordx4 v[220:223], v232, s[36:39], s71 offen sc1
v_mfma_f32_16x16x32_bf16 v[64:67], a[84:87], v[156:159], v[64:67]
v_mfma_f32_16x16x32_bf16 v[68:71], a[88:91], v[156:159], v[68:71]
v_mfma_f32_16x16x32_bf16 v[72:75], a[92:95], v[156:159], v[72:75]
v_mfma_f32_16x16x32_bf16 v[76:79], a[96:99], v[156:159], v[76:79]
s_waitcnt vmcnt(16)
v_mfma_f32_16x16x32_bf16 v[0:3], a[100:103], v[160:163], v[0:3]
v_mfma_f32_16x16x32_bf16 v[4:7], a[104:107], v[160:163], v[4:7]
v_mfma_f32_16x16x32_bf16 v[8:11], a[108:111], v[160:163], v[8:11]
v_mfma_f32_16x16x32_bf16 v[12:15], a[112:115], v[160:163], v[12:15]
v_mfma_f32_16x16x32_bf16 v[16:19], a[116:119], v[160:163], v[16:19]
v_mfma_f32_16x16x32_bf16 v[20:23], a[100:103], v[164:167], v[20:23]
v_mfma_f32_16x16x32_bf16 v[24:27], a[104:107], v[164:167], v[24:27]
v_mfma_f32_16x16x32_bf16 v[28:31], a[108:111], v[164:167], v[28:31]
v_mfma_f32_16x16x32_bf16 v[32:35], a[112:115], v[164:167], v[32:35]
v_mfma_f32_16x16x32_bf16 v[36:39], a[116:119], v[164:167], v[36:39]
v_mfma_f32_16x16x32_bf16 v[40:43], a[100:103], v[168:171], v[40:43]
v_mfma_f32_16x16x32_bf16 v[44:47], a[104:107], v[168:171], v[44:47]
v_mfma_f32_16x16x32_bf16 v[48:51], a[108:111], v[168:171], v[48:51]
v_mfma_f32_16x16x32_bf16 v[52:55], a[112:115], v[168:171], v[52:55]
v_mfma_f32_16x16x32_bf16 v[56:59], a[116:119], v[168:171], v[56:59]
v_mfma_f32_16x16x32_bf16 v[60:63], a[100:103], v[172:175], v[60:63]
v_mfma_f32_16x16x32_bf16 v[64:67], a[104:107], v[172:175], v[64:67]
v_mfma_f32_16x16x32_bf16 v[68:71], a[108:111], v[172:175], v[68:71]
v_mfma_f32_16x16x32_bf16 v[72:75], a[112:115], v[172:175], v[72:75]
v_mfma_f32_16x16x32_bf16 v[76:79], a[116:119], v[172:175], v[76:79]
s_waitcnt vmcnt(10)
v_mfma_f32_16x16x32_bf16 v[0:3], a[120:123], v[176:179], v[0:3]
s_add_u32 s71, s10, 53248
s_cmp_ge_u32 s3, 2
s_cselect_b32 s71, 2146435072, s71
buffer_load_dwordx4 v[160:163], v228, s[36:39], s71 offen sc1
v_mfma_f32_16x16x32_bf16 v[4:7], a[124:127], v[176:179], v[4:7]
v_mfma_f32_16x16x32_bf16 v[8:11], a[128:131], v[176:179], v[8:11]
v_mfma_f32_16x16x32_bf16 v[12:15], a[132:135], v[176:179], v[12:15]
v_mfma_f32_16x16x32_bf16 v[16:19], a[136:139], v[176:179], v[16:19]
buffer_load_dwordx4 v[164:167], v229, s[36:39], s71 offen sc1
v_mfma_f32_16x16x32_bf16 v[20:23], a[120:123], v[180:183], v[20:23]
v_mfma_f32_16x16x32_bf16 v[24:27], a[124:127], v[180:183], v[24:27]
v_mfma_f32_16x16x32_bf16 v[28:31], a[128:131], v[180:183], v[28:31]
v_mfma_f32_16x16x32_bf16 v[32:35], a[132:135], v[180:183], v[32:35]
buffer_load_dwordx4 v[168:171], v230, s[36:39], s71 offen sc1
v_mfma_f32_16x16x32_bf16 v[36:39], a[136:139], v[180:183], v[36:39]
v_mfma_f32_16x16x32_bf16 v[40:43], a[120:123], v[184:187], v[40:43]
v_mfma_f32_16x16x32_bf16 v[44:47], a[124:127], v[184:187], v[44:47]
v_mfma_f32_16x16x32_bf16 v[48:51], a[128:131], v[184:187], v[48:51]
buffer_load_dwordx4 v[172:175], v232, s[36:39], s71 offen sc1
v_mfma_f32_16x16x32_bf16 v[52:55], a[132:135], v[184:187], v[52:55]
v_mfma_f32_16x16x32_bf16 v[56:59], a[136:139], v[184:187], v[56:59]
v_mfma_f32_16x16x32_bf16 v[60:63], a[120:123], v[188:191], v[60:63]
v_mfma_f32_16x16x32_bf16 v[64:67], a[124:127], v[188:191], v[64:67]
s_and_b32 s72, s7, 1
s_cmp_eq_u32 s72, 0
s_mov_b32 s76, 0xcccccccc
s_cselect_b32 s76, 0x33333333, s76
s_mov_b32 s77, s76
s_lshr_b32 s72, s7, 1
s_lshl_b32 s72, s72, 8
s_add_u32 s75, s72, 20603008
v_lshlrev_b32 v249, 2, v224
buffer_load_dword v248, v249, s[36:39], s75 offen sc1
v_mfma_f32_16x16x32_bf16 v[68:71], a[128:131], v[188:191], v[68:71]
v_mfma_f32_16x16x32_bf16 v[72:75], a[132:135], v[188:191], v[72:75]
v_mfma_f32_16x16x32_bf16 v[76:79], a[136:139], v[188:191], v[76:79]
s_waitcnt vmcnt(9)
v_mfma_f32_16x16x32_bf16 v[0:3], a[140:143], v[192:195], v[0:3]
s_add_u32 s70, s3, 1
s_and_b32 s70, s70, 3
s_mul_i32 s70, s70, 15360
s_add_u32 s70, s70, 0
v_add_u32 v243, s70, v226
s_add_u32 s70, s3, 2
s_and_b32 s70, s70, 3
s_mul_i32 s70, s70, 15360
s_add_u32 s70, s70, 5120
v_add_u32 v244, s70, v226
s_add_u32 s70, s3, 3
s_and_b32 s70, s70, 3
s_mul_i32 s70, s70, 15360
s_add_u32 s70, s70, 10240
v_add_u32 v245, s70, v226
s_mul_i32 s70, s3, 15360
s_add_u32 s70, s70, 0
v_add_u32 v246, s70, v226
v_add_u32 v238, 0x10000, v226
v_add_u32 v236, 0x20000, v226
v_mfma_f32_16x16x32_bf16 v[4:7], a[144:147], v[192:195], v[4:7]
v_mfma_f32_16x16x32_bf16 v[8:11], a[148:151], v[192:195], v[8:11]
v_mfma_f32_16x16x32_bf16 v[12:15], a[152:155], v[192:195], v[12:15]
v_mfma_f32_16x16x32_bf16 v[16:19], a[156:159], v[192:195], v[16:19]
v_mfma_f32_16x16x32_bf16 v[20:23], a[140:143], v[196:199], v[20:23]
v_mfma_f32_16x16x32_bf16 v[24:27], a[144:147], v[196:199], v[24:27]
v_mfma_f32_16x16x32_bf16 v[28:31], a[148:151], v[196:199], v[28:31]
v_mfma_f32_16x16x32_bf16 v[32:35], a[152:155], v[196:199], v[32:35]
v_mfma_f32_16x16x32_bf16 v[36:39], a[156:159], v[196:199], v[36:39]
v_mfma_f32_16x16x32_bf16 v[40:43], a[140:143], v[200:203], v[40:43]
v_mfma_f32_16x16x32_bf16 v[44:47], a[144:147], v[200:203], v[44:47]
v_mfma_f32_16x16x32_bf16 v[48:51], a[148:151], v[200:203], v[48:51]
v_mfma_f32_16x16x32_bf16 v[52:55], a[152:155], v[200:203], v[52:55]
v_mfma_f32_16x16x32_bf16 v[56:59], a[156:159], v[200:203], v[56:59]
v_mfma_f32_16x16x32_bf16 v[60:63], a[140:143], v[204:207], v[60:63]
v_mfma_f32_16x16x32_bf16 v[64:67], a[144:147], v[204:207], v[64:67]
v_mfma_f32_16x16x32_bf16 v[68:71], a[148:151], v[204:207], v[68:71]
v_mfma_f32_16x16x32_bf16 v[72:75], a[152:155], v[204:207], v[72:75]
v_mfma_f32_16x16x32_bf16 v[76:79], a[156:159], v[204:207], v[76:79]
s_waitcnt vmcnt(0)
s_mov_b32 s70, 0
L_wq_23:
v_cmp_ne_u32 vcc, s4, v248
s_nop 3
s_and_b64 vcc, vcc, s[76:77]
s_cbranch_scc0 L_wd_24
s_add_u32 s70, s70, 1
s_cmp_ge_u32 s70, 200000
s_cbranch_scc1 L_wd_24
s_sleep 1
buffer_load_dword v248, v249, s[36:39], s75 offen sc1
s_waitcnt vmcnt(0)
s_branch L_wq_23
L_wd_24:
v_mfma_f32_16x16x32_bf16 v[0:3], a[168:171], v[208:211], v[0:3]
s_mul_i32 s75, s7, 81920
s_lshl_b32 s71, s3, 10
s_add_u32 s75, s75, s71
s_add_u32 s75, s75, 14942208
s_add_u32 s71, s75, 0
buffer_load_dwordx4 v[80:83], v226, s[36:39], s71 offen sc1
v_mfma_f32_16x16x32_bf16 v[4:7], a[172:175], v[208:211], v[4:7]
v_mfma_f32_16x16x32_bf16 v[8:11], a[176:179], v[208:211], v[8:11]
v_mfma_f32_16x16x32_bf16 v[12:15], a[180:183], v[208:211], v[12:15]
v_mfma_f32_16x16x32_bf16 v[16:19], a[184:187], v[208:211], v[16:19]
s_add_u32 s71, s75, 4096
buffer_load_dwordx4 v[84:87], v226, s[36:39], s71 offen sc1
v_mfma_f32_16x16x32_bf16 v[20:23], a[168:171], v[212:215], v[20:23]
v_mfma_f32_16x16x32_bf16 v[24:27], a[172:175], v[212:215], v[24:27]
v_mfma_f32_16x16x32_bf16 v[28:31], a[176:179], v[212:215], v[28:31]
v_mfma_f32_16x16x32_bf16 v[32:35], a[180:183], v[212:215], v[32:35]
s_add_u32 s71, s75, 8192
buffer_load_dwordx4 v[88:91], v226, s[36:39], s71 offen sc1
v_mfma_f32_16x16x32_bf16 v[36:39], a[184:187], v[212:215], v[36:39]
v_mfma_f32_16x16x32_bf16 v[40:43], a[168:171], v[216:219], v[40:43]
v_mfma_f32_16x16x32_bf16 v[44:47], a[172:175], v[216:219], v[44:47]
v_mfma_f32_16x16x32_bf16 v[48:51], a[176:179], v[216:219], v[48:51]
s_add_u32 s71, s75, 12288
buffer_load_dwordx4 v[92:95], v226, s[36:39], s71 offen sc1
v_mfma_f32_16x16x32_bf16 v[52:55], a[180:183], v[216:219], v[52:55]
v_mfma_f32_16x16x32_bf16 v[56:59], a[184:187], v[216:219], v[56:59]
v_mfma_f32_16x16x32_bf16 v[60:63], a[168:171], v[220:223], v[60:63]
v_mfma_f32_16x16x32_bf16 v[64:67], a[172:175], v[220:223], v[64:67]
s_add_u32 s71, s75, 16384
buffer_load_dwordx4 v[96:99], v226, s[36:39], s71 offen sc1
v_mfma_f32_16x16x32_bf16 v[68:71], a[176:179], v[220:223], v[68:71]
v_mfma_f32_16x16x32_bf16 v[72:75], a[180:183], v[220:223], v[72:75]
v_mfma_f32_16x16x32_bf16 v[76:79], a[184:187], v[220:223], v[76:79]
v_mfma_f32_16x16x32_bf16 v[20:23], a[188:191], v[164:167], v[20:23]
s_add_u32 s71, s75, 20480
buffer_load_dwordx4 v[100:103], v226, s[36:39], s71 offen sc1
v_mfma_f32_16x16x32_bf16 v[24:27], a[192:195], v[164:167], v[24:27]
v_mfma_f32_16x16x32_bf16 v[28:31], a[196:199], v[164:167], v[28:31]
v_mfma_f32_16x16x32_bf16 v[32:35], a[200:203], v[164:167], v[32:35]
v_mfma_f32_16x16x32_bf16 v[36:39], a[204:207], v[164:167], v[36:39]
s_add_u32 s71, s75, 24576
buffer_load_dwordx4 v[104:107], v226, s[36:39], s71 offen sc1
v_mfma_f32_16x16x32_bf16 v[40:43], a[188:191], v[168:171], v[40:43]
v_mfma_f32_16x16x32_bf16 v[44:47], a[192:195], v[168:171], v[44:47]
v_mfma_f32_16x16x32_bf16 v[48:51], a[196:199], v[168:171], v[48:51]
v_mfma_f32_16x16x32_bf16 v[52:55], a[200:203], v[168:171], v[52:55]
s_add_u32 s71, s75, 28672
buffer_load_dwordx4 v[108:111], v226, s[36:39], s71 offen sc1
v_mfma_f32_16x16x32_bf16 v[56:59], a[204:207], v[168:171], v[56:59]
v_mfma_f32_16x16x32_bf16 v[60:63], a[188:191], v[172:175], v[60:63]
ds_write_b128 v243, v[20:23] offset:0
v_mfma_f32_16x16x32_bf16 v[64:67], a[192:195], v[172:175], v[64:67]
ds_write_b128 v243, v[24:27] offset:1024
v_mfma_f32_16x16x32_bf16 v[68:71], a[196:199], v[172:175], v[68:71]
s_add_u32 s71, s75, 32768
buffer_load_dwordx4 v[112:115], v226, s[36:39], s71 offen sc1
ds_write_b128 v243, v[28:31] offset:2048
v_mfma_f32_16x16x32_bf16 v[72:75], a[200:203], v[172:175], v[72:75]
ds_write_b128 v243, v[32:35] offset:3072
v_mfma_f32_16x16x32_bf16 v[76:79], a[204:207], v[172:175], v[76:79]
ds_write_b128 v243, v[36:39] offset:4096
v_mfma_f32_16x16x32_bf16 v[0:3], a[188:191], v[160:163], v[0:3]
ds_write_b128 v244, v[40:43] offset:0
v_mfma_f32_16x16x32_bf16 v[4:7], a[192:195], v[160:163], v[4:7]
s_add_u32 s71, s75, 36864
buffer_load_dwordx4 v[116:119], v226, s[36:39], s71 offen sc1
ds_write_b128 v244, v[44:47] offset:1024
v_mfma_f32_16x16x32_bf16 v[8:11], a[196:199], v[160:163], v[8:11]
ds_write_b128 v244, v[48:51] offset:2048
v_mfma_f32_16x16x32_bf16 v[12:15], a[200:203], v[160:163], v[12:15]
ds_write_b128 v244, v[52:55] offset:3072
v_mfma_f32_16x16x32_bf16 v[16:19], a[204:207], v[160:163], v[16:19]
ds_write_b128 v244, v[56:59] offset:4096
ds_write_b128 v245, v[60:63] offset:0
ds_write_b128 v245, v[64:67] offset:1024
ds_write_b128 v245, v[68:71] offset:2048
ds_write_b128 v245, v[72:75] offset:3072
ds_write_b128 v245, v[76:79] offset:4096
v_and_b32 v241, 15, v224
v_mul_u32_u24 v241, 1280, v241
v_lshrrev_b32 v242, 4, v224
v_lshl_add_u32 v237, v242, 3, v241
s_lshl_b32 s70, s7, 6
s_lshl_b32 s71, s3, 4
s_add_u32 s70, s70, s71
s_mul_i32 s70, s70, 1280
s_mul_i32 s71, s8, 160
s_add_u32 s11, s70, s71
buffer_load_dwordx2 v[60:61], v237, s[24:27], s11 offen
buffer_load_dwordx2 v[62:63], v237, s[24:27], s11 offen offset:32
buffer_load_dwordx2 v[64:65], v237, s[24:27], s11 offen offset:64
buffer_load_dwordx2 v[66:67], v237, s[24:27], s11 offen offset:96
buffer_load_dwordx2 v[68:69], v237, s[24:27], s11 offen offset:128
s_waitcnt lgkmcnt(0)
s_barrier
ds_read_b128 v[180:183], v238 offset:12288
ds_read_b128 v[184:187], v238 offset:13312
ds_read_b128 v[188:191], v238 offset:14336
ds_read_b128 v[192:195], v238 offset:15360
ds_read_b128 v[196:199], v238 offset:16384
ds_read_b128 v[200:203], v238 offset:17408
ds_read_b128 v[204:207], v238 offset:18432
ds_read_b128 v[208:211], v238 offset:19456
ds_read_b128 v[212:215], v238 offset:20480
ds_read_b128 v[216:219], v238 offset:21504
s_waitcnt vmcnt(14) lgkmcnt(5)
v_mfma_f32_16x16x32_bf16 v[160:163], v[180:183], v[80:83], 0
ds_read_b128 v[20:23], v238 offset:22528
s_add_u32 s71, s75, 40960
buffer_load_dwordx4 v[120:123], v226, s[36:39], s71 offen sc1
v_mfma_f32_16x16x32_bf16 v[164:167], v[184:187], v[80:83], 0
ds_read_b128 v[24:27], v238 offset:23552
ds_read_b128 v[40:43], v246 offset:0
ds_read_b128 v[44:47], v246 offset:1024
v_mfma_f32_16x16x32_bf16 v[168:171], v[188:191], v[80:83], 0
ds_read_b128 v[28:31], v238 offset:24576
ds_read_b128 v[48:51], v246 offset:2048
s_waitcnt lgkmcnt(3)
v_add_f32 v0, v0, v40
v_mfma_f32_16x16x32_bf16 v[172:175], v[192:195], v[80:83], 0
ds_read_b128 v[32:35], v238 offset:25600
v_add_f32 v1, v1, v41
v_add_f32 v2, v2, v42
v_mfma_f32_16x16x32_bf16 v[176:179], v[196:199], v[80:83], 0
ds_read_b128 v[36:39], v238 offset:26624
v_add_f32 v3, v3, v43
ds_read_b128 v[40:43], v246 offset:3072
s_waitcnt vmcnt(14) lgkmcnt(5)
v_mfma_f32_16x16x32_bf16 v[160:163], v[200:203], v[84:87], v[160:163]
ds_read_b128 v[180:183], v238 offset:27648
s_add_u32 s71, s75, 45056
buffer_load_dwordx4 v[124:127], v226, s[36:39], s71 offen sc1
v_mfma_f32_16x16x32_bf16 v[164:167], v[204:207], v[84:87], v[164:167]
ds_read_b128 v[184:187], v238 offset:28672
v_add_f32 v4, v4, v44
v_add_f32 v5, v5, v45
v_mfma_f32_16x16x32_bf16 v[168:171], v[208:211], v[84:87], v[168:171]
ds_read_b128 v[188:191], v238 offset:29696
v_add_f32 v6, v6, v46
v_add_f32 v7, v7, v47
ds_read_b128 v[44:47], v246 offset:4096
v_mfma_f32_16x16x32_bf16 v[172:175], v[212:215], v[84:87], v[172:175]
ds_read_b128 v[192:195], v238 offset:30720
s_waitcnt lgkmcnt(8)
v_add_f32 v8, v8, v48
v_mfma_f32_16x16x32_bf16 v[176:179], v[216:219], v[84:87], v[176:179]
ds_read_b128 v[196:199], v238 offset:31744
v_add_f32 v9, v9, v49
v_add_f32 v10, v10, v50
v_add_f32 v11, v11, v51
s_waitcnt vmcnt(14) lgkmcnt(7)
v_mfma_f32_16x16x32_bf16 v[160:163], v[20:23], v[88:91], v[160:163]
ds_read_b128 v[200:203], v238 offset:32768
s_add_u32 s71, s75, 49152
buffer_load_dwordx4 v[128:131], v226, s[36:39], s71 offen sc1
v_mfma_f32_16x16x32_bf16 v[164:167], v[24:27], v[88:91], v[164:167]
ds_read_b128 v[204:207], v238 offset:33792
ds_read_b128 v[48:51], v246 offset:5120
s_waitcnt lgkmcnt(9)
v_mfma_f32_16x16x32_bf16 v[168:171], v[28:31], v[88:91], v[168:171]
ds_read_b128 v[208:211], v238 offset:34816
v_add_f32 v12, v12, v40
v_add_f32 v13, v13, v41
v_add_f32 v14, v14, v42
v_mfma_f32_16x16x32_bf16 v[172:175], v[32:35], v[88:91], v[172:175]
ds_read_b128 v[212:215], v238 offset:35840
v_add_f32 v15, v15, v43
ds_read_b128 v[40:43], v246 offset:6144
v_mfma_f32_16x16x32_bf16 v[176:179], v[36:39], v[88:91], v[176:179]
ds_read_b128 v[216:219], v238 offset:36864
s_waitcnt lgkmcnt(9)
v_add_f32 v16, v16, v44
v_add_f32 v17, v17, v45
s_waitcnt vmcnt(14) lgkmcnt(7)
v_mfma_f32_16x16x32_bf16 v[160:163], v[180:183], v[92:95], v[160:163]
ds_read_b128 v[20:23], v238 offset:37888
s_add_u32 s71, s75, 53248
buffer_load_dwordx4 v[132:135], v226, s[36:39], s71 offen sc1
v_mfma_f32_16x16x32_bf16 v[164:167], v[184:187], v[92:95], v[164:167]
ds_read_b128 v[24:27], v238 offset:38912
v_add_f32 v18, v18, v46
v_add_f32 v19, v19, v47
v_mfma_f32_16x16x32_bf16 v[168:171], v[188:191], v[92:95], v[168:171]
ds_read_b128 v[28:31], v238 offset:39936
ds_read_b128 v[44:47], v246 offset:7168
s_waitcnt lgkmcnt(8)
v_add_f32 v0, v0, v48
v_mfma_f32_16x16x32_bf16 v[172:175], v[192:195], v[92:95], v[172:175]
ds_read_b128 v[32:35], v238 offset:40960
v_add_f32 v1, v1, v49
v_add_f32 v2, v2, v50
v_mfma_f32_16x16x32_bf16 v[176:179], v[196:199], v[92:95], v[176:179]
ds_read_b128 v[36:39], v238 offset:41984
v_add_f32 v3, v3, v51
ds_read_b128 v[48:51], v246 offset:8192
s_waitcnt vmcnt(14) lgkmcnt(7)
v_mfma_f32_16x16x32_bf16 v[160:163], v[200:203], v[96:99], v[160:163]
ds_read_b128 v[180:183], v238 offset:43008
s_add_u32 s71, s75, 57344
buffer_load_dwordx4 v[136:139], v226, s[36:39], s71 offen sc1
v_mfma_f32_16x16x32_bf16 v[164:167], v[204:207], v[96:99], v[164:167]
ds_read_b128 v[184:187], v238 offset:44032
v_add_f32 v4, v4, v40
v_add_f32 v5, v5, v41
v_mfma_f32_16x16x32_bf16 v[168:171], v[208:211], v[96:99], v[168:171]
ds_read_b128 v[188:191], v238 offset:45056
v_add_f32 v6, v6, v42
v_add_f32 v7, v7, v43
ds_read_b128 v[40:43], v246 offset:9216
v_mfma_f32_16x16x32_bf16 v[172:175], v[212:215], v[96:99], v[172:175]
ds_read_b128 v[192:195], v238 offset:46080
s_waitcnt lgkmcnt(8)
v_add_f32 v8, v8, v44
v_mfma_f32_16x16x32_bf16 v[176:179], v[216:219], v[96:99], v[176:179]
ds_read_b128 v[196:199], v238 offset:47104
v_add_f32 v9, v9, v45
v_add_f32 v10, v10, v46
v_add_f32 v11, v11, v47
s_waitcnt vmcnt(14) lgkmcnt(7)
v_mfma_f32_16x16x32_bf16 v[160:163], v[20:23], v[100:103], v[160:163]
ds_read_b128 v[200:203], v238 offset:48128
s_add_u32 s71, s75, 61440
buffer_load_dwordx4 v[140:143], v226, s[36:39], s71 offen sc1
v_mfma_f32_16x16x32_bf16 v[164:167], v[24:27], v[100:103], v[164:167]
ds_read_b128 v[204:207], v238 offset:49152
ds_read_b128 v[44:47], v246 offset:10240
s_waitcnt lgkmcnt(9)
v_mfma_f32_16x16x32_bf16 v[168:171], v[28:31], v[100:103], v[168:171]
ds_read_b128 v[208:211], v238 offset:50176
v_add_f32 v12, v12, v48
v_add_f32 v13, v13, v49
v_add_f32 v14, v14, v50
v_mfma_f32_16x16x32_bf16 v[172:175], v[32:35], v[100:103], v[172:175]
ds_read_b128 v[212:215], v238 offset:51200
v_add_f32 v15, v15, v51
ds_read_b128 v[48:51], v246 offset:11264
v_mfma_f32_16x16x32_bf16 v[176:179], v[36:39], v[100:103], v[176:179]
ds_read_b128 v[216:219], v238 offset:52224
s_waitcnt lgkmcnt(9)
v_add_f32 v16, v16, v40
v_add_f32 v17, v17, v41
s_waitcnt vmcnt(14) lgkmcnt(7)
v_mfma_f32_16x16x32_bf16 v[160:163], v[180:183], v[104:107], v[160:163]
ds_read_b128 v[20:23], v238 offset:53248
s_add_u32 s71, s75, 65536
buffer_load_dwordx4 v[144:147], v226, s[36:39], s71 offen sc1
v_mfma_f32_16x16x32_bf16 v[164:167], v[184:187], v[104:107], v[164:167]
ds_read_b128 v[24:27], v238 offset:54272
v_add_f32 v18, v18, v42
v_add_f32 v19, v19, v43
v_mfma_f32_16x16x32_bf16 v[168:171], v[188:191], v[104:107], v[168:171]
ds_read_b128 v[28:31], v238 offset:55296
ds_read_b128 v[40:43], v246 offset:12288
s_waitcnt lgkmcnt(8)
v_add_f32 v0, v0, v44
v_mfma_f32_16x16x32_bf16 v[172:175], v[192:195], v[104:107], v[172:175]
ds_read_b128 v[32:35], v238 offset:56320
v_add_f32 v1, v1, v45
v_add_f32 v2, v2, v46
v_mfma_f32_16x16x32_bf16 v[176:179], v[196:199], v[104:107], v[176:179]
ds_read_b128 v[36:39], v238 offset:57344
v_add_f32 v3, v3, v47
ds_read_b128 v[44:47], v246 offset:13312
s_waitcnt vmcnt(14) lgkmcnt(7)
v_mfma_f32_16x16x32_bf16 v[160:163], v[200:203], v[108:111], v[160:163]
ds_read_b128 v[180:183], v238 offset:58368
s_add_u32 s71, s75, 69632
buffer_load_dwordx4 v[148:151], v226, s[36:39], s71 offen sc1
v_mfma_f32_16x16x32_bf16 v[164:167], v[204:207], v[108:111], v[164:167]
ds_read_b128 v[184:187], v238 offset:59392
v_add_f32 v4, v4, v48
v_add_f32 v5, v5, v49
v_mfma_f32_16x16x32_bf16 v[168:171], v[208:211], v[108:111], v[168:171]
ds_read_b128 v[188:191], v238 offset:60416
v_add_f32 v6, v6, v50
v_add_f32 v7, v7, v51
ds_read_b128 v[48:51], v246 offset:14336
v_mfma_f32_16x16x32_bf16 v[172:175], v[212:215], v[108:111], v[172:175]
ds_read_b128 v[192:195], v238 offset:61440
s_waitcnt lgkmcnt(8)
v_add_f32 v8, v8, v40
v_mfma_f32_16x16x32_bf16 v[176:179], v[216:219], v[108:111], v[176:179]
ds_read_b128 v[196:199], v238 offset:62464
v_add_f32 v9, v9, v41
v_add_f32 v10, v10, v42
v_add_f32 v11, v11, v43
s_waitcnt vmcnt(14) lgkmcnt(7)
v_mfma_f32_16x16x32_bf16 v[160:163], v[20:23], v[112:115], v[160:163]
ds_read_b128 v[200:203], v238 offset:63488
s_add_u32 s71, s75, 73728
buffer_load_dwordx4 v[152:155], v226, s[36:39], s71 offen sc1
v_mfma_f32_16x16x32_bf16 v[164:167], v[24:27], v[112:115], v[164:167]
ds_read_b128 v[204:207], v238 offset:64512
s_waitcnt lgkmcnt(8)
v_add_f32 v12, v12, v44
v_mfma_f32_16x16x32_bf16 v[168:171], v[28:31], v[112:115], v[168:171]
ds_read_b128 v[208:211], v236 offset:0
v_add_f32 v13, v13, v45
v_add_f32 v14, v14, v46
v_add_f32 v15, v15, v47
v_mfma_f32_16x16x32_bf16 v[172:175], v[32:35], v[112:115], v[172:175]
ds_read_b128 v[212:215], v236 offset:1024
s_waitcnt lgkmcnt(6)
v_add_f32 v16, v16, v48
v_mfma_f32_16x16x32_bf16 v[176:179], v[36:39], v[112:115], v[176:179]
ds_read_b128 v[216:219], v236 offset:2048
v_add_f32 v17, v17, v49
v_add_f32 v18, v18, v50
v_add_f32 v19, v19, v51
s_waitcnt vmcnt(14) lgkmcnt(5)
v_mfma_f32_16x16x32_bf16 v[160:163], v[180:183], v[116:119], v[160:163]
ds_read_b128 v[20:23], v236 offset:3072
s_add_u32 s71, s75, 77824
buffer_load_dwordx4 v[156:159], v226, s[36:39], s71 offen sc1
v_mfma_f32_16x16x32_bf16 v[164:167], v[184:187], v[116:119], v[164:167]
ds_read_b128 v[24:27], v236 offset:4096
v_mul_f32 v248, 0xbfb8aa3b, v0
v_mul_f32 v249, 0xbfb8aa3b, v1
v_mfma_f32_16x16x32_bf16 v[168:171], v[188:191], v[116:119], v[168:171]
ds_read_b128 v[28:31], v236 offset:5120
v_exp_f32 v248, v248
v_exp_f32 v249, v249
v_add_f32 v248, 1.0, v248
v_mfma_f32_16x16x32_bf16 v[172:175], v[192:195], v[116:119], v[172:175]
ds_read_b128 v[32:35], v236 offset:6144
v_add_f32 v249, 1.0, v249
v_rcp_f32 v248, v248
v_mfma_f32_16x16x32_bf16 v[176:179], v[196:199], v[116:119], v[176:179]
ds_read_b128 v[36:39], v236 offset:7168
v_rcp_f32 v249, v249
v_mul_f32 v0, v0, v248
v_mul_f32 v1, v1, v249
s_waitcnt vmcnt(9) lgkmcnt(5)
v_mfma_f32_16x16x32_bf16 v[160:163], v[200:203], v[120:123], v[160:163]
ds_read_b128 v[180:183], v236 offset:8192
v_mul_f32 v248, 0xbfb8aa3b, v2
v_mul_f32 v249, 0xbfb8aa3b, v3
v_mfma_f32_16x16x32_bf16 v[164:167], v[204:207], v[120:123], v[164:167]
ds_read_b128 v[184:187], v236 offset:9216
v_exp_f32 v248, v248
v_exp_f32 v249, v249
v_mfma_f32_16x16x32_bf16 v[168:171], v[208:211], v[120:123], v[168:171]
ds_read_b128 v[188:191], v236 offset:10240
v_add_f32 v248, 1.0, v248
v_add_f32 v249, 1.0, v249
v_mfma_f32_16x16x32_bf16 v[172:175], v[212:215], v[120:123], v[172:175]
ds_read_b128 v[192:195], v236 offset:11264
v_rcp_f32 v248, v248
v_rcp_f32 v249, v249
v_mfma_f32_16x16x32_bf16 v[176:179], v[216:219], v[120:123], v[176:179]
ds_read_b128 v[196:199], v236 offset:12288
v_mul_f32 v2, v2, v248
v_mul_f32 v3, v3, v249
s_waitcnt vmcnt(8) lgkmcnt(5)
v_mfma_f32_16x16x32_bf16 v[160:163], v[20:23], v[124:127], v[160:163]
ds_read_b128 v[200:203], v236 offset:13312
v_mul_f32 v248, 0xbfb8aa3b, v4
v_mul_f32 v249, 0xbfb8aa3b, v5
v_mfma_f32_16x16x32_bf16 v[164:167], v[24:27], v[124:127], v[164:167]
ds_read_b128 v[204:207], v236 offset:14336
v_exp_f32 v248, v248
v_exp_f32 v249, v249
v_mfma_f32_16x16x32_bf16 v[168:171], v[28:31], v[124:127], v[168:171]
ds_read_b128 v[208:211], v236 offset:15360
v_add_f32 v248, 1.0, v248
v_add_f32 v249, 1.0, v249
v_mfma_f32_16x16x32_bf16 v[172:175], v[32:35], v[124:127], v[172:175]
ds_read_b128 v[212:215], v236 offset:16384
v_rcp_f32 v248, v248
v_rcp_f32 v249, v249
v_mfma_f32_16x16x32_bf16 v[176:179], v[36:39], v[124:127], v[176:179]
ds_read_b128 v[216:219], v236 offset:17408
v_mul_f32 v4, v4, v248
v_mul_f32 v5, v5, v249
s_waitcnt vmcnt(7) lgkmcnt(5)
v_mfma_f32_16x16x32_bf16 v[160:163], v[180:183], v[128:131], v[160:163]
ds_read_b128 v[20:23], v236 offset:18432
v_mul_f32 v248, 0xbfb8aa3b, v6
v_mul_f32 v249, 0xbfb8aa3b, v7
v_mfma_f32_16x16x32_bf16 v[164:167], v[184:187], v[128:131], v[164:167]
ds_read_b128 v[24:27], v236 offset:19456
v_exp_f32 v248, v248
v_exp_f32 v249, v249
v_mfma_f32_16x16x32_bf16 v[168:171], v[188:191], v[128:131], v[168:171]
ds_read_b128 v[28:31], v236 offset:20480
v_add_f32 v248, 1.0, v248
v_add_f32 v249, 1.0, v249
v_mfma_f32_16x16x32_bf16 v[172:175], v[192:195], v[128:131], v[172:175]
ds_read_b128 v[32:35], v236 offset:21504
v_rcp_f32 v248, v248
v_rcp_f32 v249, v249
v_mfma_f32_16x16x32_bf16 v[176:179], v[196:199], v[128:131], v[176:179]
ds_read_b128 v[36:39], v236 offset:22528
v_mul_f32 v6, v6, v248
v_mul_f32 v7, v7, v249
s_waitcnt vmcnt(6) lgkmcnt(5)
v_mfma_f32_16x16x32_bf16 v[160:163], v[200:203], v[132:135], v[160:163]
ds_read_b128 v[180:183], v236 offset:23552
v_mul_f32 v248, 0xbfb8aa3b, v8
v_mul_f32 v249, 0xbfb8aa3b, v9
v_mfma_f32_16x16x32_bf16 v[164:167], v[204:207], v[132:135], v[164:167]
ds_read_b128 v[184:187], v236 offset:24576
v_exp_f32 v248, v248
v_exp_f32 v249, v249
v_mfma_f32_16x16x32_bf16 v[168:171], v[208:211], v[132:135], v[168:171]
ds_read_b128 v[188:191], v236 offset:25600
v_add_f32 v248, 1.0, v248
v_add_f32 v249, 1.0, v249
v_mfma_f32_16x16x32_bf16 v[172:175], v[212:215], v[132:135], v[172:175]
ds_read_b128 v[192:195], v236 offset:26624
v_rcp_f32 v248, v248
v_rcp_f32 v249, v249
v_mfma_f32_16x16x32_bf16 v[176:179], v[216:219], v[132:135], v[176:179]
ds_read_b128 v[196:199], v236 offset:27648
v_mul_f32 v8, v8, v248
v_mul_f32 v9, v9, v249
s_waitcnt vmcnt(5) lgkmcnt(5)
v_mfma_f32_16x16x32_bf16 v[160:163], v[20:23], v[136:139], v[160:163]
ds_read_b128 v[200:203], v236 offset:28672
v_mul_f32 v248, 0xbfb8aa3b, v10
v_mul_f32 v249, 0xbfb8aa3b, v11
v_mfma_f32_16x16x32_bf16 v[164:167], v[24:27], v[136:139], v[164:167]
ds_read_b128 v[204:207], v236 offset:29696
v_exp_f32 v248, v248
v_exp_f32 v249, v249
v_mfma_f32_16x16x32_bf16 v[168:171], v[28:31], v[136:139], v[168:171]
ds_read_b128 v[208:211], v236 offset:30720
v_add_f32 v248, 1.0, v248
v_add_f32 v249, 1.0, v249
v_mfma_f32_16x16x32_bf16 v[172:175], v[32:35], v[136:139], v[172:175]
ds_read_b128 v[212:215], v236 offset:31744
v_rcp_f32 v248, v248
v_rcp_f32 v249, v249
v_mfma_f32_16x16x32_bf16 v[176:179], v[36:39], v[136:139], v[176:179]
ds_read_b128 v[216:219], v226 offset:61440
v_mul_f32 v10, v10, v248
v_mul_f32 v11, v11, v249
s_waitcnt vmcnt(4) lgkmcnt(5)
v_mfma_f32_16x16x32_bf16 v[160:163], v[180:183], v[140:143], v[160:163]
ds_read_b128 v[20:23], v226 offset:62464
v_mul_f32 v248, 0xbfb8aa3b, v12
v_mul_f32 v249, 0xbfb8aa3b, v13
v_mfma_f32_16x16x32_bf16 v[164:167], v[184:187], v[140:143], v[164:167]
ds_read_b128 v[24:27], v226 offset:63488
v_exp_f32 v248, v248
v_exp_f32 v249, v249
v_mfma_f32_16x16x32_bf16 v[168:171], v[188:191], v[140:143], v[168:171]
ds_read_b128 v[28:31], v226 offset:64512
v_add_f32 v248, 1.0, v248
v_add_f32 v249, 1.0, v249
v_mfma_f32_16x16x32_bf16 v[172:175], v[192:195], v[140:143], v[172:175]
ds_read_b128 v[32:35], v238 offset:0
v_rcp_f32 v248, v248
v_rcp_f32 v249, v249
v_mfma_f32_16x16x32_bf16 v[176:179], v[196:199], v[140:143], v[176:179]
ds_read_b128 v[36:39], v238 offset:1024
v_mul_f32 v12, v12, v248
v_mul_f32 v13, v13, v249
s_waitcnt vmcnt(3) lgkmcnt(5)
v_mfma_f32_16x16x32_bf16 v[160:163], v[200:203], v[144:147], v[160:163]
ds_read_b128 v[180:183], v238 offset:2048
v_mul_f32 v248, 0xbfb8aa3b, v14
v_mul_f32 v249, 0xbfb8aa3b, v15
v_mfma_f32_16x16x32_bf16 v[164:167], v[204:207], v[144:147], v[164:167]
ds_read_b128 v[184:187], v238 offset:3072
v_exp_f32 v248, v248
v_exp_f32 v249, v249
v_mfma_f32_16x16x32_bf16 v[168:171], v[208:211], v[144:147], v[168:171]
ds_read_b128 v[188:191], v238 offset:4096
v_add_f32 v248, 1.0, v248
v_add_f32 v249, 1.0, v249
v_mfma_f32_16x16x32_bf16 v[172:175], v[212:215], v[144:147], v[172:175]
ds_read_b128 v[192:195], v238 offset:5120
v_rcp_f32 v248, v248
v_rcp_f32 v249, v249
v_mfma_f32_16x16x32_bf16 v[176:179], v[216:219], v[144:147], v[176:179]
ds_read_b128 v[196:199], v238 offset:6144
v_mul_f32 v14, v14, v248
v_mul_f32 v15, v15, v249
s_waitcnt vmcnt(2) lgkmcnt(5)
v_mfma_f32_16x16x32_bf16 v[160:163], v[20:23], v[148:151], v[160:163]
ds_read_b128 v[200:203], v238 offset:7168
v_mul_f32 v248, 0xbfb8aa3b, v16
v_mul_f32 v249, 0xbfb8aa3b, v17
v_mfma_f32_16x16x32_bf16 v[164:167], v[24:27], v[148:151], v[164:167]
ds_read_b128 v[204:207], v238 offset:8192
v_exp_f32 v248, v248
v_exp_f32 v249, v249
v_mfma_f32_16x16x32_bf16 v[168:171], v[28:31], v[148:151], v[168:171]
ds_read_b128 v[208:211], v238 offset:9216
v_add_f32 v248, 1.0, v248
v_add_f32 v249, 1.0, v249
v_mfma_f32_16x16x32_bf16 v[172:175], v[32:35], v[148:151], v[172:175]
ds_read_b128 v[212:215], v238 offset:10240
v_rcp_f32 v248, v248
v_rcp_f32 v249, v249
v_mfma_f32_16x16x32_bf16 v[176:179], v[36:39], v[148:151], v[176:179]
ds_read_b128 v[216:219], v238 offset:11264
v_mul_f32 v16, v16, v248
v_mul_f32 v17, v17, v249
s_waitcnt vmcnt(1) lgkmcnt(5)
v_mfma_f32_16x16x32_bf16 v[160:163], v[180:183], v[152:155], v[160:163]
v_mul_f32 v248, 0xbfb8aa3b, v18
v_mul_f32 v249, 0xbfb8aa3b, v19
v_mfma_f32_16x16x32_bf16 v[164:167], v[184:187], v[152:155], v[164:167]
v_exp_f32 v248, v248
v_exp_f32 v249, v249
v_mfma_f32_16x16x32_bf16 v[168:171], v[188:191], v[152:155], v[168:171]
v_add_f32 v248, 1.0, v248
v_add_f32 v249, 1.0, v249
v_mfma_f32_16x16x32_bf16 v[172:175], v[192:195], v[152:155], v[172:175]
v_rcp_f32 v248, v248
v_rcp_f32 v249, v249
v_mfma_f32_16x16x32_bf16 v[176:179], v[196:199], v[152:155], v[176:179]
v_mul_f32 v18, v18, v248
v_mul_f32 v19, v19, v249
s_waitcnt vmcnt(0) lgkmcnt(0)
v_mfma_f32_16x16x32_bf16 v[160:163], v[200:203], v[156:159], v[160:163]
v_mfma_f32_16x16x32_bf16 v[164:167], v[204:207], v[156:159], v[164:167]
v_mfma_f32_16x16x32_bf16 v[168:171], v[208:211], v[156:159], v[168:171]
v_mfma_f32_16x16x32_bf16 v[172:175], v[212:215], v[156:159], v[172:175]
v_mfma_f32_16x16x32_bf16 v[176:179], v[216:219], v[156:159], v[176:179]
s_nop 7
v_lshlrev_b32 v248, 16, v60
v_and_b32 v249, 0xffff0000, v60
v_lshlrev_b32 v250, 16, v61
v_and_b32 v251, 0xffff0000, v61
v_fma_f32 v248, v160, v0, v248
v_fma_f32 v249, v161, v1, v249
v_fma_f32 v250, v162, v2, v250
v_fma_f32 v251, v163, v3, v251
v_cvt_pk_bf16_f32 v60, v248, v249
v_cvt_pk_bf16_f32 v61, v250, v251
buffer_store_dwordx2 v[60:61], v237, s[40:43], s11 offen
v_lshlrev_b32 v248, 16, v62
v_and_b32 v249, 0xffff0000, v62
v_lshlrev_b32 v250, 16, v63
v_and_b32 v251, 0xffff0000, v63
v_fma_f32 v248, v164, v4, v248
v_fma_f32 v249, v165, v5, v249
v_fma_f32 v250, v166, v6, v250
v_fma_f32 v251, v167, v7, v251
v_cvt_pk_bf16_f32 v62, v248, v249
v_cvt_pk_bf16_f32 v63, v250, v251
buffer_store_dwordx2 v[62:63], v237, s[40:43], s11 offen offset:32
v_lshlrev_b32 v248, 16, v64
v_and_b32 v249, 0xffff0000, v64
v_lshlrev_b32 v250, 16, v65
v_and_b32 v251, 0xffff0000, v65
v_fma_f32 v248, v168, v8, v248
v_fma_f32 v249, v169, v9, v249
v_fma_f32 v250, v170, v10, v250
v_fma_f32 v251, v171, v11, v251
v_cvt_pk_bf16_f32 v64, v248, v249
v_cvt_pk_bf16_f32 v65, v250, v251
buffer_store_dwordx2 v[64:65], v237, s[40:43], s11 offen offset:64
v_lshlrev_b32 v248, 16, v66
v_and_b32 v249, 0xffff0000, v66
v_lshlrev_b32 v250, 16, v67
v_and_b32 v251, 0xffff0000, v67
v_fma_f32 v248, v172, v12, v248
v_fma_f32 v249, v173, v13, v249
v_fma_f32 v250, v174, v14, v250
v_fma_f32 v251, v175, v15, v251
v_cvt_pk_bf16_f32 v66, v248, v249
v_cvt_pk_bf16_f32 v67, v250, v251
buffer_store_dwordx2 v[66:67], v237, s[40:43], s11 offen offset:96
v_lshlrev_b32 v248, 16, v68
v_and_b32 v249, 0xffff0000, v68
v_lshlrev_b32 v250, 16, v69
v_and_b32 v251, 0xffff0000, v69
v_fma_f32 v248, v176, v16, v248
v_fma_f32 v249, v177, v17, v249
v_fma_f32 v250, v178, v18, v250
v_fma_f32 v251, v179, v19, v251
v_cvt_pk_bf16_f32 v68, v248, v249
v_cvt_pk_bf16_f32 v69, v250, v251
buffer_store_dwordx2 v[68:69], v237, s[40:43], s11 offen offset:128
s_waitcnt vmcnt(0)
s_endpgm
L_end_of_code:
.section .rodata,"a"
.p2align 6
.amdhsa_kernel recurrent_scan__sliding_block__geglu_ffn__prompt_kernel
  .amdhsa_next_free_vgpr 512
  .amdhsa_next_free_sgpr 102
  .amdhsa_accum_offset 256
  .amdhsa_group_segment_fixed_size 0
  .amdhsa_kernarg_size 80
  .amdhsa_user_sgpr_count 2
  .amdhsa_user_sgpr_kernarg_segment_ptr 1
  .amdhsa_system_sgpr_workgroup_id_x 1
.end_amdhsa_kernel
```
